```python
import torch

def _softmax(x, axis=-1):
    return torch.softmax(x, dim=axis)
def _gelu(x):
    return torch.nn.functional.gelu(x, approximate="tanh")
def _silu(x):
    return torch.nn.functional.silu(x)
def _sigmoid(x):
    return torch.sigmoid(x)
def _layernorm(x, axis=-1, eps=1e-5):
    m = x.mean(dim=axis, keepdim=True)
    v = x.var(dim=axis, keepdim=True, unbiased=False)
    return (x - m) / torch.sqrt(v + eps)
def _scatter_add(tgt, idx, src, axis=0):
    return tgt.clone().index_add_(axis, idx, src)
def _segment_sum(src, seg, n):
    out = torch.zeros((n,) + src.shape[1:], dtype=src.dtype)
    return out.index_add_(0, seg, src)
def _pad(x, pw):
    flat = tuple(v for pair in reversed(pw) for v in pair)
    return torch.nn.functional.pad(x, flat)

kernel_name = 'interleave_layers__spectral_gfnet__glu_gated_geglu__prompt'

def setup_inputs():

    _w = (lambda a: (lambda t: t.to(torch.bfloat16) if t.is_floating_point() else t)(torch.as_tensor(a)))
    def _A_setup():
        B, S, D = 1, 2048, 1024
        Df = D // 2 + 1
        return {
            "x": _w((lambda *s: torch.randn(*s, dtype=torch.bfloat16) * 0.05)(B, S, D)),
            "w_r": _w((lambda *s: torch.randn(*s, dtype=torch.bfloat16) * 0.4)(S, Df) * 0.02),
            "w_i": _w((lambda *s: torch.randn(*s, dtype=torch.bfloat16) * 0.4)(S, Df) * 0.02),
        }
    _A_in = _A_setup()

    def _B_setup():
        B, S, Dm, Df = 1, 2048, 1024, 3584
        return {
            "x": _w((lambda *s: torch.randn(*s, dtype=torch.bfloat16) * 0.05)(B, S, Dm)),
            "w_gate": _w((lambda *s: torch.randn(*s, dtype=torch.bfloat16) * 0.4)(Dm, Df) * (Dm ** -0.5)),
            "w_up": _w((lambda *s: torch.randn(*s, dtype=torch.bfloat16) * 0.4)(Dm, Df) * (Dm ** -0.5)),
            "w_down": _w((lambda *s: torch.randn(*s, dtype=torch.bfloat16) * 0.4)(Df, Dm) * (Df ** -0.5)),
        }
    _B_in = _B_setup()

    return {
        "A_x": _A_in["x"],
        "A_w_r": _A_in["w_r"],
        "A_w_i": _A_in["w_i"],
        "B_x": _B_in["x"],
        "B_w_gate": _B_in["w_gate"],
        "B_w_up": _B_in["w_up"],
        "B_w_down": _B_in["w_down"],
    }

def reference(A_x, A_w_r, A_w_i, B_x, B_w_gate, B_w_up, B_w_down):
    def _A_ref(x, w_r, w_i):
        B, S, D = x.shape
        X = (lambda x, axes=(-2,-1): torch.fft.rfft2(x.float(), dim=axes))(x, axes=(-2, -1))
        W = w_r + 1j * w_i
        X = X * W
        y = (lambda x, s, axes=(-2,-1): torch.fft.irfft2(x, s=s, dim=axes).to(torch.bfloat16))(X, (S, D), axes=(-2, -1))
        return y

    def _B_ref(x, w_gate, w_up, w_down):
        g = torch.einsum("bsd,df->bsf", x, w_gate)
        u = torch.einsum("bsd,df->bsf", x, w_up)
        h = _gelu(g) * u
        return torch.einsum("bsf,fd->bsd", h, w_down)

    x = A_x
    x = x + _A_ref(_layernorm(x, axis=-1), A_w_r, A_w_i)
    x = x + _B_ref(_layernorm(x, axis=-1), B_w_gate, B_w_up, B_w_down)
    x = x + _A_ref(_layernorm(x, axis=-1), A_w_r, A_w_i)
    x = x + _B_ref(_layernorm(x, axis=-1), B_w_gate, B_w_up, B_w_down)
    return x
```

```asm
; @launch kernel=fa_kernel grid=(256,1,1) block=(256,1,1) lds=163840
.amdgcn_target "amdgcn-amd-amdhsa--gfx950"
.text
.globl fa_kernel
.p2align 8
.type fa_kernel,@function
fa_kernel:
  s_cmp_lt_u32 s2, 256
  s_cbranch_scc1 fa_kernel_go
  s_endpgm
fa_kernel_go:
  s_load_dwordx2 s[94:95], s[0:1], 0
  s_load_dwordx4 s[64:67], s[0:1], 8
  s_load_dwordx4 s[72:75], s[0:1], 64
  s_load_dwordx8 s[84:91], s[0:1], 32
  s_getpc_b64 s[44:45]
fa_kernel_pc1:
  s_sub_u32 s44, s44, fa_kernel_pc1 - fa_kernel
  s_subb_u32 s45, s45, 0
  s_mov_b32 s46, fa_code_end - fa_kernel
  s_mov_b32 s47, 0x00020000
  v_lshlrev_b32 v250, 7, v0
  s_bfe_u32 s3, s2, 0x30003
  s_lshl_b32 s3, s3, 13
  v_and_b32 v251, 15, v0
  v_lshrrev_b32 v250, 6, v0
  v_lshl_add_u32 v250, v250, 4, v251
  v_lshlrev_b32 v250, 7, v250
  s_mov_b64 exec, 0xffff
  buffer_load_dword v251, v250, s[44:47], s3 offen
  s_mov_b64 exec, -1
fa_kernel_c0:
  s_mov_b32 s97, 0
  s_mov_b32 s81, -1
  v_lshrrev_b32 v1, 6, v0
  s_nop 0
  v_readfirstlane_b32 s96, v1
  s_and_b32 s36, s2, 7
  s_lshr_b32 s37, s2, 3
  s_and_b32 s54, s36, 1
  s_lshl_b32 s54, s54, 2
  s_and_b32 s35, s37, 3
  s_add_u32 s54, s54, s35
  s_lshr_b32 s55, s36, 1
  s_lshl_b32 s55, s55, 3
  s_lshr_b32 s36, s37, 2
  s_add_u32 s55, s55, s36
  v_mbcnt_lo_u32_b32 v1, -1, 0
  v_mbcnt_hi_u32_b32 v1, -1, v1
  s_lshl_b32 s3, s96, 6
  v_add_u32 v0, s3, v1
  v_and_b32 v2, 15, v1
  v_lshrrev_b32 v3, 4, v1
  s_mov_b32 s21, s96
  s_lshl_b32 s20, s54, 5
  s_add_u32 s20, s20, s55
  s_and_b32 s22, s20, 3
  s_lshl_b32 s22, s22, 2
  s_add_u32 s22, s22, s21
  s_lshl_b32 s22, s22, 6
  s_lshr_b32 s23, s20, 2
  s_add_u32 s22, s22, s23
  v_lshlrev_b32 v5, 9, v3
  v_lshl_add_u32 v5, v2, 2, v5
  s_lshl_b32 s24, s22, 11
  s_add_u32 s25, s24, 0x200000
  s_waitcnt lgkmcnt(0)
  s_mov_b32 s8, s94
  s_mov_b32 s9, s95
  s_mov_b32 s10, 0x400000
  s_mov_b32 s11, 0x00020000
  s_mov_b32 s60, s64
  s_mov_b32 s61, s65
  s_mov_b32 s62, 0x201000
  s_mov_b32 s63, 0x00020000
  s_mov_b32 s64, s66
  s_mov_b32 s65, s67
  s_mov_b32 s66, s62
  s_mov_b32 s67, 0x00020000
  s_mov_b32 s92, s74
  s_mov_b32 s93, s75
  s_cmp_lg_u32 s96, 0
  s_cbranch_scc1 fa_kernel_z0
  s_add_u32 s76, s92, 0x7000000
  s_addc_u32 s77, s93, 0
  s_mov_b32 s78, 0x8028000
  s_mov_b32 s79, 0x00020000
  v_lshlrev_b32 v6, 15, v1
  v_cmp_lt_u32 vcc, 4, v1
  v_mov_b32 v7, 0x7fd8000
  s_nop 0
  v_cndmask_b32 v7, 0, v7, vcc
  v_add_u32 v6, v6, v7
  v_mov_b32 v7, 0
  s_lshl_b32 s3, s20, 7
  s_mov_b64 exec, 0x3ff
  buffer_store_dword v7, v6, s[76:79], s3 offen sc1
  s_mov_b64 exec, -1
fa_kernel_z0:
  buffer_load_dword v24, v5, s[8:11], s24 offen offset:0
  buffer_load_dword v25, v5, s[8:11], s24 offen offset:128
  buffer_load_dword v26, v5, s[8:11], s24 offen offset:256
  buffer_load_dword v27, v5, s[8:11], s24 offen offset:384
  buffer_load_dword v28, v5, s[8:11], s24 offen offset:64
  buffer_load_dword v29, v5, s[8:11], s24 offen offset:192
  buffer_load_dword v30, v5, s[8:11], s24 offen offset:320
  buffer_load_dword v31, v5, s[8:11], s24 offen offset:448
  buffer_load_dword v32, v5, s[8:11], s25 offen offset:0
  buffer_load_dword v33, v5, s[8:11], s25 offen offset:128
  buffer_load_dword v34, v5, s[8:11], s25 offen offset:256
  buffer_load_dword v35, v5, s[8:11], s25 offen offset:384
  buffer_load_dword v36, v5, s[8:11], s25 offen offset:64
  buffer_load_dword v37, v5, s[8:11], s25 offen offset:192
  buffer_load_dword v38, v5, s[8:11], s25 offen offset:320
  buffer_load_dword v39, v5, s[8:11], s25 offen offset:448
  s_and_b32 s40, s20, 7
  s_lshr_b32 s41, s20, 3
  s_bfe_u32 s42, s41, 0x10004
  s_bfe_u32 s43, s41, 0x10003
  s_and_b32 s44, s41, 7
  s_lshl_b32 s44, s44, 2
  s_add_u32 s44, s44, s96
  s_lshl_b32 s44, s44, 6
  s_lshl_b32 s45, s42, 4
  s_add_u32 s44, s44, s45
  s_lshl_b32 s45, s43, 5
  s_add_u32 s44, s44, s45
  s_mul_i32 s44, s44, 1026
  s_lshl_b32 s45, s40, 7
  s_add_u32 s44, s44, s45
  v_lshlrev_b32 v4, 1, v1
  v_and_b32 v4, 31, v1
  v_lshlrev_b32 v4, 2, v4
  v_lshrrev_b32 v6, 5, v1
  v_mul_u32_u24 v6, 1026, v6
  v_add_u32 v4, v4, v6
  buffer_load_dword a100, v4, s[60:63], s44 offen offset:0
  buffer_load_dword a116, v4, s[64:67], s44 offen offset:0
  buffer_load_dword a101, v4, s[60:63], s44 offen offset:2052
  buffer_load_dword a117, v4, s[64:67], s44 offen offset:2052
  s_add_u32 s44, s44, 4104
  buffer_load_dword a102, v4, s[60:63], s44 offen offset:0
  buffer_load_dword a118, v4, s[64:67], s44 offen offset:0
  buffer_load_dword a103, v4, s[60:63], s44 offen offset:2052
  buffer_load_dword a119, v4, s[64:67], s44 offen offset:2052
  s_add_u32 s44, s44, 4104
  buffer_load_dword a104, v4, s[60:63], s44 offen offset:0
  buffer_load_dword a120, v4, s[64:67], s44 offen offset:0
  buffer_load_dword a105, v4, s[60:63], s44 offen offset:2052
  buffer_load_dword a121, v4, s[64:67], s44 offen offset:2052
  s_add_u32 s44, s44, 4104
  buffer_load_dword a106, v4, s[60:63], s44 offen offset:0
  buffer_load_dword a122, v4, s[64:67], s44 offen offset:0
  buffer_load_dword a107, v4, s[60:63], s44 offen offset:2052
  buffer_load_dword a123, v4, s[64:67], s44 offen offset:2052
  s_mov_b32 s68, s72
  s_mov_b32 s69, s73
  s_mov_b32 s70, 0x100
  s_mov_b32 s71, 0x00020000
  s_add_u32 s82, s92, 0x1000000
  s_addc_u32 s83, s93, 0
  s_mov_b32 s72, s82
  s_mov_b32 s73, s83
  s_mov_b32 s74, 0x400000
  s_mov_b32 s75, 0x00020000
  v_mov_b32 v136, 0
  v_mov_b32 v137, 0
  v_mov_b32 v138, 0
  v_mov_b32 v139, 0
  v_mov_b32 v140, 0
  v_mov_b32 v141, 0
  v_mov_b32 v142, 0
  v_mov_b32 v143, 0
  v_mov_b32 v144, 0
  v_mov_b32 v145, 0
  v_mov_b32 v146, 0
  v_mov_b32 v147, 0
  v_mov_b32 v148, 0
  v_mov_b32 v149, 0
  v_mov_b32 v150, 0
  v_mov_b32 v151, 0
  v_lshlrev_b32 v224, 4, v1
  s_and_b32 s38, s55, 1
  s_lshl_b32 s39, s38, 1
  v_add_u32 v240, 0, v1
  v_mul_u32_u24 v241, 4682, v240
  v_lshrrev_b32 v241, 16, v241
  v_mul_u32_u24 v242, 14, v241
  v_sub_u32 v240, v240, v242
  v_add_u32 v240, s39, v240
  v_subrev_u32 v242, 14, v240
  v_min_u32 v240, v240, v242
  v_bfe_u32 v242, v241, 2, 2
  v_and_b32 v243, 3, v241
  v_lshl_add_u32 v242, v242, 3, v243
  v_lshrrev_b32 v241, 4, v241
  v_lshl_add_u32 v242, v241, 2, v242
  v_mul_u32_u24 v242, 7168, v242
  v_lshl_add_u32 v228, v240, 4, v242
  v_add_u32 v240, 64, v1
  v_mul_u32_u24 v241, 4682, v240
  v_lshrrev_b32 v241, 16, v241
  v_mul_u32_u24 v242, 14, v241
  v_sub_u32 v240, v240, v242
  v_add_u32 v240, s39, v240
  v_subrev_u32 v242, 14, v240
  v_min_u32 v240, v240, v242
  v_bfe_u32 v242, v241, 2, 2
  v_and_b32 v243, 3, v241
  v_lshl_add_u32 v242, v242, 3, v243
  v_lshrrev_b32 v241, 4, v241
  v_lshl_add_u32 v242, v241, 2, v242
  v_mul_u32_u24 v242, 7168, v242
  v_lshl_add_u32 v229, v240, 4, v242
  v_add_u32 v240, 128, v1
  v_mul_u32_u24 v241, 4682, v240
  v_lshrrev_b32 v241, 16, v241
  v_mul_u32_u24 v242, 14, v241
  v_sub_u32 v240, v240, v242
  v_add_u32 v240, s39, v240
  v_subrev_u32 v242, 14, v240
  v_min_u32 v240, v240, v242
  v_bfe_u32 v242, v241, 2, 2
  v_and_b32 v243, 3, v241
  v_lshl_add_u32 v242, v242, 3, v243
  v_lshrrev_b32 v241, 4, v241
  v_lshl_add_u32 v242, v241, 2, v242
  v_mul_u32_u24 v242, 7168, v242
  v_lshl_add_u32 v230, v240, 4, v242
  v_add_u32 v240, 192, v1
  v_mul_u32_u24 v241, 4682, v240
  v_lshrrev_b32 v241, 16, v241
  v_mul_u32_u24 v242, 14, v241
  v_sub_u32 v240, v240, v242
  v_add_u32 v240, s39, v240
  v_subrev_u32 v242, 14, v240
  v_min_u32 v240, v240, v242
  v_bfe_u32 v242, v241, 2, 2
  v_and_b32 v243, 3, v241
  v_lshl_add_u32 v242, v242, 3, v243
  v_lshrrev_b32 v241, 4, v241
  v_lshl_add_u32 v242, v241, 2, v242
  v_mul_u32_u24 v242, 7168, v242
  v_lshl_add_u32 v231, v240, 4, v242
  v_add_u32 v240, 256, v1
  v_mul_u32_u24 v241, 4682, v240
  v_lshrrev_b32 v241, 16, v241
  v_mul_u32_u24 v242, 14, v241
  v_sub_u32 v240, v240, v242
  v_add_u32 v240, s39, v240
  v_subrev_u32 v242, 14, v240
  v_min_u32 v240, v240, v242
  v_bfe_u32 v242, v241, 2, 2
  v_and_b32 v243, 3, v241
  v_lshl_add_u32 v242, v242, 3, v243
  v_lshrrev_b32 v241, 4, v241
  v_lshl_add_u32 v242, v241, 2, v242
  v_mul_u32_u24 v242, 7168, v242
  v_lshl_add_u32 v232, v240, 4, v242
  v_add_u32 v240, 320, v1
  v_mul_u32_u24 v241, 4682, v240
  v_lshrrev_b32 v241, 16, v241
  v_mul_u32_u24 v242, 14, v241
  v_sub_u32 v240, v240, v242
  v_add_u32 v240, s39, v240
  v_subrev_u32 v242, 14, v240
  v_min_u32 v240, v240, v242
  v_bfe_u32 v242, v241, 2, 2
  v_and_b32 v243, 3, v241
  v_lshl_add_u32 v242, v242, 3, v243
  v_lshrrev_b32 v241, 4, v241
  v_lshl_add_u32 v242, v241, 2, v242
  v_mul_u32_u24 v242, 7168, v242
  v_lshl_add_u32 v233, v240, 4, v242
  v_add_u32 v240, 384, v1
  v_mul_u32_u24 v241, 4682, v240
  v_lshrrev_b32 v241, 16, v241
  v_mul_u32_u24 v242, 14, v241
  v_sub_u32 v240, v240, v242
  v_add_u32 v240, s39, v240
  v_subrev_u32 v242, 14, v240
  v_min_u32 v240, v240, v242
  v_bfe_u32 v242, v241, 2, 2
  v_and_b32 v243, 3, v241
  v_lshl_add_u32 v242, v242, 3, v243
  v_lshrrev_b32 v241, 4, v241
  v_lshl_add_u32 v242, v241, 2, v242
  v_mul_u32_u24 v242, 7168, v242
  v_lshl_add_u32 v234, v240, 4, v242
  s_lshr_b32 s36, s96, 1
  s_mul_i32 s53, s36, 229376
  s_mul_i32 s36, s55, 224
  s_add_u32 s53, s53, s36
  s_mul_i32 s52, s96, 7168
  s_bitcmp1_b32 s96, 0
  s_cselect_b32 s48, s86, s84
  s_cselect_b32 s49, s87, s85
  s_mov_b32 s50, 7340032
  s_mov_b32 s51, 0x00020000
  v_lshrrev_b32 v240, 2, v1
  v_mul_u32_u24 v240, 224, v240
  v_and_b32 v241, 3, v1
  v_lshl_add_u32 v225, v241, 3, v240
  v_add_u32 v226, 57344, v225
  v_add_u32 v227, 114688, v225
  s_add_u32 s56, s53, 6881280
  v_accvgpr_write_b32 a240, v224
  v_accvgpr_write_b32 a241, v225
  v_accvgpr_write_b32 a242, v226
  v_accvgpr_write_b32 a243, v227
  v_accvgpr_write_b32 a244, v228
  v_accvgpr_write_b32 a245, v229
  v_accvgpr_write_b32 a246, v230
  v_accvgpr_write_b32 a247, v231
  v_accvgpr_write_b32 a248, v232
  v_accvgpr_write_b32 a249, v233
  v_accvgpr_write_b32 a250, v234
  s_branch fa_kernel_k1
fa_kernel_w0:
  s_cmp_eq_u32 s96, 3
  s_cbranch_scc0 fa_kernel_n0
  s_lshl_b32 s46, s20, 3
  v_and_b32 v250, 7, v1
  v_add_u32 v250, s46, v250
  s_bfe_u32 s46, s20, 0x10007
  s_lshl_b32 s46, s46, 4
  s_bfe_u32 s47, s20, 0x10006
  s_lshl_b32 s47, s47, 5
  s_add_u32 s46, s46, s47
  s_bfe_u32 s47, s20, 0x10005
  s_lshl_b32 s47, s47, 10
  s_add_u32 s46, s46, s47
  s_bfe_u32 s47, s20, 0x20003
  s_lshl_b32 s47, s47, 8
  s_add_u32 s46, s46, s47
  v_bfe_u32 v251, v250, 2, 4
  v_and_b32 v250, 3, v250
  v_lshl_add_u32 v250, v250, 6, v251
  v_add_u32 v250, s46, v250
  v_sub_u32 v251, 0x800, v250
  v_and_b32 v251, 0x7ff, v251
  v_cmp_lt_u32 vcc, 7, v1
  s_nop 1
  v_cndmask_b32 v250, v250, v251, vcc
  v_mul_u32_u24 v250, 1026, v250
  s_mov_b64 exec, 0xffff
  buffer_load_ushort a132, v250, s[60:63], 0 offen offset:1024
  buffer_load_ushort a133, v250, s[64:67], 0 offen offset:1024
  s_mov_b64 exec, -1
fa_kernel_n0:
  s_mov_b32 s60, s84
  s_mov_b32 s61, s85
  s_cmp_eq_u32 s97, 0
  s_cselect_b32 s62, 7340032, 0
  s_mov_b32 s63, 0x00020000
  v_lshlrev_b32 v252, 7, v0
  s_lshl_b32 s64, s20, 15
  buffer_load_dword v253, v252, s[60:63], s64 offen
  s_and_b32 s23, s96, 1
  v_cvt_f32_u32 v104, v2
  v_cvt_f32_u32 v105, v3
  v_mov_b32 v106, s23
  v_cvt_f32_u32 v106, v106
  v_mul_f32 v105, 4.0, v105
  v_fmamk_f32 v113, v106, 0x41800000, v105
  v_mul_f32 v114, 0.5, v106
  v_add_f32 v107, 0x0, v104
  v_mul_f32 v107, 0x3a000000, v107
  v_mul_f32 v108, v113, v107
  v_mov_b32 v109, v108
  v_cos_f32 v216, v109
  v_sin_f32 v232, v109
  v_add_f32 v109, v107, v108
  v_cos_f32 v217, v109
  v_sin_f32 v233, v109
  v_fmamk_f32 v109, v107, 0x40000000, v108
  v_cos_f32 v218, v109
  v_sin_f32 v234, v109
  v_fmamk_f32 v109, v107, 0x40400000, v108
  v_cos_f32 v219, v109
  v_sin_f32 v235, v109
  v_add_f32 v108, v108, v114
  v_fmamk_f32 v109, v107, 0x42000000, v108
  v_cos_f32 v224, v109
  v_sin_f32 v240, v109
  v_fmamk_f32 v109, v107, 0x42040000, v108
  v_cos_f32 v225, v109
  v_sin_f32 v241, v109
  v_fmamk_f32 v109, v107, 0x42080000, v108
  v_cos_f32 v226, v109
  v_sin_f32 v242, v109
  v_fmamk_f32 v109, v107, 0x420c0000, v108
  v_cos_f32 v227, v109
  v_sin_f32 v243, v109
  v_add_f32 v107, 0x41800000, v104
  v_mul_f32 v107, 0x3a000000, v107
  v_mul_f32 v108, v113, v107
  v_mov_b32 v109, v108
  v_cos_f32 v220, v109
  v_sin_f32 v236, v109
  v_add_f32 v109, v107, v108
  v_cos_f32 v221, v109
  v_sin_f32 v237, v109
  v_fmamk_f32 v109, v107, 0x40000000, v108
  v_cos_f32 v222, v109
  v_sin_f32 v238, v109
  v_fmamk_f32 v109, v107, 0x40400000, v108
  v_cos_f32 v223, v109
  v_sin_f32 v239, v109
  v_add_f32 v108, v108, v114
  v_fmamk_f32 v109, v107, 0x42000000, v108
  v_cos_f32 v228, v109
  v_sin_f32 v244, v109
  v_fmamk_f32 v109, v107, 0x42040000, v108
  v_cos_f32 v229, v109
  v_sin_f32 v245, v109
  v_fmamk_f32 v109, v107, 0x42080000, v108
  v_cos_f32 v230, v109
  v_sin_f32 v246, v109
  v_fmamk_f32 v109, v107, 0x420c0000, v108
  v_cos_f32 v231, v109
  v_sin_f32 v247, v109
  v_bfe_u32 v118, v2, 3, 1
  v_lshlrev_b32 v118, 2, v118
  v_bfe_u32 v119, v2, 1, 1
  v_add_u32 v118, v118, v119
  v_cvt_f32_u32 v118, v118
  v_fmamk_f32 v118, v106, 0x3f000000, v118
  v_mul_f32 v117, 0x3d000000, v118
  v_and_b32 v118, 1, v2
  v_cvt_f32_u32 v118, v118
  v_mul_f32 v118, 0xbe800000, v118
  v_add_f32 v114, 0x3e000000, v118
  v_add_f32 v115, 0xbe000000, v118
  v_bfe_u32 v119, v2, 2, 1
  v_lshlrev_b32 v119, 31, v119
  v_xor_b32 v114, v119, v114
  v_xor_b32 v115, v119, v115
  v_sub_f32 v118, 1.0, v106
  v_fmamk_f32 v116, v118, 0x41800000, v105
  v_add_f32 v107, 0x0, v117
  v_fma_f32 v118, v113, v107, v114
  v_fma_f32 v119, v113, v107, v115
  v_mov_b32 v109, v118
  v_cos_f32 v110, v109
  v_sin_f32 v111, v109
  s_nop 0
  v_cvt_pk_bf16_f32 v120, v110, v111
  v_accvgpr_write_b32 a64, v120
  v_add_f32 v109, v107, v119
  v_cos_f32 v110, v109
  v_sin_f32 v111, v109
  s_nop 0
  v_cvt_pk_bf16_f32 v120, v110, v111
  v_accvgpr_write_b32 a65, v120
  v_fmamk_f32 v109, v107, 0x40000000, v118
  v_cos_f32 v110, v109
  v_sin_f32 v111, v109
  s_nop 0
  v_cvt_pk_bf16_f32 v120, v110, v111
  v_accvgpr_write_b32 a66, v120
  v_fmamk_f32 v109, v107, 0x40400000, v119
  v_cos_f32 v110, v109
  v_sin_f32 v111, v109
  s_nop 0
  v_cvt_pk_bf16_f32 v120, v110, v111
  v_accvgpr_write_b32 a67, v120
  v_fma_f32 v118, v116, v107, v114
  v_fma_f32 v119, v116, v107, v115
  v_mov_b32 v109, v118
  v_cos_f32 v110, v109
  v_sin_f32 v111, v109
  s_nop 0
  v_cvt_pk_bf16_f32 v120, v110, v111
  v_accvgpr_write_b32 a80, v120
  v_add_f32 v109, v107, v119
  v_cos_f32 v110, v109
  v_sin_f32 v111, v109
  s_nop 0
  v_cvt_pk_bf16_f32 v120, v110, v111
  v_accvgpr_write_b32 a81, v120
  v_fmamk_f32 v109, v107, 0x40000000, v118
  v_cos_f32 v110, v109
  v_sin_f32 v111, v109
  s_nop 0
  v_cvt_pk_bf16_f32 v120, v110, v111
  v_accvgpr_write_b32 a82, v120
  v_fmamk_f32 v109, v107, 0x40400000, v119
  v_cos_f32 v110, v109
  v_sin_f32 v111, v109
  s_nop 0
  v_cvt_pk_bf16_f32 v120, v110, v111
  v_accvgpr_write_b32 a83, v120
  v_add_f32 v107, 0x3d800000, v117
  v_fma_f32 v118, v113, v107, v114
  v_fma_f32 v119, v113, v107, v115
  v_mov_b32 v109, v118
  v_cos_f32 v110, v109
  v_sin_f32 v111, v109
  s_nop 0
  v_cvt_pk_bf16_f32 v120, v110, v111
  v_accvgpr_write_b32 a68, v120
  v_add_f32 v109, v107, v119
  v_cos_f32 v110, v109
  v_sin_f32 v111, v109
  s_nop 0
  v_cvt_pk_bf16_f32 v120, v110, v111
  v_accvgpr_write_b32 a69, v120
  v_fmamk_f32 v109, v107, 0x40000000, v118
  v_cos_f32 v110, v109
  v_sin_f32 v111, v109
  s_nop 0
  v_cvt_pk_bf16_f32 v120, v110, v111
  v_accvgpr_write_b32 a70, v120
  v_fmamk_f32 v109, v107, 0x40400000, v119
  v_cos_f32 v110, v109
  v_sin_f32 v111, v109
  s_nop 0
  v_cvt_pk_bf16_f32 v120, v110, v111
  v_accvgpr_write_b32 a71, v120
  v_fma_f32 v118, v116, v107, v114
  v_fma_f32 v119, v116, v107, v115
  v_mov_b32 v109, v118
  v_cos_f32 v110, v109
  v_sin_f32 v111, v109
  s_nop 0
  v_cvt_pk_bf16_f32 v120, v110, v111
  v_accvgpr_write_b32 a84, v120
  v_add_f32 v109, v107, v119
  v_cos_f32 v110, v109
  v_sin_f32 v111, v109
  s_nop 0
  v_cvt_pk_bf16_f32 v120, v110, v111
  v_accvgpr_write_b32 a85, v120
  v_fmamk_f32 v109, v107, 0x40000000, v118
  v_cos_f32 v110, v109
  v_sin_f32 v111, v109
  s_nop 0
  v_cvt_pk_bf16_f32 v120, v110, v111
  v_accvgpr_write_b32 a86, v120
  v_fmamk_f32 v109, v107, 0x40400000, v119
  v_cos_f32 v110, v109
  v_sin_f32 v111, v109
  s_nop 0
  v_cvt_pk_bf16_f32 v120, v110, v111
  v_accvgpr_write_b32 a87, v120
  v_add_f32 v107, 0x3e800000, v117
  v_fma_f32 v118, v113, v107, v114
  v_fma_f32 v119, v113, v107, v115
  v_mov_b32 v109, v118
  v_cos_f32 v110, v109
  v_sin_f32 v111, v109
  s_nop 0
  v_cvt_pk_bf16_f32 v120, v110, v111
  v_accvgpr_write_b32 a72, v120
  v_add_f32 v109, v107, v119
  v_cos_f32 v110, v109
  v_sin_f32 v111, v109
  s_nop 0
  v_cvt_pk_bf16_f32 v120, v110, v111
  v_accvgpr_write_b32 a73, v120
  v_fmamk_f32 v109, v107, 0x40000000, v118
  v_cos_f32 v110, v109
  v_sin_f32 v111, v109
  s_nop 0
  v_cvt_pk_bf16_f32 v120, v110, v111
  v_accvgpr_write_b32 a74, v120
  v_fmamk_f32 v109, v107, 0x40400000, v119
  v_cos_f32 v110, v109
  v_sin_f32 v111, v109
  s_nop 0
  v_cvt_pk_bf16_f32 v120, v110, v111
  v_accvgpr_write_b32 a75, v120
  v_fma_f32 v118, v116, v107, v114
  v_fma_f32 v119, v116, v107, v115
  v_mov_b32 v109, v118
  v_cos_f32 v110, v109
  v_sin_f32 v111, v109
  s_nop 0
  v_cvt_pk_bf16_f32 v120, v110, v111
  v_accvgpr_write_b32 a88, v120
  v_add_f32 v109, v107, v119
  v_cos_f32 v110, v109
  v_sin_f32 v111, v109
  s_nop 0
  v_cvt_pk_bf16_f32 v120, v110, v111
  v_accvgpr_write_b32 a89, v120
  v_fmamk_f32 v109, v107, 0x40000000, v118
  v_cos_f32 v110, v109
  v_sin_f32 v111, v109
  s_nop 0
  v_cvt_pk_bf16_f32 v120, v110, v111
  v_accvgpr_write_b32 a90, v120
  v_fmamk_f32 v109, v107, 0x40400000, v119
  v_cos_f32 v110, v109
  v_sin_f32 v111, v109
  s_nop 0
  v_cvt_pk_bf16_f32 v120, v110, v111
  v_accvgpr_write_b32 a91, v120
  v_add_f32 v107, 0x3ea00000, v117
  v_fma_f32 v118, v113, v107, v114
  v_fma_f32 v119, v113, v107, v115
  v_mov_b32 v109, v118
  v_cos_f32 v110, v109
  v_sin_f32 v111, v109
  s_nop 0
  v_cvt_pk_bf16_f32 v120, v110, v111
  v_accvgpr_write_b32 a76, v120
  v_add_f32 v109, v107, v119
  v_cos_f32 v110, v109
  v_sin_f32 v111, v109
  s_nop 0
  v_cvt_pk_bf16_f32 v120, v110, v111
  v_accvgpr_write_b32 a77, v120
  v_fmamk_f32 v109, v107, 0x40000000, v118
  v_cos_f32 v110, v109
  v_sin_f32 v111, v109
  s_nop 0
  v_cvt_pk_bf16_f32 v120, v110, v111
  v_accvgpr_write_b32 a78, v120
  v_fmamk_f32 v109, v107, 0x40400000, v119
  v_cos_f32 v110, v109
  v_sin_f32 v111, v109
  s_nop 0
  v_cvt_pk_bf16_f32 v120, v110, v111
  v_accvgpr_write_b32 a79, v120
  v_fma_f32 v118, v116, v107, v114
  v_fma_f32 v119, v116, v107, v115
  v_mov_b32 v109, v118
  v_cos_f32 v110, v109
  v_sin_f32 v111, v109
  s_nop 0
  v_cvt_pk_bf16_f32 v120, v110, v111
  v_accvgpr_write_b32 a92, v120
  v_add_f32 v109, v107, v119
  v_cos_f32 v110, v109
  v_sin_f32 v111, v109
  s_nop 0
  v_cvt_pk_bf16_f32 v120, v110, v111
  v_accvgpr_write_b32 a93, v120
  v_fmamk_f32 v109, v107, 0x40000000, v118
  v_cos_f32 v110, v109
  v_sin_f32 v111, v109
  s_nop 0
  v_cvt_pk_bf16_f32 v120, v110, v111
  v_accvgpr_write_b32 a94, v120
  v_fmamk_f32 v109, v107, 0x40400000, v119
  v_cos_f32 v110, v109
  v_sin_f32 v111, v109
  s_nop 0
  v_cvt_pk_bf16_f32 v120, v110, v111
  v_accvgpr_write_b32 a95, v120
  s_waitcnt vmcnt(17)
  s_lshl_b32 s3, s96, 5
  s_or_b32 s3, s3, s20
  s_cmp_lt_u32 s3, 32
  s_cbranch_scc0 fa_kernel_k1c
  v_mov_b32 v250, 1
  v_mov_b32 v251, 0
  s_mov_b64 exec, 1
  buffer_store_byte v250, v251, s[68:71], s20 offen sc1
  s_mov_b64 exec, -1
  s_branch fa_kernel_k1c
fa_kernel_k2w:
  v_cvt_f32_u32 v104, v2
  v_cvt_f32_u32 v105, v3
  v_mov_b32 v106, s23
  v_cvt_f32_u32 v106, v106
  v_mul_f32 v105, 4.0, v105
  v_fmamk_f32 v113, v106, 0x41800000, v105
  v_mul_f32 v114, 0.5, v106
  v_add_f32 v107, 0x0, v104
  v_mul_f32 v107, 0x3a000000, v107
  v_mul_f32 v108, v113, v107
  v_mov_b32 v109, v108
  v_cos_f32 v216, v109
  v_sin_f32 v232, v109
  v_add_f32 v109, v107, v108
  v_cos_f32 v217, v109
  v_sin_f32 v233, v109
  v_fmamk_f32 v109, v107, 0x40000000, v108
  v_cos_f32 v218, v109
  v_sin_f32 v234, v109
  v_fmamk_f32 v109, v107, 0x40400000, v108
  v_cos_f32 v219, v109
  v_sin_f32 v235, v109
  v_add_f32 v108, v108, v114
  v_fmamk_f32 v109, v107, 0x42000000, v108
  v_cos_f32 v224, v109
  v_sin_f32 v240, v109
  v_fmamk_f32 v109, v107, 0x42040000, v108
  v_cos_f32 v225, v109
  v_sin_f32 v241, v109
  v_fmamk_f32 v109, v107, 0x42080000, v108
  v_cos_f32 v226, v109
  v_sin_f32 v242, v109
  v_fmamk_f32 v109, v107, 0x420c0000, v108
  v_cos_f32 v227, v109
  v_sin_f32 v243, v109
  v_add_f32 v107, 0x41800000, v104
  v_mul_f32 v107, 0x3a000000, v107
  v_mul_f32 v108, v113, v107
  v_mov_b32 v109, v108
  v_cos_f32 v220, v109
  v_sin_f32 v236, v109
  v_add_f32 v109, v107, v108
  v_cos_f32 v221, v109
  v_sin_f32 v237, v109
  v_fmamk_f32 v109, v107, 0x40000000, v108
  v_cos_f32 v222, v109
  v_sin_f32 v238, v109
  v_fmamk_f32 v109, v107, 0x40400000, v108
  v_cos_f32 v223, v109
  v_sin_f32 v239, v109
  v_add_f32 v108, v108, v114
  v_fmamk_f32 v109, v107, 0x42000000, v108
  v_cos_f32 v228, v109
  v_sin_f32 v244, v109
  v_fmamk_f32 v109, v107, 0x42040000, v108
  v_cos_f32 v229, v109
  v_sin_f32 v245, v109
  v_fmamk_f32 v109, v107, 0x42080000, v108
  v_cos_f32 v230, v109
  v_sin_f32 v246, v109
  v_fmamk_f32 v109, v107, 0x420c0000, v108
  v_cos_f32 v231, v109
  v_sin_f32 v247, v109
  v_bfe_u32 v118, v2, 3, 1
  v_lshlrev_b32 v118, 2, v118
  v_bfe_u32 v119, v2, 1, 1
  v_add_u32 v118, v118, v119
  v_cvt_f32_u32 v118, v118
  v_fmamk_f32 v118, v106, 0x3f000000, v118
  v_mul_f32 v117, 0x3d000000, v118
  v_and_b32 v118, 1, v2
  v_cvt_f32_u32 v118, v118
  v_mul_f32 v118, 0xbe800000, v118
  v_add_f32 v114, 0x3e000000, v118
  v_add_f32 v115, 0xbe000000, v118
  v_bfe_u32 v119, v2, 2, 1
  v_lshlrev_b32 v119, 31, v119
  v_xor_b32 v114, v119, v114
  v_xor_b32 v115, v119, v115
  v_sub_f32 v118, 1.0, v106
  v_fmamk_f32 v116, v118, 0x41800000, v105
  v_add_f32 v107, 0x0, v117
  v_fma_f32 v118, v113, v107, v114
  v_fma_f32 v119, v113, v107, v115
  v_mov_b32 v109, v118
  v_cos_f32 v110, v109
  v_sin_f32 v111, v109
  s_nop 0
  v_cvt_pk_bf16_f32 v120, v110, v111
  v_accvgpr_write_b32 a64, v120
  v_add_f32 v109, v107, v119
  v_cos_f32 v110, v109
  v_sin_f32 v111, v109
  s_nop 0
  v_cvt_pk_bf16_f32 v120, v110, v111
  v_accvgpr_write_b32 a65, v120
  v_fmamk_f32 v109, v107, 0x40000000, v118
  v_cos_f32 v110, v109
  v_sin_f32 v111, v109
  s_nop 0
  v_cvt_pk_bf16_f32 v120, v110, v111
  v_accvgpr_write_b32 a66, v120
  v_fmamk_f32 v109, v107, 0x40400000, v119
  v_cos_f32 v110, v109
  v_sin_f32 v111, v109
  s_nop 0
  v_cvt_pk_bf16_f32 v120, v110, v111
  v_accvgpr_write_b32 a67, v120
  v_fma_f32 v118, v116, v107, v114
  v_fma_f32 v119, v116, v107, v115
  v_mov_b32 v109, v118
  v_cos_f32 v110, v109
  v_sin_f32 v111, v109
  s_nop 0
  v_cvt_pk_bf16_f32 v120, v110, v111
  v_accvgpr_write_b32 a80, v120
  v_add_f32 v109, v107, v119
  v_cos_f32 v110, v109
  v_sin_f32 v111, v109
  s_nop 0
  v_cvt_pk_bf16_f32 v120, v110, v111
  v_accvgpr_write_b32 a81, v120
  v_fmamk_f32 v109, v107, 0x40000000, v118
  v_cos_f32 v110, v109
  v_sin_f32 v111, v109
  s_nop 0
  v_cvt_pk_bf16_f32 v120, v110, v111
  v_accvgpr_write_b32 a82, v120
  v_fmamk_f32 v109, v107, 0x40400000, v119
  v_cos_f32 v110, v109
  v_sin_f32 v111, v109
  s_nop 0
  v_cvt_pk_bf16_f32 v120, v110, v111
  v_accvgpr_write_b32 a83, v120
  v_add_f32 v107, 0x3d800000, v117
  v_fma_f32 v118, v113, v107, v114
  v_fma_f32 v119, v113, v107, v115
  v_mov_b32 v109, v118
  v_cos_f32 v110, v109
  v_sin_f32 v111, v109
  s_nop 0
  v_cvt_pk_bf16_f32 v120, v110, v111
  v_accvgpr_write_b32 a68, v120
  v_add_f32 v109, v107, v119
  v_cos_f32 v110, v109
  v_sin_f32 v111, v109
  s_nop 0
  v_cvt_pk_bf16_f32 v120, v110, v111
  v_accvgpr_write_b32 a69, v120
  v_fmamk_f32 v109, v107, 0x40000000, v118
  v_cos_f32 v110, v109
  v_sin_f32 v111, v109
  s_nop 0
  v_cvt_pk_bf16_f32 v120, v110, v111
  v_accvgpr_write_b32 a70, v120
  v_fmamk_f32 v109, v107, 0x40400000, v119
  v_cos_f32 v110, v109
  v_sin_f32 v111, v109
  s_nop 0
  v_cvt_pk_bf16_f32 v120, v110, v111
  v_accvgpr_write_b32 a71, v120
  v_fma_f32 v118, v116, v107, v114
  v_fma_f32 v119, v116, v107, v115
  v_mov_b32 v109, v118
  v_cos_f32 v110, v109
  v_sin_f32 v111, v109
  s_nop 0
  v_cvt_pk_bf16_f32 v120, v110, v111
  v_accvgpr_write_b32 a84, v120
  v_add_f32 v109, v107, v119
  v_cos_f32 v110, v109
  v_sin_f32 v111, v109
  s_nop 0
  v_cvt_pk_bf16_f32 v120, v110, v111
  v_accvgpr_write_b32 a85, v120
  v_fmamk_f32 v109, v107, 0x40000000, v118
  v_cos_f32 v110, v109
  v_sin_f32 v111, v109
  s_nop 0
  v_cvt_pk_bf16_f32 v120, v110, v111
  v_accvgpr_write_b32 a86, v120
  v_fmamk_f32 v109, v107, 0x40400000, v119
  v_cos_f32 v110, v109
  v_sin_f32 v111, v109
  s_nop 0
  v_cvt_pk_bf16_f32 v120, v110, v111
  v_accvgpr_write_b32 a87, v120
  v_add_f32 v107, 0x3e800000, v117
  v_fma_f32 v118, v113, v107, v114
  v_fma_f32 v119, v113, v107, v115
  v_mov_b32 v109, v118
  v_cos_f32 v110, v109
  v_sin_f32 v111, v109
  s_nop 0
  v_cvt_pk_bf16_f32 v120, v110, v111
  v_accvgpr_write_b32 a72, v120
  v_add_f32 v109, v107, v119
  v_cos_f32 v110, v109
  v_sin_f32 v111, v109
  s_nop 0
  v_cvt_pk_bf16_f32 v120, v110, v111
  v_accvgpr_write_b32 a73, v120
  v_fmamk_f32 v109, v107, 0x40000000, v118
  v_cos_f32 v110, v109
  v_sin_f32 v111, v109
  s_nop 0
  v_cvt_pk_bf16_f32 v120, v110, v111
  v_accvgpr_write_b32 a74, v120
  v_fmamk_f32 v109, v107, 0x40400000, v119
  v_cos_f32 v110, v109
  v_sin_f32 v111, v109
  s_nop 0
  v_cvt_pk_bf16_f32 v120, v110, v111
  v_accvgpr_write_b32 a75, v120
  v_fma_f32 v118, v116, v107, v114
  v_fma_f32 v119, v116, v107, v115
  v_mov_b32 v109, v118
  v_cos_f32 v110, v109
  v_sin_f32 v111, v109
  s_nop 0
  v_cvt_pk_bf16_f32 v120, v110, v111
  v_accvgpr_write_b32 a88, v120
  v_add_f32 v109, v107, v119
  v_cos_f32 v110, v109
  v_sin_f32 v111, v109
  s_nop 0
  v_cvt_pk_bf16_f32 v120, v110, v111
  v_accvgpr_write_b32 a89, v120
  v_fmamk_f32 v109, v107, 0x40000000, v118
  v_cos_f32 v110, v109
  v_sin_f32 v111, v109
  s_nop 0
  v_cvt_pk_bf16_f32 v120, v110, v111
  v_accvgpr_write_b32 a90, v120
  v_fmamk_f32 v109, v107, 0x40400000, v119
  v_cos_f32 v110, v109
  v_sin_f32 v111, v109
  s_nop 0
  v_cvt_pk_bf16_f32 v120, v110, v111
  v_accvgpr_write_b32 a91, v120
  v_add_f32 v107, 0x3ea00000, v117
  v_fma_f32 v118, v113, v107, v114
  v_fma_f32 v119, v113, v107, v115
  v_mov_b32 v109, v118
  v_cos_f32 v110, v109
  v_sin_f32 v111, v109
  s_nop 0
  v_cvt_pk_bf16_f32 v120, v110, v111
  v_accvgpr_write_b32 a76, v120
  v_add_f32 v109, v107, v119
  v_cos_f32 v110, v109
  v_sin_f32 v111, v109
  s_nop 0
  v_cvt_pk_bf16_f32 v120, v110, v111
  v_accvgpr_write_b32 a77, v120
  v_fmamk_f32 v109, v107, 0x40000000, v118
  v_cos_f32 v110, v109
  v_sin_f32 v111, v109
  s_nop 0
  v_cvt_pk_bf16_f32 v120, v110, v111
  v_accvgpr_write_b32 a78, v120
  v_fmamk_f32 v109, v107, 0x40400000, v119
  v_cos_f32 v110, v109
  v_sin_f32 v111, v109
  s_nop 0
  v_cvt_pk_bf16_f32 v120, v110, v111
  v_accvgpr_write_b32 a79, v120
  v_fma_f32 v118, v116, v107, v114
  v_fma_f32 v119, v116, v107, v115
  v_mov_b32 v109, v118
  v_cos_f32 v110, v109
  v_sin_f32 v111, v109
  s_nop 0
  v_cvt_pk_bf16_f32 v120, v110, v111
  v_accvgpr_write_b32 a92, v120
  v_add_f32 v109, v107, v119
  v_cos_f32 v110, v109
  v_sin_f32 v111, v109
  s_nop 0
  v_cvt_pk_bf16_f32 v120, v110, v111
  v_accvgpr_write_b32 a93, v120
  v_fmamk_f32 v109, v107, 0x40000000, v118
  v_cos_f32 v110, v109
  v_sin_f32 v111, v109
  s_nop 0
  v_cvt_pk_bf16_f32 v120, v110, v111
  v_accvgpr_write_b32 a94, v120
  v_fmamk_f32 v109, v107, 0x40400000, v119
  v_cos_f32 v110, v109
  v_sin_f32 v111, v109
  s_nop 0
  v_cvt_pk_bf16_f32 v120, v110, v111
  v_accvgpr_write_b32 a95, v120
fa_kernel_k2x:
  s_cmp_lg_u32 s96, 0
  s_cbranch_scc1 fa_kernel_pe4
  v_mbcnt_lo_u32_b32 v251, -1, 0
  v_lshlrev_b32 v251, 7, v251
  s_mov_b32 s3, 131072
  s_mov_b64 exec, 0xffffffff
  s_mov_b32 s80, 0x40000
fa_kernel_pl2:
  buffer_load_dword v250, v251, s[76:79], s3 offen sc1
  s_waitcnt vmcnt(0)
  v_cmp_gt_u32 vcc, 8, v250
  s_cbranch_vccz fa_kernel_pd3
  s_sub_u32 s80, s80, 1
  s_cmp_lg_u32 s80, 0
  s_cbranch_scc1 fa_kernel_pl2
fa_kernel_pd3:
  s_mov_b64 exec, -1
fa_kernel_pe4:
  s_barrier
  s_cmp_eq_u32 s97, 0
  s_cbranch_scc1 fa_kernel_p0
fa_kernel_k2l:
  buffer_load_dwordx4 v[24:27], v6, s[12:15], s28 offen offset:0 sc1
  buffer_load_dwordx4 v[28:31], v6, s[12:15], s28 offen offset:1024 sc1
  buffer_load_dwordx4 v[32:35], v6, s[12:15], s28 offen offset:2048 sc1
  buffer_load_dwordx4 v[36:39], v6, s[12:15], s28 offen offset:3072 sc1
  s_waitcnt vmcnt(0)
  ds_write_b128 v249, v[24:27] offset:0
  v_xor_b32 v41, 64, v249
  ds_write_b128 v41, v[28:31] offset:1024
  v_xor_b32 v42, 128, v249
  ds_write_b128 v42, v[32:35] offset:2048
  v_xor_b32 v43, 192, v249
  ds_write_b128 v43, v[36:39] offset:3072
  v_xor_b32 v249, 128, v5
  s_waitcnt lgkmcnt(0)
  s_barrier
  ds_read_b128 v[24:27], v5 offset:0
  ds_read_b128 v[28:31], v249 offset:0
  ds_read_b128 v[32:35], v5 offset:4096
  ds_read_b128 v[36:39], v249 offset:4096
  ds_read_b128 v[40:43], v5 offset:8192
  ds_read_b128 v[44:47], v249 offset:8192
  ds_read_b128 v[48:51], v5 offset:12288
  ds_read_b128 v[52:55], v249 offset:12288
  s_waitcnt lgkmcnt(6)
  v_mfma_f32_16x16x32_bf16 v[136:139], v[24:27], a[0:3], 0
  v_mfma_f32_16x16x32_bf16 v[8:11], v[24:27], a[16:19], 0
  v_mfma_f32_16x16x32_bf16 v[136:139], v[28:31], a[4:7], v[136:139]
  v_mfma_f32_16x16x32_bf16 v[8:11], v[28:31], a[20:23], v[8:11]
  s_waitcnt lgkmcnt(4)
  v_mfma_f32_16x16x32_bf16 v[140:143], v[32:35], a[0:3], 0
  v_mfma_f32_16x16x32_bf16 v[12:15], v[32:35], a[16:19], 0
  v_mfma_f32_16x16x32_bf16 v[140:143], v[36:39], a[4:7], v[140:143]
  v_mfma_f32_16x16x32_bf16 v[12:15], v[36:39], a[20:23], v[12:15]
  s_waitcnt lgkmcnt(2)
  v_mfma_f32_16x16x32_bf16 v[144:147], v[40:43], a[8:11], 0
  v_mfma_f32_16x16x32_bf16 v[16:19], v[40:43], a[24:27], 0
  v_mfma_f32_16x16x32_bf16 v[144:147], v[44:47], a[12:15], v[144:147]
  v_mfma_f32_16x16x32_bf16 v[16:19], v[44:47], a[28:31], v[16:19]
  s_waitcnt lgkmcnt(0)
  v_mfma_f32_16x16x32_bf16 v[148:151], v[48:51], a[8:11], 0
  v_mfma_f32_16x16x32_bf16 v[20:23], v[48:51], a[24:27], 0
  v_mfma_f32_16x16x32_bf16 v[148:151], v[52:55], a[12:15], v[148:151]
  v_mfma_f32_16x16x32_bf16 v[20:23], v[52:55], a[28:31], v[20:23]
  s_nop 1
  v_pk_add_f32 v[144:145], v[136:137], v[144:145] neg_lo:[0,1] neg_hi:[0,1]
  v_pk_add_f32 v[146:147], v[138:139], v[146:147] neg_lo:[0,1] neg_hi:[0,1]
  v_pk_fma_f32 v[136:137], v[136:137], 2.0, v[144:145] op_sel_hi:[1,0,1] neg_lo:[0,0,1] neg_hi:[0,0,1]
  v_pk_fma_f32 v[138:139], v[138:139], 2.0, v[146:147] op_sel_hi:[1,0,1] neg_lo:[0,0,1] neg_hi:[0,0,1]
  v_pk_add_f32 v[16:17], v[8:9], v[16:17] neg_lo:[0,1] neg_hi:[0,1]
  v_pk_add_f32 v[18:19], v[10:11], v[18:19] neg_lo:[0,1] neg_hi:[0,1]
  v_pk_fma_f32 v[8:9], v[8:9], 2.0, v[16:17] op_sel_hi:[1,0,1] neg_lo:[0,0,1] neg_hi:[0,0,1]
  v_pk_fma_f32 v[10:11], v[10:11], 2.0, v[18:19] op_sel_hi:[1,0,1] neg_lo:[0,0,1] neg_hi:[0,0,1]
  v_pk_add_f32 v[148:149], v[140:141], v[148:149] neg_lo:[0,1] neg_hi:[0,1]
  v_pk_add_f32 v[150:151], v[142:143], v[150:151] neg_lo:[0,1] neg_hi:[0,1]
  v_pk_fma_f32 v[140:141], v[140:141], 2.0, v[148:149] op_sel_hi:[1,0,1] neg_lo:[0,0,1] neg_hi:[0,0,1]
  v_pk_fma_f32 v[142:143], v[142:143], 2.0, v[150:151] op_sel_hi:[1,0,1] neg_lo:[0,0,1] neg_hi:[0,0,1]
  v_pk_add_f32 v[20:21], v[12:13], v[20:21] neg_lo:[0,1] neg_hi:[0,1]
  v_pk_add_f32 v[22:23], v[14:15], v[22:23] neg_lo:[0,1] neg_hi:[0,1]
  v_pk_fma_f32 v[12:13], v[12:13], 2.0, v[20:21] op_sel_hi:[1,0,1] neg_lo:[0,0,1] neg_hi:[0,0,1]
  v_pk_fma_f32 v[14:15], v[14:15], 2.0, v[22:23] op_sel_hi:[1,0,1] neg_lo:[0,0,1] neg_hi:[0,0,1]
  v_pk_mul_f32 v[100:101], v[136:137], v[184:185]
  v_pk_mul_f32 v[102:103], v[138:139], v[186:187]
  v_pk_fma_f32 v[100:101], v[8:9], v[200:201], v[100:101]
  v_pk_fma_f32 v[102:103], v[10:11], v[202:203], v[102:103]
  v_pk_mul_f32 v[8:9], v[8:9], v[184:185]
  v_pk_mul_f32 v[10:11], v[10:11], v[186:187]
  v_pk_fma_f32 v[8:9], v[136:137], v[200:201], v[8:9] neg_lo:[0,1,0] neg_hi:[0,1,0]
  v_pk_fma_f32 v[10:11], v[138:139], v[202:203], v[10:11] neg_lo:[0,1,0] neg_hi:[0,1,0]
  v_cvt_pk_bf16_f32 v72, v100, v8
  v_cvt_pk_bf16_f32 v73, v101, v9
  v_cvt_pk_bf16_f32 v74, v102, v10
  v_cvt_pk_bf16_f32 v75, v103, v11
  v_pk_mul_f32 v[100:101], v[140:141], v[188:189]
  v_pk_mul_f32 v[102:103], v[142:143], v[190:191]
  v_pk_fma_f32 v[100:101], v[12:13], v[204:205], v[100:101]
  v_pk_fma_f32 v[102:103], v[14:15], v[206:207], v[102:103]
  v_pk_mul_f32 v[12:13], v[12:13], v[188:189]
  v_pk_mul_f32 v[14:15], v[14:15], v[190:191]
  v_pk_fma_f32 v[12:13], v[140:141], v[204:205], v[12:13] neg_lo:[0,1,0] neg_hi:[0,1,0]
  v_pk_fma_f32 v[14:15], v[142:143], v[206:207], v[14:15] neg_lo:[0,1,0] neg_hi:[0,1,0]
  v_cvt_pk_bf16_f32 v76, v100, v12
  v_cvt_pk_bf16_f32 v77, v101, v13
  v_cvt_pk_bf16_f32 v78, v102, v14
  v_cvt_pk_bf16_f32 v79, v103, v15
  v_pk_mul_f32 v[100:101], v[144:145], v[192:193]
  v_pk_mul_f32 v[102:103], v[146:147], v[194:195]
  v_pk_fma_f32 v[100:101], v[16:17], v[208:209], v[100:101]
  v_pk_fma_f32 v[102:103], v[18:19], v[210:211], v[102:103]
  v_pk_mul_f32 v[16:17], v[16:17], v[192:193]
  v_pk_mul_f32 v[18:19], v[18:19], v[194:195]
  v_pk_fma_f32 v[16:17], v[144:145], v[208:209], v[16:17] neg_lo:[0,1,0] neg_hi:[0,1,0]
  v_pk_fma_f32 v[18:19], v[146:147], v[210:211], v[18:19] neg_lo:[0,1,0] neg_hi:[0,1,0]
  v_cvt_pk_bf16_f32 v80, v100, v16
  v_cvt_pk_bf16_f32 v81, v101, v17
  v_cvt_pk_bf16_f32 v82, v102, v18
  v_cvt_pk_bf16_f32 v83, v103, v19
  v_pk_mul_f32 v[100:101], v[148:149], v[196:197]
  v_pk_mul_f32 v[102:103], v[150:151], v[198:199]
  v_pk_fma_f32 v[100:101], v[20:21], v[212:213], v[100:101]
  v_pk_fma_f32 v[102:103], v[22:23], v[214:215], v[102:103]
  v_pk_mul_f32 v[20:21], v[20:21], v[196:197]
  v_pk_mul_f32 v[22:23], v[22:23], v[198:199]
  v_pk_fma_f32 v[20:21], v[148:149], v[212:213], v[20:21] neg_lo:[0,1,0] neg_hi:[0,1,0]
  v_pk_fma_f32 v[22:23], v[150:151], v[214:215], v[22:23] neg_lo:[0,1,0] neg_hi:[0,1,0]
  v_cvt_pk_bf16_f32 v84, v100, v20
  v_cvt_pk_bf16_f32 v85, v101, v21
  v_cvt_pk_bf16_f32 v86, v102, v22
  v_cvt_pk_bf16_f32 v87, v103, v23
  v_mfma_f32_16x16x32_bf16 v[24:27], a[32:35], v[72:75], 0
  v_mfma_f32_16x16x32_bf16 v[40:43], a[48:51], v[72:75], 0
  v_mfma_f32_16x16x32_bf16 v[28:31], a[36:39], v[72:75], 0
  v_mfma_f32_16x16x32_bf16 v[44:47], a[52:55], v[72:75], 0
  v_mfma_f32_16x16x32_bf16 v[32:35], a[32:35], v[80:83], 0
  v_mfma_f32_16x16x32_bf16 v[48:51], a[48:51], v[80:83], 0
  v_mfma_f32_16x16x32_bf16 v[36:39], a[36:39], v[80:83], 0
  v_mfma_f32_16x16x32_bf16 v[52:55], a[52:55], v[80:83], 0
  v_mfma_f32_16x16x32_bf16 v[24:27], a[40:43], v[76:79], v[24:27]
  v_mfma_f32_16x16x32_bf16 v[40:43], a[56:59], v[76:79], v[40:43]
  v_mfma_f32_16x16x32_bf16 v[28:31], a[44:47], v[76:79], v[28:31]
  v_mfma_f32_16x16x32_bf16 v[44:47], a[60:63], v[76:79], v[44:47]
  v_mfma_f32_16x16x32_bf16 v[32:35], a[40:43], v[84:87], v[32:35]
  v_mfma_f32_16x16x32_bf16 v[48:51], a[56:59], v[84:87], v[48:51]
  v_mfma_f32_16x16x32_bf16 v[36:39], a[44:47], v[84:87], v[36:39]
  v_mfma_f32_16x16x32_bf16 v[52:55], a[60:63], v[84:87], v[52:55]
  s_waitcnt vmcnt(63)
  v_lshlrev_b32 v184, 16, v56
  v_and_b32 v200, 0xffff0000, v56
  v_lshlrev_b32 v185, 16, v57
  v_and_b32 v201, 0xffff0000, v57
  v_lshlrev_b32 v186, 16, v58
  v_and_b32 v202, 0xffff0000, v58
  v_lshlrev_b32 v187, 16, v59
  v_and_b32 v203, 0xffff0000, v59
  v_lshlrev_b32 v188, 16, v60
  v_and_b32 v204, 0xffff0000, v60
  v_lshlrev_b32 v189, 16, v61
  v_and_b32 v205, 0xffff0000, v61
  v_lshlrev_b32 v190, 16, v62
  v_and_b32 v206, 0xffff0000, v62
  v_lshlrev_b32 v191, 16, v63
  v_and_b32 v207, 0xffff0000, v63
  v_lshlrev_b32 v192, 16, v64
  v_and_b32 v208, 0xffff0000, v64
  v_lshlrev_b32 v193, 16, v65
  v_and_b32 v209, 0xffff0000, v65
  v_lshlrev_b32 v194, 16, v66
  v_and_b32 v210, 0xffff0000, v66
  v_lshlrev_b32 v195, 16, v67
  v_and_b32 v211, 0xffff0000, v67
  v_lshlrev_b32 v196, 16, v68
  v_and_b32 v212, 0xffff0000, v68
  v_lshlrev_b32 v197, 16, v69
  v_and_b32 v213, 0xffff0000, v69
  v_lshlrev_b32 v198, 16, v70
  v_and_b32 v214, 0xffff0000, v70
  v_lshlrev_b32 v199, 16, v71
  v_and_b32 v215, 0xffff0000, v71
  v_pk_mul_f32 v[100:101], v[24:25], v[184:185]
  v_pk_mul_f32 v[102:103], v[26:27], v[186:187]
  v_pk_fma_f32 v[100:101], v[40:41], v[200:201], v[100:101] neg_lo:[0,1,0] neg_hi:[0,1,0]
  v_pk_fma_f32 v[102:103], v[42:43], v[202:203], v[102:103] neg_lo:[0,1,0] neg_hi:[0,1,0]
  v_pk_mul_f32 v[40:41], v[40:41], v[184:185]
  v_pk_mul_f32 v[42:43], v[42:43], v[186:187]
  v_pk_fma_f32 v[40:41], v[24:25], v[200:201], v[40:41]
  v_pk_fma_f32 v[42:43], v[26:27], v[202:203], v[42:43]
  v_cvt_pk_bf16_f32 v56, v100, -v40
  v_cvt_pk_bf16_f32 v57, v101, -v41
  v_cvt_pk_bf16_f32 v58, v102, -v42
  v_cvt_pk_bf16_f32 v59, v103, -v43
  v_pk_mul_f32 v[100:101], v[28:29], v[188:189]
  v_pk_mul_f32 v[102:103], v[30:31], v[190:191]
  v_pk_fma_f32 v[100:101], v[44:45], v[204:205], v[100:101] neg_lo:[0,1,0] neg_hi:[0,1,0]
  v_pk_fma_f32 v[102:103], v[46:47], v[206:207], v[102:103] neg_lo:[0,1,0] neg_hi:[0,1,0]
  v_pk_mul_f32 v[44:45], v[44:45], v[188:189]
  v_pk_mul_f32 v[46:47], v[46:47], v[190:191]
  v_pk_fma_f32 v[44:45], v[28:29], v[204:205], v[44:45]
  v_pk_fma_f32 v[46:47], v[30:31], v[206:207], v[46:47]
  v_cvt_pk_bf16_f32 v60, v100, -v44
  v_cvt_pk_bf16_f32 v61, v101, -v45
  v_cvt_pk_bf16_f32 v62, v102, -v46
  v_cvt_pk_bf16_f32 v63, v103, -v47
  v_pk_mul_f32 v[100:101], v[32:33], v[192:193]
  v_pk_mul_f32 v[102:103], v[34:35], v[194:195]
  v_pk_fma_f32 v[100:101], v[48:49], v[208:209], v[100:101] neg_lo:[0,1,0] neg_hi:[0,1,0]
  v_pk_fma_f32 v[102:103], v[50:51], v[210:211], v[102:103] neg_lo:[0,1,0] neg_hi:[0,1,0]
  v_pk_mul_f32 v[48:49], v[48:49], v[192:193]
  v_pk_mul_f32 v[50:51], v[50:51], v[194:195]
  v_pk_fma_f32 v[48:49], v[32:33], v[208:209], v[48:49]
  v_pk_fma_f32 v[50:51], v[34:35], v[210:211], v[50:51]
  v_cvt_pk_bf16_f32 v64, v100, -v48
  v_cvt_pk_bf16_f32 v65, v101, -v49
  v_cvt_pk_bf16_f32 v66, v102, -v50
  v_cvt_pk_bf16_f32 v67, v103, -v51
  v_pk_mul_f32 v[100:101], v[36:37], v[196:197]
  v_pk_mul_f32 v[102:103], v[38:39], v[198:199]
  v_pk_fma_f32 v[100:101], v[52:53], v[212:213], v[100:101] neg_lo:[0,1,0] neg_hi:[0,1,0]
  v_pk_fma_f32 v[102:103], v[54:55], v[214:215], v[102:103] neg_lo:[0,1,0] neg_hi:[0,1,0]
  v_pk_mul_f32 v[52:53], v[52:53], v[196:197]
  v_pk_mul_f32 v[54:55], v[54:55], v[198:199]
  v_pk_fma_f32 v[52:53], v[36:37], v[212:213], v[52:53]
  v_pk_fma_f32 v[54:55], v[38:39], v[214:215], v[54:55]
  v_cvt_pk_bf16_f32 v68, v100, -v52
  v_cvt_pk_bf16_f32 v69, v101, -v53
  v_cvt_pk_bf16_f32 v70, v102, -v54
  v_cvt_pk_bf16_f32 v71, v103, -v55
  v_mfma_f32_16x16x32_bf16 v[136:139], v[56:59], a[32:35], 0
  v_mfma_f32_16x16x32_bf16 v[8:11], v[56:59], a[48:51], 0
  v_mfma_f32_16x16x32_bf16 v[140:143], v[56:59], a[36:39], 0
  v_mfma_f32_16x16x32_bf16 v[12:15], v[56:59], a[52:55], 0
  v_mfma_f32_16x16x32_bf16 v[144:147], v[64:67], a[32:35], 0
  v_mfma_f32_16x16x32_bf16 v[16:19], v[64:67], a[48:51], 0
  v_mfma_f32_16x16x32_bf16 v[148:151], v[64:67], a[36:39], 0
  v_mfma_f32_16x16x32_bf16 v[20:23], v[64:67], a[52:55], 0
  v_mfma_f32_16x16x32_bf16 v[136:139], v[60:63], a[40:43], v[136:139]
  v_mfma_f32_16x16x32_bf16 v[8:11], v[60:63], a[56:59], v[8:11]
  v_mfma_f32_16x16x32_bf16 v[140:143], v[60:63], a[44:47], v[140:143]
  v_mfma_f32_16x16x32_bf16 v[12:15], v[60:63], a[60:63], v[12:15]
  v_mfma_f32_16x16x32_bf16 v[144:147], v[68:71], a[40:43], v[144:147]
  v_mfma_f32_16x16x32_bf16 v[16:19], v[68:71], a[56:59], v[16:19]
  v_mfma_f32_16x16x32_bf16 v[148:151], v[68:71], a[44:47], v[148:151]
  v_mfma_f32_16x16x32_bf16 v[20:23], v[68:71], a[60:63], v[20:23]
  s_nop 0
  v_pk_mul_f32 v[184:185], v[136:137], v[216:217]
  v_pk_mul_f32 v[186:187], v[138:139], v[218:219]
  v_pk_fma_f32 v[184:185], v[8:9], v[232:233], v[184:185]
  v_pk_fma_f32 v[186:187], v[10:11], v[234:235], v[186:187]
  v_pk_mul_f32 v[8:9], v[8:9], v[216:217]
  v_pk_mul_f32 v[10:11], v[10:11], v[218:219]
  v_pk_fma_f32 v[8:9], v[136:137], v[232:233], v[8:9] neg_lo:[0,1,0] neg_hi:[0,1,0]
  v_pk_fma_f32 v[10:11], v[138:139], v[234:235], v[10:11] neg_lo:[0,1,0] neg_hi:[0,1,0]
  v_pk_mul_f32 v[188:189], v[144:145], v[224:225]
  v_pk_mul_f32 v[190:191], v[146:147], v[226:227]
  v_pk_fma_f32 v[188:189], v[16:17], v[240:241], v[188:189]
  v_pk_fma_f32 v[190:191], v[18:19], v[242:243], v[190:191]
  v_pk_mul_f32 v[16:17], v[16:17], v[224:225]
  v_pk_mul_f32 v[18:19], v[18:19], v[226:227]
  v_pk_fma_f32 v[16:17], v[144:145], v[240:241], v[16:17] neg_lo:[0,1,0] neg_hi:[0,1,0]
  v_pk_fma_f32 v[18:19], v[146:147], v[242:243], v[18:19] neg_lo:[0,1,0] neg_hi:[0,1,0]
  v_pk_add_f32 v[200:201], v[184:185], v[188:189] neg_lo:[0,1] neg_hi:[0,1]
  v_pk_add_f32 v[204:205], v[8:9], v[16:17] neg_lo:[0,1] neg_hi:[0,1]
  v_pk_add_f32 v[202:203], v[186:187], v[190:191] neg_lo:[0,1] neg_hi:[0,1]
  v_pk_add_f32 v[206:207], v[10:11], v[18:19] neg_lo:[0,1] neg_hi:[0,1]
  v_cvt_pk_bf16_f32 v80, v200, v204
  v_cvt_pk_bf16_f32 v81, v201, v205
  v_cvt_pk_bf16_f32 v82, v202, v206
  v_cvt_pk_bf16_f32 v83, v203, v207
  ds_write_b128 v7, v[80:83] offset:0
  v_pk_add_f32 v[184:185], v[184:185], v[188:189]
  v_pk_add_f32 v[8:9], v[8:9], v[16:17]
  v_pk_add_f32 v[186:187], v[186:187], v[190:191]
  v_pk_add_f32 v[10:11], v[10:11], v[18:19]
  v_cvt_pk_bf16_f32 v72, v184, v8
  v_cvt_pk_bf16_f32 v73, v185, v9
  v_cvt_pk_bf16_f32 v74, v186, v10
  v_cvt_pk_bf16_f32 v75, v187, v11
  v_pk_mul_f32 v[184:185], v[140:141], v[220:221]
  v_pk_mul_f32 v[186:187], v[142:143], v[222:223]
  v_pk_fma_f32 v[184:185], v[12:13], v[236:237], v[184:185]
  v_pk_fma_f32 v[186:187], v[14:15], v[238:239], v[186:187]
  v_pk_mul_f32 v[12:13], v[12:13], v[220:221]
  v_pk_mul_f32 v[14:15], v[14:15], v[222:223]
  v_pk_fma_f32 v[12:13], v[140:141], v[236:237], v[12:13] neg_lo:[0,1,0] neg_hi:[0,1,0]
  v_pk_fma_f32 v[14:15], v[142:143], v[238:239], v[14:15] neg_lo:[0,1,0] neg_hi:[0,1,0]
  v_pk_mul_f32 v[188:189], v[148:149], v[228:229]
  v_pk_mul_f32 v[190:191], v[150:151], v[230:231]
  v_pk_fma_f32 v[188:189], v[20:21], v[244:245], v[188:189]
  v_pk_fma_f32 v[190:191], v[22:23], v[246:247], v[190:191]
  v_pk_mul_f32 v[20:21], v[20:21], v[228:229]
  v_pk_mul_f32 v[22:23], v[22:23], v[230:231]
  v_pk_fma_f32 v[20:21], v[148:149], v[244:245], v[20:21] neg_lo:[0,1,0] neg_hi:[0,1,0]
  v_pk_fma_f32 v[22:23], v[150:151], v[246:247], v[22:23] neg_lo:[0,1,0] neg_hi:[0,1,0]
  v_pk_add_f32 v[200:201], v[184:185], v[188:189] neg_lo:[0,1] neg_hi:[0,1]
  v_pk_add_f32 v[204:205], v[12:13], v[20:21] neg_lo:[0,1] neg_hi:[0,1]
  v_pk_add_f32 v[202:203], v[186:187], v[190:191] neg_lo:[0,1] neg_hi:[0,1]
  v_pk_add_f32 v[206:207], v[14:15], v[22:23] neg_lo:[0,1] neg_hi:[0,1]
  v_cvt_pk_bf16_f32 v84, v200, v204
  v_cvt_pk_bf16_f32 v85, v201, v205
  v_cvt_pk_bf16_f32 v86, v202, v206
  v_cvt_pk_bf16_f32 v87, v203, v207
  ds_write_b128 v7, v[84:87] offset:1024
  v_pk_add_f32 v[184:185], v[184:185], v[188:189]
  v_pk_add_f32 v[12:13], v[12:13], v[20:21]
  v_pk_add_f32 v[186:187], v[186:187], v[190:191]
  v_pk_add_f32 v[14:15], v[14:15], v[22:23]
  v_cvt_pk_bf16_f32 v76, v184, v12
  v_cvt_pk_bf16_f32 v77, v185, v13
  v_cvt_pk_bf16_f32 v78, v186, v14
  v_cvt_pk_bf16_f32 v79, v187, v15
  v_xor_b32 v7, 0x800, v7
  s_waitcnt lgkmcnt(0)
  s_barrier
  ds_read_b128 v[88:91], v7 offset:0
  ds_read_b128 v[92:95], v7 offset:1024
  v_mfma_f32_16x16x32_bf16 v[24:27], a[64:67], v[72:75], 0
  v_mfma_f32_16x16x32_bf16 v[28:31], a[68:71], v[72:75], 0
  v_mfma_f32_16x16x32_bf16 v[32:35], a[72:75], v[72:75], 0
  v_mfma_f32_16x16x32_bf16 v[36:39], a[76:79], v[72:75], 0
  v_mfma_f32_16x16x32_bf16 v[40:43], a[64:67], v[76:79], 0
  v_mfma_f32_16x16x32_bf16 v[44:47], a[68:71], v[76:79], 0
  v_mfma_f32_16x16x32_bf16 v[48:51], a[72:75], v[76:79], 0
  v_mfma_f32_16x16x32_bf16 v[52:55], a[76:79], v[76:79], 0
  s_waitcnt lgkmcnt(0)
  v_mfma_f32_16x16x32_bf16 v[24:27], a[80:83], v[88:91], v[24:27]
  v_mfma_f32_16x16x32_bf16 v[28:31], a[84:87], v[88:91], v[28:31]
  v_mfma_f32_16x16x32_bf16 v[32:35], a[88:91], v[88:91], v[32:35]
  v_mfma_f32_16x16x32_bf16 v[36:39], a[92:95], v[88:91], v[36:39]
  v_mfma_f32_16x16x32_bf16 v[40:43], a[80:83], v[92:95], v[40:43]
  v_mfma_f32_16x16x32_bf16 v[44:47], a[84:87], v[92:95], v[44:47]
  v_mfma_f32_16x16x32_bf16 v[48:51], a[88:91], v[92:95], v[48:51]
  v_mfma_f32_16x16x32_bf16 v[52:55], a[92:95], v[92:95], v[52:55]
  s_nop 0
  v_cvt_pk_bf16_f32 v104, v24, v25
  v_cvt_pk_bf16_f32 v105, v26, v27
  v_cvt_pk_bf16_f32 v106, v28, v29
  v_cvt_pk_bf16_f32 v107, v30, v31
  buffer_store_dwordx4 v[104:107], v248, s[8:11], s26 offen offset:0 sc1
  v_cvt_pk_bf16_f32 v108, v32, v33
  v_cvt_pk_bf16_f32 v109, v34, v35
  v_cvt_pk_bf16_f32 v110, v36, v37
  v_cvt_pk_bf16_f32 v111, v38, v39
  buffer_store_dwordx4 v[108:111], v248, s[8:11], s26 offen offset:64 sc1
  v_cvt_pk_bf16_f32 v112, v40, v41
  v_cvt_pk_bf16_f32 v113, v42, v43
  v_cvt_pk_bf16_f32 v114, v44, v45
  v_cvt_pk_bf16_f32 v115, v46, v47
  buffer_store_dwordx4 v[112:115], v248, s[8:11], s26 offen offset:2048 sc1
  v_cvt_pk_bf16_f32 v116, v48, v49
  v_cvt_pk_bf16_f32 v117, v50, v51
  v_cvt_pk_bf16_f32 v118, v52, v53
  v_cvt_pk_bf16_f32 v119, v54, v55
  buffer_store_dwordx4 v[116:119], v248, s[8:11], s26 offen offset:2112 sc1
  s_waitcnt vmcnt(0)
  s_barrier
  s_add_u32 s76, s92, 0x7000000
  s_addc_u32 s77, s93, 0
  s_mov_b32 s78, 0x28000
  s_mov_b32 s79, 0x00020000
  s_cmp_lg_u32 s96, 0
  s_cbranch_scc1 fa_kernel_pub5
  s_and_b32 s3, s20, 31
  s_lshl_b32 s3, s3, 7
  s_add_u32 s3, s3, 98304
  v_mov_b32 v250, 1
  v_mov_b32 v251, 0
  s_mov_b64 exec, 1
  buffer_atomic_add v250, v251, s[76:79], s3 offen sc1
  s_mov_b64 exec, -1
fa_kernel_pub5:
  v_mbcnt_lo_u32_b32 v1, -1, 0
  v_mbcnt_hi_u32_b32 v1, -1, v1
  s_lshl_b32 s3, s96, 6
  v_add_u32 v0, s3, v1
  v_and_b32 v2, 15, v1
  v_lshrrev_b32 v3, 4, v1
  s_mov_b32 s21, s96
  s_lshl_b32 s20, s54, 5
  s_add_u32 s20, s20, s55
  s_and_b32 s22, s20, 3
  s_lshl_b32 s22, s22, 2
  s_add_u32 s22, s22, s21
  s_lshl_b32 s22, s22, 6
  s_lshr_b32 s23, s20, 2
  s_add_u32 s22, s22, s23
  v_lshrrev_b32 v16, 1, v0
  v_and_b32 v17, 1, v0
  v_lshlrev_b32 v6, 13, v16
  v_lshl_add_u32 v6, v17, 4, v6
  v_sub_u32 v18, 0x400, v16
  v_cmp_eq_u32 vcc, 1, v17
  s_nop 1
  v_cndmask_b32 v16, v16, v18, vcc
  v_mov_b32 v18, 1
  v_cndmask_b32 v17, v18, -1, vcc
  v_and_b32 v18, 31, v16
  v_bfe_u32 v19, v16, 5, 2
  v_lshlrev_b32 v19, 2, v19
  v_lshl_add_u32 v19, v18, 7, v19
  v_bfe_u32 v18, v16, 1, 3
  v_lshrrev_b32 v16, 7, v16
  v_xor_b32 v10, v16, v18
  v_and_b32 v10, 7, v10
  v_lshl_add_u32 v10, v10, 4, v19
  v_add_u32 v16, v16, v17
  v_xor_b32 v11, v16, v18
  v_and_b32 v11, 7, v11
  v_lshl_add_u32 v11, v11, 4, v19
  v_add_u32 v16, v16, v17
  v_xor_b32 v12, v16, v18
  v_and_b32 v12, 7, v12
  v_lshl_add_u32 v12, v12, 4, v19
  v_add_u32 v16, v16, v17
  v_xor_b32 v13, v16, v18
  v_and_b32 v13, 7, v13
  v_lshl_add_u32 v13, v13, 4, v19
  v_add_u32 v16, v16, v17
  v_xor_b32 v14, v16, v18
  v_and_b32 v14, 7, v14
  v_lshl_add_u32 v14, v14, 4, v19
  v_cmp_gt_u32 vcc, 2, v0
  s_nop 1
  v_cndmask_b32 v10, v10, v14, vcc
  s_add_u32 s8, s92, 0x6000000
  s_addc_u32 s9, s93, 0
  s_cmp_eq_u32 s97, 0
  s_cselect_b32 s8, s94, s8
  s_cselect_b32 s9, s95, s9
  s_mov_b32 s10, 0x800000
  s_cselect_b32 s10, 0x400000, s10
  s_mov_b32 s11, 0x00020000
  s_add_u32 s12, s92, 0x1800000
  s_addc_u32 s13, s93, 0
  s_mov_b32 s14, 0x400000
  s_mov_b32 s15, 0x00020000
  s_mov_b32 s16, s92
  s_mov_b32 s17, s93
  s_mov_b32 s18, 0x800000
  s_mov_b32 s19, 0x00020000
  v_lshrrev_b32 v16, 2, v2
  v_and_b32 v17, 3, v2
  v_lshl_add_u32 v16, v16, 3, v17
  v_lshlrev_b32 v5, 6, v16
  v_lshl_add_u32 v5, v3, 4, v5
  s_lshl_b32 s24, s22, 11
  s_add_u32 s25, s24, 0x200000
  buffer_load_dwordx4 v[44:47], v5, s[8:11], s24 offen offset:0 sc1
  buffer_load_dwordx4 v[48:51], v5, s[8:11], s24 offen offset:256 sc1
  buffer_load_dwordx4 v[52:55], v5, s[8:11], s25 offen offset:0 sc1
  buffer_load_dwordx4 v[56:59], v5, s[8:11], s25 offen offset:256 sc1
  s_add_u32 s24, s24, 0x400000
  buffer_load_dwordx4 v[172:175], v5, s[8:11], s24 offen offset:0 sc1
  buffer_load_dwordx4 v[176:179], v5, s[8:11], s24 offen offset:256 sc1
  s_add_u32 s25, s25, 0x400000
  buffer_load_dwordx4 v[180:183], v5, s[8:11], s25 offen offset:0 sc1
  buffer_load_dwordx4 v[184:187], v5, s[8:11], s25 offen offset:256 sc1
  v_cvt_f32_u32 v23, v16
  v_lshrrev_b32 v16, 1, v2
  v_xor_b32 v16, v16, v3
  v_lshlrev_b32 v16, 4, v16
  v_lshl_add_u32 v8, v2, 7, v16
  s_lshl_b32 s23, s21, 12
  v_add_u32 v8, s23, v8
  v_xor_b32 v9, 64, v8
  v_add_u32 v8, 114688, v8
  v_add_u32 v9, 114688, v9
  v_add_u32 v10, 114688, v10
  v_add_u32 v11, 114688, v11
  v_add_u32 v12, 114688, v12
  v_add_u32 v13, 114688, v13
  v_add_u32 v14, 114688, v14
  v_cvt_f32_u32 v17, v3
  v_mul_f32 v17, 4.0, v17
  s_lshr_b32 s28, s20, 5
  s_lshl_b32 s28, s28, 19
  s_bfe_u32 s29, s20, 0x40001
  s_lshl_b32 s29, s29, 10
  s_add_u32 s28, s28, s29
  s_and_b32 s29, s20, 1
  s_lshl_b32 s29, s29, 7
  s_add_u32 s28, s28, s29
  v_add_f32 v18, 0x0, v23
  v_mul_f32 v18, 0x3d000000, v18
  v_mul_f32 v19, v17, v18
  v_mov_b32 v20, v19
  v_cos_f32 v21, v20
  v_sin_f32 v22, v20
  v_mul_f32 v108, 0x3d000000, v20
  v_cvt_pk_bf16_f32 v60, v21, -v22
  v_cvt_pk_bf16_f32 v76, v22, v21
  v_add_f32 v20, v18, v19
  v_cos_f32 v21, v20
  v_sin_f32 v22, v20
  v_mul_f32 v109, 0x3d000000, v20
  v_cvt_pk_bf16_f32 v61, v21, -v22
  v_cvt_pk_bf16_f32 v77, v22, v21
  v_fmamk_f32 v20, v18, 0x40000000, v19
  v_cos_f32 v21, v20
  v_sin_f32 v22, v20
  v_mul_f32 v110, 0x3d000000, v20
  v_cvt_pk_bf16_f32 v62, v21, -v22
  v_cvt_pk_bf16_f32 v78, v22, v21
  v_fmamk_f32 v20, v18, 0x40400000, v19
  v_cos_f32 v21, v20
  v_sin_f32 v22, v20
  v_mul_f32 v111, 0x3d000000, v20
  v_cvt_pk_bf16_f32 v63, v21, -v22
  v_cvt_pk_bf16_f32 v79, v22, v21
  v_fmamk_f32 v20, v18, 0x41800000, v19
  v_cos_f32 v21, v20
  v_sin_f32 v22, v20
  v_mul_f32 v116, 0x3d000000, v20
  v_cvt_pk_bf16_f32 v68, v21, -v22
  v_cvt_pk_bf16_f32 v84, v22, v21
  v_fmamk_f32 v20, v18, 0x41880000, v19
  v_cos_f32 v21, v20
  v_sin_f32 v22, v20
  v_mul_f32 v117, 0x3d000000, v20
  v_cvt_pk_bf16_f32 v69, v21, -v22
  v_cvt_pk_bf16_f32 v85, v22, v21
  v_fmamk_f32 v20, v18, 0x41900000, v19
  v_cos_f32 v21, v20
  v_sin_f32 v22, v20
  v_mul_f32 v118, 0x3d000000, v20
  v_cvt_pk_bf16_f32 v70, v21, -v22
  v_cvt_pk_bf16_f32 v86, v22, v21
  v_fmamk_f32 v20, v18, 0x41980000, v19
  v_cos_f32 v21, v20
  v_sin_f32 v22, v20
  v_mul_f32 v119, 0x3d000000, v20
  v_cvt_pk_bf16_f32 v71, v21, -v22
  v_cvt_pk_bf16_f32 v87, v22, v21
  v_add_f32 v18, 0x40800000, v23
  v_mul_f32 v18, 0x3d000000, v18
  v_mul_f32 v19, v17, v18
  v_mov_b32 v20, v19
  v_cos_f32 v21, v20
  v_sin_f32 v22, v20
  v_mul_f32 v112, 0x3d000000, v20
  v_cvt_pk_bf16_f32 v64, v21, -v22
  v_cvt_pk_bf16_f32 v80, v22, v21
  v_add_f32 v20, v18, v19
  v_cos_f32 v21, v20
  v_sin_f32 v22, v20
  v_mul_f32 v113, 0x3d000000, v20
  v_cvt_pk_bf16_f32 v65, v21, -v22
  v_cvt_pk_bf16_f32 v81, v22, v21
  v_fmamk_f32 v20, v18, 0x40000000, v19
  v_cos_f32 v21, v20
  v_sin_f32 v22, v20
  v_mul_f32 v114, 0x3d000000, v20
  v_cvt_pk_bf16_f32 v66, v21, -v22
  v_cvt_pk_bf16_f32 v82, v22, v21
  v_fmamk_f32 v20, v18, 0x40400000, v19
  v_cos_f32 v21, v20
  v_sin_f32 v22, v20
  v_mul_f32 v115, 0x3d000000, v20
  v_cvt_pk_bf16_f32 v67, v21, -v22
  v_cvt_pk_bf16_f32 v83, v22, v21
  v_fmamk_f32 v20, v18, 0x41800000, v19
  v_cos_f32 v21, v20
  v_sin_f32 v22, v20
  v_mul_f32 v120, 0x3d000000, v20
  v_cvt_pk_bf16_f32 v72, v21, -v22
  v_cvt_pk_bf16_f32 v88, v22, v21
  v_fmamk_f32 v20, v18, 0x41880000, v19
  v_cos_f32 v21, v20
  v_sin_f32 v22, v20
  v_mul_f32 v121, 0x3d000000, v20
  v_cvt_pk_bf16_f32 v73, v21, -v22
  v_cvt_pk_bf16_f32 v89, v22, v21
  v_fmamk_f32 v20, v18, 0x41900000, v19
  v_cos_f32 v21, v20
  v_sin_f32 v22, v20
  v_mul_f32 v122, 0x3d000000, v20
  v_cvt_pk_bf16_f32 v74, v21, -v22
  v_cvt_pk_bf16_f32 v90, v22, v21
  v_fmamk_f32 v20, v18, 0x41980000, v19
  v_cos_f32 v21, v20
  v_sin_f32 v22, v20
  v_mul_f32 v123, 0x3d000000, v20
  v_cvt_pk_bf16_f32 v75, v21, -v22
  v_cvt_pk_bf16_f32 v91, v22, v21
  v_lshrrev_b32 v16, 2, v2
  v_and_b32 v17, 3, v2
  v_lshl_add_u32 v16, v16, 3, v17
  v_lshlrev_b32 v188, 9, v16
  v_lshl_add_u32 v188, v3, 7, v188
  s_lshl_b32 s3, s21, 1
  v_and_b32 v17, 7, v2
  v_xor_b32 v17, s3, v17
  v_lshl_add_u32 v188, v17, 4, v188
  v_add_u32 v188, 131072, v188
  v_xor_b32 v189, 16, v188
  v_bfe_u32 v17, v0, 5, 2
  v_and_b32 v18, 7, v0
  v_xor_b32 v17, v17, v18
  v_lshrrev_b32 v19, 3, v0
  v_lshlrev_b32 v190, 7, v19
  v_lshl_add_u32 v190, v17, 4, v190
  v_add_u32 v190, 131072, v190
  v_xor_b32 v191, 64, v190
  v_lshrrev_b32 v17, 5, v0
  v_and_b32 v19, 3, v19
  v_lshlrev_b32 v7, 14, v17
  v_lshl_add_u32 v7, v19, 8, v7
  v_lshl_add_u32 v7, v18, 4, v7
  v_mov_b32 v16, 0
  v_mov_b32 v17, 114688
  v_cmp_eq_u32 vcc, 0, v0
  s_nop 0
  s_and_saveexec_b64 s[26:27], vcc
  ds_write2st64_b32 v17, v16, v16 offset0:0 offset1:16
  ds_write2st64_b32 v17, v16, v16 offset0:32 offset1:48
  s_mov_b64 exec, s[26:27]
  s_lshl_b32 s24, s20, 5
  s_cmp_lg_u32 s96, 0
  s_cbranch_scc1 fa_kernel_pe8
  v_mbcnt_lo_u32_b32 v17, -1, 0
  v_lshlrev_b32 v17, 7, v17
  s_mov_b32 s3, 98304
  s_mov_b64 exec, 0xffffffff
  s_mov_b32 s80, 0x40000
fa_kernel_pl6:
  buffer_load_dword v16, v17, s[76:79], s3 offen sc1
  s_waitcnt vmcnt(0)
  v_cmp_gt_u32 vcc, 8, v16
  s_cbranch_vccz fa_kernel_pd7
  s_sub_u32 s80, s80, 1
  s_cmp_lg_u32 s80, 0
  s_cbranch_scc1 fa_kernel_pl6
fa_kernel_pd7:
  s_mov_b64 exec, -1
fa_kernel_pe8:
  s_barrier
  buffer_load_dwordx4 v[24:27], v6, s[12:15], s24 offen sc1
  s_add_u32 s24, s24, 0x100000
  buffer_load_dwordx4 v[28:31], v6, s[12:15], s24 offen sc1
  s_add_u32 s24, s24, 0x100000
  buffer_load_dwordx4 v[32:35], v6, s[12:15], s24 offen sc1
  s_add_u32 s24, s24, 0x100000
  buffer_load_dwordx4 v[36:39], v6, s[12:15], s24 offen sc1
  s_mov_b32 s60, s86
  s_mov_b32 s61, s87
  s_cmp_eq_u32 s97, 0
  s_cselect_b32 s62, 7340032, 0
  s_mov_b32 s63, 0x00020000
  v_lshlrev_b32 v252, 7, v1
  s_lshl_b32 s64, s20, 2
  s_add_u32 s64, s64, s96
  s_lshl_b32 s64, s64, 12
  s_add_u32 s64, s64, 0x400000
  s_mov_b64 exec, 0xffffffff
  buffer_load_dword v253, v252, s[60:63], s64 offen
  s_mov_b64 exec, -1
  v_cos_f32 v92, v108
  v_sin_f32 v108, v108
  v_cos_f32 v93, v109
  v_sin_f32 v109, v109
  v_cos_f32 v94, v110
  v_sin_f32 v110, v110
  v_cos_f32 v95, v111
  v_sin_f32 v111, v111
  v_cos_f32 v96, v112
  v_sin_f32 v112, v112
  v_cos_f32 v97, v113
  v_sin_f32 v113, v113
  v_cos_f32 v98, v114
  v_sin_f32 v114, v114
  v_cos_f32 v99, v115
  v_sin_f32 v115, v115
  v_cos_f32 v100, v116
  v_sin_f32 v116, v116
  v_cos_f32 v101, v117
  v_sin_f32 v117, v117
  v_cos_f32 v102, v118
  v_sin_f32 v118, v118
  v_cos_f32 v103, v119
  v_sin_f32 v119, v119
  v_cos_f32 v104, v120
  v_sin_f32 v120, v120
  v_cos_f32 v105, v121
  v_sin_f32 v121, v121
  v_cos_f32 v106, v122
  v_sin_f32 v122, v122
  v_cos_f32 v107, v123
  v_sin_f32 v123, v123
  s_waitcnt vmcnt(5)
  v_lshlrev_b32 v192, 16, v44
  v_and_b32 v193, 0xffff0000, v44
  v_lshlrev_b32 v16, 16, v172
  v_and_b32 v17, 0xffff0000, v172
  v_pk_add_f32 v[192:193], v[192:193], v[16:17]
  v_lshlrev_b32 v194, 16, v45
  v_and_b32 v195, 0xffff0000, v45
  v_lshlrev_b32 v16, 16, v173
  v_and_b32 v17, 0xffff0000, v173
  v_pk_add_f32 v[194:195], v[194:195], v[16:17]
  v_lshlrev_b32 v196, 16, v46
  v_and_b32 v197, 0xffff0000, v46
  v_lshlrev_b32 v16, 16, v174
  v_and_b32 v17, 0xffff0000, v174
  v_pk_add_f32 v[196:197], v[196:197], v[16:17]
  v_lshlrev_b32 v198, 16, v47
  v_and_b32 v199, 0xffff0000, v47
  v_lshlrev_b32 v16, 16, v175
  v_and_b32 v17, 0xffff0000, v175
  v_pk_add_f32 v[198:199], v[198:199], v[16:17]
  v_lshlrev_b32 v200, 16, v48
  v_and_b32 v201, 0xffff0000, v48
  v_lshlrev_b32 v16, 16, v176
  v_and_b32 v17, 0xffff0000, v176
  v_pk_add_f32 v[200:201], v[200:201], v[16:17]
  v_lshlrev_b32 v202, 16, v49
  v_and_b32 v203, 0xffff0000, v49
  v_lshlrev_b32 v16, 16, v177
  v_and_b32 v17, 0xffff0000, v177
  v_pk_add_f32 v[202:203], v[202:203], v[16:17]
  v_lshlrev_b32 v204, 16, v50
  v_and_b32 v205, 0xffff0000, v50
  v_lshlrev_b32 v16, 16, v178
  v_and_b32 v17, 0xffff0000, v178
  v_pk_add_f32 v[204:205], v[204:205], v[16:17]
  v_lshlrev_b32 v206, 16, v51
  v_and_b32 v207, 0xffff0000, v51
  v_lshlrev_b32 v16, 16, v179
  v_and_b32 v17, 0xffff0000, v179
  v_pk_add_f32 v[206:207], v[206:207], v[16:17]
  v_lshlrev_b32 v208, 16, v52
  v_and_b32 v209, 0xffff0000, v52
  v_lshlrev_b32 v16, 16, v180
  v_and_b32 v17, 0xffff0000, v180
  v_pk_add_f32 v[208:209], v[208:209], v[16:17]
  v_lshlrev_b32 v210, 16, v53
  v_and_b32 v211, 0xffff0000, v53
  v_lshlrev_b32 v16, 16, v181
  v_and_b32 v17, 0xffff0000, v181
  v_pk_add_f32 v[210:211], v[210:211], v[16:17]
  v_lshlrev_b32 v212, 16, v54
  v_and_b32 v213, 0xffff0000, v54
  v_lshlrev_b32 v16, 16, v182
  v_and_b32 v17, 0xffff0000, v182
  v_pk_add_f32 v[212:213], v[212:213], v[16:17]
  v_lshlrev_b32 v214, 16, v55
  v_and_b32 v215, 0xffff0000, v55
  v_lshlrev_b32 v16, 16, v183
  v_and_b32 v17, 0xffff0000, v183
  v_pk_add_f32 v[214:215], v[214:215], v[16:17]
  v_lshlrev_b32 v216, 16, v56
  v_and_b32 v217, 0xffff0000, v56
  v_lshlrev_b32 v16, 16, v184
  v_and_b32 v17, 0xffff0000, v184
  v_pk_add_f32 v[216:217], v[216:217], v[16:17]
  v_lshlrev_b32 v218, 16, v57
  v_and_b32 v219, 0xffff0000, v57
  v_lshlrev_b32 v16, 16, v185
  v_and_b32 v17, 0xffff0000, v185
  v_pk_add_f32 v[218:219], v[218:219], v[16:17]
  v_lshlrev_b32 v220, 16, v58
  v_and_b32 v221, 0xffff0000, v58
  v_lshlrev_b32 v16, 16, v186
  v_and_b32 v17, 0xffff0000, v186
  v_pk_add_f32 v[220:221], v[220:221], v[16:17]
  v_lshlrev_b32 v222, 16, v59
  v_and_b32 v223, 0xffff0000, v59
  v_lshlrev_b32 v16, 16, v187
  v_and_b32 v17, 0xffff0000, v187
  v_pk_add_f32 v[222:223], v[222:223], v[16:17]
  s_waitcnt vmcnt(4)
  ds_write2st64_b32 v10, v24, v25 offset0:0 offset1:16
  ds_write2st64_b32 v10, v26, v27 offset0:32 offset1:48
  s_waitcnt vmcnt(3)
  ds_write2st64_b32 v11, v28, v29 offset0:0 offset1:16
  ds_write2st64_b32 v11, v30, v31 offset0:32 offset1:48
  s_waitcnt vmcnt(2)
  ds_write2st64_b32 v12, v32, v33 offset0:0 offset1:16
  ds_write2st64_b32 v12, v34, v35 offset0:32 offset1:48
  s_waitcnt vmcnt(1)
  ds_write2st64_b32 v13, v36, v37 offset0:0 offset1:16
  ds_write2st64_b32 v13, v38, v39 offset0:32 offset1:48
  s_waitcnt lgkmcnt(0)
  s_barrier
  ds_read_b128 v[124:127], v8 offset:0
  ds_read_b128 v[128:131], v9 offset:0
  ds_read_b128 v[132:135], v8 offset:2048
  ds_read_b128 v[136:139], v9 offset:2048
  s_waitcnt lgkmcnt(2)
  v_mfma_f32_16x16x32_bf16 v[140:143], v[124:127], v[60:63], 0
  v_mfma_f32_16x16x32_bf16 v[156:159], v[124:127], v[76:79], 0
  v_mfma_f32_16x16x32_bf16 v[144:147], v[124:127], v[64:67], 0
  v_mfma_f32_16x16x32_bf16 v[160:163], v[124:127], v[80:83], 0
  v_mfma_f32_16x16x32_bf16 v[140:143], v[128:131], v[68:71], v[140:143]
  v_mfma_f32_16x16x32_bf16 v[156:159], v[128:131], v[84:87], v[156:159]
  v_mfma_f32_16x16x32_bf16 v[144:147], v[128:131], v[72:75], v[144:147]
  v_mfma_f32_16x16x32_bf16 v[160:163], v[128:131], v[88:91], v[160:163]
  s_waitcnt lgkmcnt(0)
  v_mfma_f32_16x16x32_bf16 v[148:151], v[132:135], v[60:63], 0
  v_mfma_f32_16x16x32_bf16 v[164:167], v[132:135], v[76:79], 0
  v_mfma_f32_16x16x32_bf16 v[152:155], v[132:135], v[64:67], 0
  v_mfma_f32_16x16x32_bf16 v[168:171], v[132:135], v[80:83], 0
  v_mfma_f32_16x16x32_bf16 v[148:151], v[136:139], v[68:71], v[148:151]
  v_mfma_f32_16x16x32_bf16 v[164:167], v[136:139], v[84:87], v[164:167]
  v_mfma_f32_16x16x32_bf16 v[152:155], v[136:139], v[72:75], v[152:155]
  v_mfma_f32_16x16x32_bf16 v[168:171], v[136:139], v[88:91], v[168:171]
  v_pk_mul_f32 v[16:17], v[140:141], v[92:93]
  v_pk_mul_f32 v[18:19], v[142:143], v[94:95]
  v_pk_fma_f32 v[16:17], v[156:157], v[108:109], v[16:17] neg_lo:[0,1,0] neg_hi:[0,1,0]
  v_pk_fma_f32 v[18:19], v[158:159], v[110:111], v[18:19] neg_lo:[0,1,0] neg_hi:[0,1,0]
  v_pk_mul_f32 v[156:157], v[156:157], v[92:93]
  v_pk_mul_f32 v[158:159], v[158:159], v[94:95]
  v_pk_fma_f32 v[156:157], v[140:141], v[108:109], v[156:157]
  v_pk_fma_f32 v[158:159], v[142:143], v[110:111], v[158:159]
  v_cvt_pk_bf16_f32 v24, v16, v156
  v_cvt_pk_bf16_f32 v25, v17, v157
  v_cvt_pk_bf16_f32 v26, v18, v158
  v_cvt_pk_bf16_f32 v27, v19, v159
  v_pk_mul_f32 v[16:17], v[144:145], v[96:97]
  v_pk_mul_f32 v[18:19], v[146:147], v[98:99]
  v_pk_fma_f32 v[16:17], v[160:161], v[112:113], v[16:17] neg_lo:[0,1,0] neg_hi:[0,1,0]
  v_pk_fma_f32 v[18:19], v[162:163], v[114:115], v[18:19] neg_lo:[0,1,0] neg_hi:[0,1,0]
  v_pk_mul_f32 v[160:161], v[160:161], v[96:97]
  v_pk_mul_f32 v[162:163], v[162:163], v[98:99]
  v_pk_fma_f32 v[160:161], v[144:145], v[112:113], v[160:161]
  v_pk_fma_f32 v[162:163], v[146:147], v[114:115], v[162:163]
  v_cvt_pk_bf16_f32 v32, v16, v160
  v_cvt_pk_bf16_f32 v33, v17, v161
  v_cvt_pk_bf16_f32 v34, v18, v162
  v_cvt_pk_bf16_f32 v35, v19, v163
  v_pk_mul_f32 v[16:17], v[148:149], v[100:101]
  v_pk_mul_f32 v[18:19], v[150:151], v[102:103]
  v_pk_fma_f32 v[16:17], v[164:165], v[116:117], v[16:17] neg_lo:[0,1,0] neg_hi:[0,1,0]
  v_pk_fma_f32 v[18:19], v[166:167], v[118:119], v[18:19] neg_lo:[0,1,0] neg_hi:[0,1,0]
  v_pk_mul_f32 v[164:165], v[164:165], v[100:101]
  v_pk_mul_f32 v[166:167], v[166:167], v[102:103]
  v_pk_fma_f32 v[164:165], v[148:149], v[116:117], v[164:165]
  v_pk_fma_f32 v[166:167], v[150:151], v[118:119], v[166:167]
  v_cvt_pk_bf16_f32 v28, v16, v164
  v_cvt_pk_bf16_f32 v29, v17, v165
  v_cvt_pk_bf16_f32 v30, v18, v166
  v_cvt_pk_bf16_f32 v31, v19, v167
  v_pk_mul_f32 v[16:17], v[152:153], v[104:105]
  v_pk_mul_f32 v[18:19], v[154:155], v[106:107]
  v_pk_fma_f32 v[16:17], v[168:169], v[120:121], v[16:17] neg_lo:[0,1,0] neg_hi:[0,1,0]
  v_pk_fma_f32 v[18:19], v[170:171], v[122:123], v[18:19] neg_lo:[0,1,0] neg_hi:[0,1,0]
  v_pk_mul_f32 v[168:169], v[168:169], v[104:105]
  v_pk_mul_f32 v[170:171], v[170:171], v[106:107]
  v_pk_fma_f32 v[168:169], v[152:153], v[120:121], v[168:169]
  v_pk_fma_f32 v[170:171], v[154:155], v[122:123], v[170:171]
  v_cvt_pk_bf16_f32 v36, v16, v168
  v_cvt_pk_bf16_f32 v37, v17, v169
  v_cvt_pk_bf16_f32 v38, v18, v170
  v_cvt_pk_bf16_f32 v39, v19, v171
  v_mfma_f32_16x16x32_bf16 v[192:195], v[24:27], v[60:63], v[192:195]
  v_mfma_f32_16x16x32_bf16 v[208:211], v[24:27], v[76:79], v[208:211]
  v_mfma_f32_16x16x32_bf16 v[200:203], v[24:27], v[64:67], v[200:203]
  v_mfma_f32_16x16x32_bf16 v[216:219], v[24:27], v[80:83], v[216:219]
  v_mfma_f32_16x16x32_bf16 v[196:199], v[32:35], v[60:63], v[196:199]
  v_mfma_f32_16x16x32_bf16 v[212:215], v[32:35], v[76:79], v[212:215]
  v_mfma_f32_16x16x32_bf16 v[204:207], v[32:35], v[64:67], v[204:207]
  v_mfma_f32_16x16x32_bf16 v[220:223], v[32:35], v[80:83], v[220:223]
  v_mfma_f32_16x16x32_bf16 v[192:195], v[28:31], v[68:71], v[192:195]
  v_mfma_f32_16x16x32_bf16 v[208:211], v[28:31], v[84:87], v[208:211]
  v_mfma_f32_16x16x32_bf16 v[200:203], v[28:31], v[72:75], v[200:203]
  v_mfma_f32_16x16x32_bf16 v[216:219], v[28:31], v[88:91], v[216:219]
  v_mfma_f32_16x16x32_bf16 v[196:199], v[36:39], v[68:71], v[196:199]
  v_mfma_f32_16x16x32_bf16 v[212:215], v[36:39], v[84:87], v[212:215]
  v_mfma_f32_16x16x32_bf16 v[204:207], v[36:39], v[72:75], v[204:207]
  v_mfma_f32_16x16x32_bf16 v[220:223], v[36:39], v[88:91], v[220:223]
  s_nop 0
  v_pk_add_f32 v[140:141], v[192:193], v[194:195]
  s_nop 2
  v_pk_add_f32 v[142:143], v[196:197], v[198:199]
  v_pk_add_f32 v[144:145], v[200:201], v[202:203]
  v_pk_add_f32 v[146:147], v[204:205], v[206:207]
  v_pk_add_f32 v[148:149], v[208:209], v[210:211]
  v_pk_add_f32 v[150:151], v[212:213], v[214:215]
  v_pk_add_f32 v[152:153], v[216:217], v[218:219]
  v_pk_add_f32 v[154:155], v[220:221], v[222:223]
  v_pk_add_f32 v[140:141], v[140:141], v[144:145]
  v_pk_add_f32 v[142:143], v[142:143], v[146:147]
  v_pk_add_f32 v[148:149], v[148:149], v[152:153]
  v_pk_add_f32 v[150:151], v[150:151], v[154:155]
  v_pk_add_f32 v[140:141], v[140:141], v[142:143]
  v_pk_add_f32 v[148:149], v[148:149], v[150:151]
  v_add_f32 v16, v140, v141
  v_add_f32 v17, v148, v149
  s_nop 0
  v_add_f32_dpp v16, v16, v16 row_shr:1 row_mask:0xf bank_mask:0xf
  v_add_f32_dpp v17, v17, v17 row_shr:1 row_mask:0xf bank_mask:0xf
  v_cvt_pk_bf16_f32 v124, v192, v193
  v_cvt_pk_bf16_f32 v125, v194, v195
  v_cvt_pk_bf16_f32 v126, v196, v197
  v_add_f32_dpp v16, v16, v16 row_shr:2 row_mask:0xf bank_mask:0xf
  v_add_f32_dpp v17, v17, v17 row_shr:2 row_mask:0xf bank_mask:0xf
  v_cvt_pk_bf16_f32 v127, v198, v199
  ds_write_b128 v188, v[124:127] offset:0
  v_cvt_pk_bf16_f32 v128, v200, v201
  v_add_f32_dpp v16, v16, v16 row_shr:4 row_mask:0xf bank_mask:0xf
  v_add_f32_dpp v17, v17, v17 row_shr:4 row_mask:0xf bank_mask:0xf
  v_cvt_pk_bf16_f32 v129, v202, v203
  v_cvt_pk_bf16_f32 v130, v204, v205
  v_cvt_pk_bf16_f32 v131, v206, v207
  ds_write_b128 v188, v[128:131] offset:2048
  v_add_f32_dpp v16, v16, v16 row_shr:8 row_mask:0xf bank_mask:0xf
  v_add_f32_dpp v17, v17, v17 row_shr:8 row_mask:0xf bank_mask:0xf
  v_cvt_pk_bf16_f32 v132, v208, v209
  v_cvt_pk_bf16_f32 v133, v210, v211
  v_cvt_pk_bf16_f32 v134, v212, v213
  v_add_f32_dpp v16, v16, v16 row_bcast:15 row_mask:0xa bank_mask:0xf
  v_add_f32_dpp v17, v17, v17 row_bcast:15 row_mask:0xa bank_mask:0xf
  v_cvt_pk_bf16_f32 v135, v214, v215
  ds_write_b128 v189, v[132:135] offset:0
  v_cvt_pk_bf16_f32 v136, v216, v217
  v_add_f32_dpp v16, v16, v16 row_bcast:31 row_mask:0xc bank_mask:0xf
  v_add_f32_dpp v17, v17, v17 row_bcast:31 row_mask:0xc bank_mask:0xf
  v_cvt_pk_bf16_f32 v137, v218, v219
  v_cvt_pk_bf16_f32 v138, v220, v221
  v_cvt_pk_bf16_f32 v139, v222, v223
  ds_write_b128 v189, v[136:139] offset:2048
  v_mul_f32 v16, 0xba800000, v16
  v_mul_f32 v17, 0xba800000, v17
  v_readlane_b32 s24, v16, 63
  v_readlane_b32 s26, v17, 63
  s_nop 0
  v_pk_add_f32 v[192:193], v[192:193], s[24:25] op_sel_hi:[1,0]
  v_pk_add_f32 v[194:195], v[194:195], s[24:25] op_sel_hi:[1,0]
  v_pk_add_f32 v[196:197], v[196:197], s[24:25] op_sel_hi:[1,0]
  v_pk_add_f32 v[198:199], v[198:199], s[24:25] op_sel_hi:[1,0]
  v_pk_add_f32 v[200:201], v[200:201], s[24:25] op_sel_hi:[1,0]
  v_pk_add_f32 v[202:203], v[202:203], s[24:25] op_sel_hi:[1,0]
  v_pk_add_f32 v[204:205], v[204:205], s[24:25] op_sel_hi:[1,0]
  v_pk_add_f32 v[206:207], v[206:207], s[24:25] op_sel_hi:[1,0]
  v_pk_add_f32 v[208:209], v[208:209], s[26:27] op_sel_hi:[1,0]
  v_pk_add_f32 v[210:211], v[210:211], s[26:27] op_sel_hi:[1,0]
  v_pk_add_f32 v[212:213], v[212:213], s[26:27] op_sel_hi:[1,0]
  v_pk_add_f32 v[214:215], v[214:215], s[26:27] op_sel_hi:[1,0]
  v_pk_add_f32 v[216:217], v[216:217], s[26:27] op_sel_hi:[1,0]
  v_pk_add_f32 v[218:219], v[218:219], s[26:27] op_sel_hi:[1,0]
  v_pk_add_f32 v[220:221], v[220:221], s[26:27] op_sel_hi:[1,0]
  v_pk_add_f32 v[222:223], v[222:223], s[26:27] op_sel_hi:[1,0]
  v_pk_mul_f32 v[140:141], v[192:193], v[192:193]
  v_pk_mul_f32 v[142:143], v[194:195], v[194:195]
  v_pk_mul_f32 v[148:149], v[208:209], v[208:209]
  v_pk_mul_f32 v[150:151], v[210:211], v[210:211]
  v_pk_fma_f32 v[140:141], v[196:197], v[196:197], v[140:141]
  v_pk_fma_f32 v[148:149], v[212:213], v[212:213], v[148:149]
  v_pk_fma_f32 v[142:143], v[198:199], v[198:199], v[142:143]
  v_pk_fma_f32 v[150:151], v[214:215], v[214:215], v[150:151]
  v_pk_fma_f32 v[140:141], v[200:201], v[200:201], v[140:141]
  v_pk_fma_f32 v[148:149], v[216:217], v[216:217], v[148:149]
  v_pk_fma_f32 v[142:143], v[202:203], v[202:203], v[142:143]
  v_pk_fma_f32 v[150:151], v[218:219], v[218:219], v[150:151]
  v_pk_fma_f32 v[140:141], v[204:205], v[204:205], v[140:141]
  v_pk_fma_f32 v[148:149], v[220:221], v[220:221], v[148:149]
  v_pk_fma_f32 v[142:143], v[206:207], v[206:207], v[142:143]
  v_pk_fma_f32 v[150:151], v[222:223], v[222:223], v[150:151]
  v_pk_add_f32 v[140:141], v[140:141], v[142:143]
  v_pk_add_f32 v[148:149], v[148:149], v[150:151]
  v_add_f32 v16, v140, v141
  v_add_f32 v17, v148, v149
  s_nop 0
  v_add_f32_dpp v16, v16, v16 row_shr:1 row_mask:0xf bank_mask:0xf
  v_add_f32_dpp v17, v17, v17 row_shr:1 row_mask:0xf bank_mask:0xf
  s_nop 0
  v_add_f32_dpp v16, v16, v16 row_shr:2 row_mask:0xf bank_mask:0xf
  v_add_f32_dpp v17, v17, v17 row_shr:2 row_mask:0xf bank_mask:0xf
  s_nop 0
  v_add_f32_dpp v16, v16, v16 row_shr:4 row_mask:0xf bank_mask:0xf
  v_add_f32_dpp v17, v17, v17 row_shr:4 row_mask:0xf bank_mask:0xf
  s_nop 0
  v_add_f32_dpp v16, v16, v16 row_shr:8 row_mask:0xf bank_mask:0xf
  v_add_f32_dpp v17, v17, v17 row_shr:8 row_mask:0xf bank_mask:0xf
  s_nop 0
  v_add_f32_dpp v16, v16, v16 row_bcast:15 row_mask:0xa bank_mask:0xf
  v_add_f32_dpp v17, v17, v17 row_bcast:15 row_mask:0xa bank_mask:0xf
  s_nop 0
  v_add_f32_dpp v16, v16, v16 row_bcast:31 row_mask:0xc bank_mask:0xf
  v_add_f32_dpp v17, v17, v17 row_bcast:31 row_mask:0xc bank_mask:0xf
  v_mov_b32 v18, 0x3727c5ac
  v_fmamk_f32 v16, v16, 0x3a800000, v18
  v_fmamk_f32 v17, v17, 0x3a800000, v18
  v_rsq_f32 v16, v16
  v_rsq_f32 v17, v17
  s_nop 0
  v_readlane_b32 s24, v16, 63
  v_readlane_b32 s26, v17, 63
  s_nop 0
  v_pk_mul_f32 v[192:193], v[192:193], s[24:25] op_sel_hi:[1,0]
  v_pk_mul_f32 v[194:195], v[194:195], s[24:25] op_sel_hi:[1,0]
  v_pk_mul_f32 v[196:197], v[196:197], s[24:25] op_sel_hi:[1,0]
  v_pk_mul_f32 v[198:199], v[198:199], s[24:25] op_sel_hi:[1,0]
  v_pk_mul_f32 v[200:201], v[200:201], s[24:25] op_sel_hi:[1,0]
  v_pk_mul_f32 v[202:203], v[202:203], s[24:25] op_sel_hi:[1,0]
  v_pk_mul_f32 v[204:205], v[204:205], s[24:25] op_sel_hi:[1,0]
  v_pk_mul_f32 v[206:207], v[206:207], s[24:25] op_sel_hi:[1,0]
  v_cvt_pk_bf16_f32 v156, v192, v193
  v_cvt_pk_bf16_f32 v157, v194, v195
  v_cvt_pk_bf16_f32 v158, v196, v197
  v_cvt_pk_bf16_f32 v159, v198, v199
  ds_write_b128 v188, v[156:159] offset:16384
  v_cvt_pk_bf16_f32 v160, v200, v201
  v_cvt_pk_bf16_f32 v161, v202, v203
  v_cvt_pk_bf16_f32 v162, v204, v205
  v_cvt_pk_bf16_f32 v163, v206, v207
  ds_write_b128 v188, v[160:163] offset:18432
  v_pk_mul_f32 v[208:209], v[208:209], s[26:27] op_sel_hi:[1,0]
  v_pk_mul_f32 v[210:211], v[210:211], s[26:27] op_sel_hi:[1,0]
  v_pk_mul_f32 v[212:213], v[212:213], s[26:27] op_sel_hi:[1,0]
  v_pk_mul_f32 v[214:215], v[214:215], s[26:27] op_sel_hi:[1,0]
  v_pk_mul_f32 v[216:217], v[216:217], s[26:27] op_sel_hi:[1,0]
  v_pk_mul_f32 v[218:219], v[218:219], s[26:27] op_sel_hi:[1,0]
  v_pk_mul_f32 v[220:221], v[220:221], s[26:27] op_sel_hi:[1,0]
  v_pk_mul_f32 v[222:223], v[222:223], s[26:27] op_sel_hi:[1,0]
  v_cvt_pk_bf16_f32 v164, v208, v209
  v_cvt_pk_bf16_f32 v165, v210, v211
  v_cvt_pk_bf16_f32 v166, v212, v213
  v_cvt_pk_bf16_f32 v167, v214, v215
  ds_write_b128 v189, v[164:167] offset:16384
  v_cvt_pk_bf16_f32 v168, v216, v217
  v_cvt_pk_bf16_f32 v169, v218, v219
  v_cvt_pk_bf16_f32 v170, v220, v221
  v_cvt_pk_bf16_f32 v171, v222, v223
  ds_write_b128 v189, v[168:171] offset:18432
  s_waitcnt lgkmcnt(0)
  s_barrier
  ds_read_b128 v[60:63], v190 offset:16384
  ds_read_b128 v[64:67], v191 offset:20480
  ds_read_b128 v[68:71], v190 offset:24576
  ds_read_b128 v[72:75], v191 offset:28672
  ds_read_b128 v[76:79], v190 offset:0
  ds_read_b128 v[80:83], v191 offset:4096
  ds_read_b128 v[84:87], v190 offset:8192
  ds_read_b128 v[88:91], v191 offset:12288
  s_add_u32 s29, s28, 0x0
  s_waitcnt lgkmcnt(7)
  buffer_store_dwordx4 v[60:63], v7, s[16:19], s29 offen sc1
  s_add_u32 s29, s28, 0x20000
  s_waitcnt lgkmcnt(6)
  buffer_store_dwordx4 v[64:67], v7, s[16:19], s29 offen sc1
  s_add_u32 s29, s28, 0x40000
  s_waitcnt lgkmcnt(5)
  buffer_store_dwordx4 v[68:71], v7, s[16:19], s29 offen sc1
  s_add_u32 s29, s28, 0x60000
  s_waitcnt lgkmcnt(4)
  buffer_store_dwordx4 v[72:75], v7, s[16:19], s29 offen sc1
  s_mov_b32 s8, s16
  s_add_u32 s44, s28, 0x400000
  s_mov_b32 s9, s17
  s_add_u32 s45, s28, 0x420000
  s_mov_b32 s10, s18
  s_add_u32 s46, s28, 0x440000
  s_mov_b32 s11, s19
  s_add_u32 s47, s28, 0x460000
  s_waitcnt lgkmcnt(0)
  s_waitcnt vmcnt(0)
  s_barrier
  s_add_u32 s76, s92, 0x7000000
  s_addc_u32 s77, s93, 0
  s_mov_b32 s78, 0x28000
  s_mov_b32 s79, 0x00020000
  s_cmp_lg_u32 s96, 0
  s_cbranch_scc1 fa_kernel_pub9
  s_lshl_b32 s3, s20, 7
  s_add_u32 s3, s3, 0
  v_mov_b32 v16, 1
  v_mov_b32 v17, 0
  s_mov_b64 exec, 1
  buffer_store_dword v16, v17, s[76:79], s3 offen sc1
  s_mov_b64 exec, -1
fa_kernel_pub9:
  v_accvgpr_read_b32 v224, a240
  v_accvgpr_read_b32 v225, a241
  v_accvgpr_read_b32 v226, a242
  v_accvgpr_read_b32 v227, a243
  v_accvgpr_read_b32 v228, a244
  v_accvgpr_read_b32 v229, a245
  v_accvgpr_read_b32 v230, a246
  v_accvgpr_read_b32 v231, a247
  v_accvgpr_read_b32 v232, a248
  v_accvgpr_read_b32 v233, a249
  v_accvgpr_read_b32 v234, a250
  s_lshl_b32 s22, s96, 12
  s_lshl_b32 s37, s54, 19
  s_add_u32 s37, s37, 0
  s_add_u32 s12, s92, s37
  s_addc_u32 s13, s93, 0
  s_mov_b32 s14, 524288
  s_mov_b32 s15, 0x00020000
  s_add_u32 s16, s92, 0x4000000
  s_addc_u32 s17, s93, 0
  s_mov_b32 s18, 0xe00000
  s_mov_b32 s19, 0x00020000
  s_add_u32 s31, s22, 507904
  s_and_b32 s38, s55, 1
  s_mul_i32 s25, s55, 7
  s_add_u32 s25, s25, 1
  s_lshr_b32 s25, s25, 1
  s_cmp_eq_u32 s38, 0
  s_cselect_b32 s26, 3, -1
  s_add_u32 s26, s26, s25
  s_lshl_b32 s25, s25, 12
  s_lshl_b32 s26, s26, 12
  s_lshl_b32 s36, s38, 3
  s_add_u32 s26, s26, s36
  s_lshl_b32 s37, s54, 2
  s_add_u32 s37, s37, s96
  s_mul_i32 s37, s37, 458752
  s_add_u32 s25, s25, s37
  s_add_u32 s26, s26, s37
  v_mov_b32 v244, 0xbdd2d3e8
  v_mov_b32 v246, 0xc0135761
  v_mov_b32 v245, 0xbdd2d3e8
  v_mov_b32 v247, 0xc0135761
  s_mov_b32 s60, s88
  s_mov_b32 s61, s89
  s_cmp_eq_u32 s97, 0
  s_cselect_b32 s62, 7340032, 0
  s_mov_b32 s63, 0x00020000
  v_lshlrev_b32 v248, 2, v224
  s_lshl_b32 s64, s2, 2
  s_add_u32 s64, s64, s96
  s_lshl_b32 s64, s64, 13
  s_mov_b32 s23, 2
  s_lshl_b32 s36, s54, 5
  s_cmp_lg_u32 s96, 0
  s_cbranch_scc1 fa_kernel_pe12
  v_mbcnt_lo_u32_b32 v237, -1, 0
  v_lshlrev_b32 v237, 7, v237
  s_lshl_b32 s3, s36, 7
  s_add_u32 s3, s3, 0
  s_mov_b64 exec, 0xffffffff
  s_mov_b32 s80, 0x40000
fa_kernel_pl10:
  buffer_load_dword v236, v237, s[76:79], s3 offen sc1
  s_waitcnt vmcnt(0)
  v_cmp_gt_u32 vcc, 1, v236
  s_cbranch_vccz fa_kernel_pd11
  s_sub_u32 s80, s80, 1
  s_cmp_lg_u32 s80, 0
  s_cbranch_scc1 fa_kernel_pl10
fa_kernel_pd11:
  s_mov_b64 exec, -1
fa_kernel_pe12:
  s_barrier
  s_add_u32 s28, s22, 0
  buffer_load_dwordx4 a[0:3], v224, s[12:15], s28 offen offset:0 sc1
  s_add_u32 s28, s22, 0
  buffer_load_dwordx4 a[4:7], v224, s[12:15], s28 offen offset:1024 sc1
  s_add_u32 s28, s22, 0
  buffer_load_dwordx4 a[8:11], v224, s[12:15], s28 offen offset:2048 sc1
  s_add_u32 s28, s22, 0
  buffer_load_dwordx4 a[12:15], v224, s[12:15], s28 offen offset:3072 sc1
  s_add_u32 s28, s22, 16384
  buffer_load_dwordx4 a[16:19], v224, s[12:15], s28 offen offset:0 sc1
  s_add_u32 s28, s22, 16384
  buffer_load_dwordx4 a[20:23], v224, s[12:15], s28 offen offset:1024 sc1
  s_add_u32 s28, s22, 16384
  buffer_load_dwordx4 a[24:27], v224, s[12:15], s28 offen offset:2048 sc1
  s_add_u32 s28, s22, 16384
  buffer_load_dwordx4 a[28:31], v224, s[12:15], s28 offen offset:3072 sc1
  s_add_u32 s28, s22, 32768
  buffer_load_dwordx4 a[32:35], v224, s[12:15], s28 offen offset:0 sc1
  s_add_u32 s28, s22, 32768
  buffer_load_dwordx4 a[36:39], v224, s[12:15], s28 offen offset:1024 sc1
  s_add_u32 s28, s22, 32768
  buffer_load_dwordx4 a[40:43], v224, s[12:15], s28 offen offset:2048 sc1
  s_add_u32 s28, s22, 32768
  buffer_load_dwordx4 a[44:47], v224, s[12:15], s28 offen offset:3072 sc1
  buffer_store_dwordx4 v[76:79], v7, s[8:11], s44 offen sc1
  buffer_store_dwordx4 v[80:83], v7, s[8:11], s45 offen sc1
  buffer_store_dwordx4 v[84:87], v7, s[8:11], s46 offen sc1
  buffer_store_dwordx4 v[88:91], v7, s[8:11], s47 offen sc1
  s_nop 0
  ds_read_b64_tr_b16 a[128:129], v225 offset:0
  ds_read_b64_tr_b16 a[130:131], v225 offset:3584
  ds_read_b64_tr_b16 a[132:133], v225 offset:7168
  ds_read_b64_tr_b16 a[134:135], v225 offset:10752
  ds_read_b64_tr_b16 a[136:137], v225 offset:32
  ds_read_b64_tr_b16 a[138:139], v225 offset:3616
  ds_read_b64_tr_b16 a[140:141], v225 offset:7200
  ds_read_b64_tr_b16 a[142:143], v225 offset:10784
  ds_read_b64_tr_b16 a[144:145], v225 offset:64
  s_waitcnt vmcnt(15) lgkmcnt(7)
  v_mfma_f32_16x16x32_bf16 v[0:3], a[128:131], a[0:3], 0
  s_add_u32 s28, s22, 49152
  ds_read_b64_tr_b16 a[146:147], v225 offset:3648
  s_waitcnt vmcnt(14)
  v_mfma_f32_16x16x32_bf16 v[4:7], a[128:131], a[4:7], 0
  buffer_load_dwordx4 a[48:51], v224, s[12:15], s28 offen offset:0 sc1
  s_waitcnt vmcnt(14)
  v_mfma_f32_16x16x32_bf16 v[8:11], a[128:131], a[8:11], 0
  ds_read_b64_tr_b16 a[148:149], v225 offset:7232
  s_waitcnt vmcnt(13)
  v_mfma_f32_16x16x32_bf16 v[12:15], a[128:131], a[12:15], 0
  ds_read_b64_tr_b16 a[150:151], v225 offset:10816
  s_waitcnt lgkmcnt(8)
  v_mfma_f32_16x16x32_bf16 v[16:19], a[132:135], a[0:3], 0
  s_add_u32 s28, s22, 49152
  ds_read_b64_tr_b16 a[152:153], v225 offset:96
  v_mfma_f32_16x16x32_bf16 v[20:23], a[132:135], a[4:7], 0
  buffer_load_dwordx4 a[52:55], v224, s[12:15], s28 offen offset:1024 sc1
  v_mfma_f32_16x16x32_bf16 v[24:27], a[132:135], a[8:11], 0
  ds_read_b64_tr_b16 a[154:155], v225 offset:3680
  v_mfma_f32_16x16x32_bf16 v[28:31], a[132:135], a[12:15], 0
  ds_read_b64_tr_b16 a[156:157], v225 offset:7264
  s_waitcnt lgkmcnt(9)
  v_mfma_f32_16x16x32_bf16 v[32:35], a[136:139], a[0:3], 0
  ds_read_b64_tr_b16 a[158:159], v225 offset:10848
  v_mfma_f32_16x16x32_bf16 v[36:39], a[136:139], a[4:7], 0
  s_add_u32 s28, s22, 49152
  ds_read_b64_tr_b16 a[128:129], v225 offset:128
  v_mfma_f32_16x16x32_bf16 v[40:43], a[136:139], a[8:11], 0
  buffer_load_dwordx4 a[56:59], v224, s[12:15], s28 offen offset:2048 sc1
  v_mfma_f32_16x16x32_bf16 v[44:47], a[136:139], a[12:15], 0
  ds_read_b64_tr_b16 a[130:131], v225 offset:3712
  s_waitcnt lgkmcnt(10)
  v_mfma_f32_16x16x32_bf16 v[48:51], a[140:143], a[0:3], 0
  ds_read_b64_tr_b16 a[132:133], v225 offset:7296
  v_mfma_f32_16x16x32_bf16 v[52:55], a[140:143], a[4:7], 0
  ds_read_b64_tr_b16 a[134:135], v225 offset:10880
  v_mfma_f32_16x16x32_bf16 v[56:59], a[140:143], a[8:11], 0
  ds_read_b64_tr_b16 a[136:137], v225 offset:160
  v_mfma_f32_16x16x32_bf16 v[60:63], a[140:143], a[12:15], 0
  ds_read_b64_tr_b16 a[138:139], v225 offset:3744
  s_waitcnt lgkmcnt(12)
  v_mfma_f32_16x16x32_bf16 v[64:67], a[144:147], a[0:3], 0
  s_add_u32 s28, s22, 49152
  ds_read_b64_tr_b16 a[140:141], v225 offset:7328
  v_mfma_f32_16x16x32_bf16 v[68:71], a[144:147], a[4:7], 0
  buffer_load_dwordx4 a[60:63], v224, s[12:15], s28 offen offset:3072 sc1
  v_mfma_f32_16x16x32_bf16 v[72:75], a[144:147], a[8:11], 0
  ds_read_b64_tr_b16 a[142:143], v225 offset:10912
  v_mfma_f32_16x16x32_bf16 v[76:79], a[144:147], a[12:15], 0
  ds_read_b64_tr_b16 a[144:145], v225 offset:192
  s_waitcnt lgkmcnt(13)
  v_mfma_f32_16x16x32_bf16 v[80:83], a[148:151], a[0:3], 0
  s_add_u32 m0, s52, 57344
  s_add_u32 s57, s53, 917504
  ds_read_b64_tr_b16 a[146:147], v225 offset:3776
  v_mfma_f32_16x16x32_bf16 v[84:87], a[148:151], a[4:7], 0
  buffer_load_dwordx4 v228, s[48:51], s57 offen lds
  v_mfma_f32_16x16x32_bf16 v[88:91], a[148:151], a[8:11], 0
  v_mfma_f32_16x16x32_bf16 v[92:95], a[148:151], a[12:15], 0
  ds_read_b64_tr_b16 a[148:149], v225 offset:7360
  s_waitcnt lgkmcnt(13)
  v_mfma_f32_16x16x32_bf16 v[96:99], a[152:155], a[0:3], 0
  ds_read_b64_tr_b16 a[150:151], v225 offset:10944
  v_mfma_f32_16x16x32_bf16 v[100:103], a[152:155], a[4:7], 0
  s_add_u32 m0, s52, 58368
  s_add_u32 s57, s53, 917504
  v_mfma_f32_16x16x32_bf16 v[104:107], a[152:155], a[8:11], 0
  buffer_load_dwordx4 v229, s[48:51], s57 offen lds
  v_mfma_f32_16x16x32_bf16 v[108:111], a[152:155], a[12:15], 0
  ds_read_b64_tr_b16 a[152:153], v225 offset:14336
  s_waitcnt lgkmcnt(13)
  v_mfma_f32_16x16x32_bf16 v[112:115], a[156:159], a[0:3], 0
  ds_read_b64_tr_b16 a[154:155], v225 offset:17920
  v_mfma_f32_16x16x32_bf16 v[116:119], a[156:159], a[4:7], 0
  v_mfma_f32_16x16x32_bf16 v[120:123], a[156:159], a[8:11], 0
  v_mfma_f32_16x16x32_bf16 v[124:127], a[156:159], a[12:15], 0
  ds_read_b64_tr_b16 a[156:157], v225 offset:21504
  s_waitcnt lgkmcnt(13)
  v_mfma_f32_16x16x32_bf16 v[128:131], a[128:131], a[0:3], 0
  s_add_u32 m0, s52, 59392
  s_add_u32 s57, s53, 917504
  ds_read_b64_tr_b16 a[158:159], v225 offset:25088
  v_mfma_f32_16x16x32_bf16 v[132:135], a[128:131], a[4:7], 0
  buffer_load_dwordx4 v230, s[48:51], s57 offen lds
  v_mfma_f32_16x16x32_bf16 v[136:139], a[128:131], a[8:11], 0
  v_mfma_f32_16x16x32_bf16 v[140:143], a[128:131], a[12:15], 0
  ds_read_b64_tr_b16 a[128:129], v225 offset:14368
  s_waitcnt lgkmcnt(13)
  v_mfma_f32_16x16x32_bf16 v[144:147], a[132:135], a[0:3], 0
  s_add_u32 m0, s52, 60416
  s_add_u32 s57, s53, 917504
  ds_read_b64_tr_b16 a[130:131], v225 offset:17952
  v_mfma_f32_16x16x32_bf16 v[148:151], a[132:135], a[4:7], 0
  buffer_load_dwordx4 v231, s[48:51], s57 offen lds
  v_mfma_f32_16x16x32_bf16 v[152:155], a[132:135], a[8:11], 0
  v_mfma_f32_16x16x32_bf16 v[156:159], a[132:135], a[12:15], 0
  ds_read_b64_tr_b16 a[132:133], v225 offset:21536
  s_waitcnt lgkmcnt(13)
  v_mfma_f32_16x16x32_bf16 v[160:163], a[136:139], a[0:3], 0
  ds_read_b64_tr_b16 a[134:135], v225 offset:25120
  v_mfma_f32_16x16x32_bf16 v[164:167], a[136:139], a[4:7], 0
  s_add_u32 m0, s52, 61440
  s_add_u32 s57, s53, 917504
  v_mfma_f32_16x16x32_bf16 v[168:171], a[136:139], a[8:11], 0
  buffer_load_dwordx4 v232, s[48:51], s57 offen lds
  v_mfma_f32_16x16x32_bf16 v[172:175], a[136:139], a[12:15], 0
  ds_read_b64_tr_b16 a[136:137], v225 offset:14400
  s_waitcnt lgkmcnt(13)
  v_mfma_f32_16x16x32_bf16 v[176:179], a[140:143], a[0:3], 0
  ds_read_b64_tr_b16 a[138:139], v225 offset:17984
  v_mfma_f32_16x16x32_bf16 v[180:183], a[140:143], a[4:7], 0
  v_mfma_f32_16x16x32_bf16 v[184:187], a[140:143], a[8:11], 0
  v_mfma_f32_16x16x32_bf16 v[188:191], a[140:143], a[12:15], 0
  ds_read_b64_tr_b16 a[140:141], v225 offset:21568
  s_waitcnt lgkmcnt(13)
  v_mfma_f32_16x16x32_bf16 v[192:195], a[144:147], a[0:3], 0
  s_add_u32 m0, s52, 62464
  s_add_u32 s57, s53, 917504
  ds_read_b64_tr_b16 a[142:143], v225 offset:25152
  v_mfma_f32_16x16x32_bf16 v[196:199], a[144:147], a[4:7], 0
  buffer_load_dwordx4 v233, s[48:51], s57 offen lds
  v_mfma_f32_16x16x32_bf16 v[200:203], a[144:147], a[8:11], 0
  v_mfma_f32_16x16x32_bf16 v[204:207], a[144:147], a[12:15], 0
  ds_read_b64_tr_b16 a[144:145], v225 offset:14432
  s_waitcnt lgkmcnt(13)
  v_mfma_f32_16x16x32_bf16 v[208:211], a[148:151], a[0:3], 0
  s_add_u32 m0, s52, 63488
  s_add_u32 s57, s53, 917504
  ds_read_b64_tr_b16 a[146:147], v225 offset:18016
  v_mfma_f32_16x16x32_bf16 v[212:215], a[148:151], a[4:7], 0
  buffer_load_dwordx4 v234, s[48:51], s57 offen lds
  v_mfma_f32_16x16x32_bf16 v[216:219], a[148:151], a[8:11], 0
  v_mfma_f32_16x16x32_bf16 v[220:223], a[148:151], a[12:15], 0
  ds_read_b64_tr_b16 a[148:149], v225 offset:21600
  s_waitcnt vmcnt(22) lgkmcnt(13)
  v_mfma_f32_16x16x32_bf16 v[0:3], a[152:155], a[16:19], v[0:3]
  ds_read_b64_tr_b16 a[150:151], v225 offset:25184
  s_waitcnt vmcnt(21)
  v_mfma_f32_16x16x32_bf16 v[4:7], a[152:155], a[20:23], v[4:7]
  s_add_u32 s28, s22, 65536
  s_waitcnt vmcnt(20)
  v_mfma_f32_16x16x32_bf16 v[8:11], a[152:155], a[24:27], v[8:11]
  buffer_load_dwordx4 a[64:67], v224, s[12:15], s28 offen offset:0 sc1
  s_waitcnt vmcnt(20)
  v_mfma_f32_16x16x32_bf16 v[12:15], a[152:155], a[28:31], v[12:15]
  ds_read_b64_tr_b16 a[152:153], v225 offset:14464
  s_waitcnt lgkmcnt(13)
  v_mfma_f32_16x16x32_bf16 v[16:19], a[156:159], a[16:19], v[16:19]
  ds_read_b64_tr_b16 a[154:155], v225 offset:18048
  v_mfma_f32_16x16x32_bf16 v[20:23], a[156:159], a[20:23], v[20:23]
  v_mfma_f32_16x16x32_bf16 v[24:27], a[156:159], a[24:27], v[24:27]
  v_mfma_f32_16x16x32_bf16 v[28:31], a[156:159], a[28:31], v[28:31]
  ds_read_b64_tr_b16 a[156:157], v225 offset:21632
  s_waitcnt lgkmcnt(13)
  v_mfma_f32_16x16x32_bf16 v[32:35], a[128:131], a[16:19], v[32:35]
  s_add_u32 s28, s22, 65536
  ds_read_b64_tr_b16 a[158:159], v225 offset:25216
  v_mfma_f32_16x16x32_bf16 v[36:39], a[128:131], a[20:23], v[36:39]
  buffer_load_dwordx4 a[68:71], v224, s[12:15], s28 offen offset:1024 sc1
  v_mfma_f32_16x16x32_bf16 v[40:43], a[128:131], a[24:27], v[40:43]
  v_mfma_f32_16x16x32_bf16 v[44:47], a[128:131], a[28:31], v[44:47]
  ds_read_b64_tr_b16 a[128:129], v225 offset:14496
  s_waitcnt lgkmcnt(13)
  v_mfma_f32_16x16x32_bf16 v[48:51], a[132:135], a[16:19], v[48:51]
  s_add_u32 s28, s22, 65536
  ds_read_b64_tr_b16 a[130:131], v225 offset:18080
  v_mfma_f32_16x16x32_bf16 v[52:55], a[132:135], a[20:23], v[52:55]
  buffer_load_dwordx4 a[72:75], v224, s[12:15], s28 offen offset:2048 sc1
  v_mfma_f32_16x16x32_bf16 v[56:59], a[132:135], a[24:27], v[56:59]
  v_mfma_f32_16x16x32_bf16 v[60:63], a[132:135], a[28:31], v[60:63]
  ds_read_b64_tr_b16 a[132:133], v225 offset:21664
  s_waitcnt lgkmcnt(13)
  v_mfma_f32_16x16x32_bf16 v[64:67], a[136:139], a[16:19], v[64:67]
  ds_read_b64_tr_b16 a[134:135], v225 offset:25248
  v_mfma_f32_16x16x32_bf16 v[68:71], a[136:139], a[20:23], v[68:71]
  s_add_u32 s28, s22, 65536
  v_mfma_f32_16x16x32_bf16 v[72:75], a[136:139], a[24:27], v[72:75]
  buffer_load_dwordx4 a[76:79], v224, s[12:15], s28 offen offset:3072 sc1
  v_mfma_f32_16x16x32_bf16 v[76:79], a[136:139], a[28:31], v[76:79]
  ds_read_b64_tr_b16 a[136:137], v225 offset:14528
  s_waitcnt lgkmcnt(13)
  v_mfma_f32_16x16x32_bf16 v[80:83], a[140:143], a[16:19], v[80:83]
  ds_read_b64_tr_b16 a[138:139], v225 offset:18112
  v_mfma_f32_16x16x32_bf16 v[84:87], a[140:143], a[20:23], v[84:87]
  v_mfma_f32_16x16x32_bf16 v[88:91], a[140:143], a[24:27], v[88:91]
  v_mfma_f32_16x16x32_bf16 v[92:95], a[140:143], a[28:31], v[92:95]
  ds_read_b64_tr_b16 a[140:141], v225 offset:21696
  s_waitcnt lgkmcnt(13)
  v_mfma_f32_16x16x32_bf16 v[96:99], a[144:147], a[16:19], v[96:99]
  s_add_u32 s28, s22, 81920
  ds_read_b64_tr_b16 a[142:143], v225 offset:25280
  v_mfma_f32_16x16x32_bf16 v[100:103], a[144:147], a[20:23], v[100:103]
  buffer_load_dwordx4 a[80:83], v224, s[12:15], s28 offen offset:0 sc1
  v_mfma_f32_16x16x32_bf16 v[104:107], a[144:147], a[24:27], v[104:107]
  v_mfma_f32_16x16x32_bf16 v[108:111], a[144:147], a[28:31], v[108:111]
  s_waitcnt lgkmcnt(12)
  v_mfma_f32_16x16x32_bf16 v[112:115], a[148:151], a[16:19], v[112:115]
  s_add_u32 s28, s22, 81920
  v_mfma_f32_16x16x32_bf16 v[116:119], a[148:151], a[20:23], v[116:119]
  buffer_load_dwordx4 a[84:87], v224, s[12:15], s28 offen offset:1024 sc1
  v_mfma_f32_16x16x32_bf16 v[120:123], a[148:151], a[24:27], v[120:123]
  v_mfma_f32_16x16x32_bf16 v[124:127], a[148:151], a[28:31], v[124:127]
  s_waitcnt lgkmcnt(10)
  v_mfma_f32_16x16x32_bf16 v[128:131], a[152:155], a[16:19], v[128:131]
  v_mfma_f32_16x16x32_bf16 v[132:135], a[152:155], a[20:23], v[132:135]
  s_add_u32 s28, s22, 81920
  v_mfma_f32_16x16x32_bf16 v[136:139], a[152:155], a[24:27], v[136:139]
  buffer_load_dwordx4 a[88:91], v224, s[12:15], s28 offen offset:2048 sc1
  v_mfma_f32_16x16x32_bf16 v[140:143], a[152:155], a[28:31], v[140:143]
  s_waitcnt lgkmcnt(0)
  s_barrier
  ds_read_b64_tr_b16 a[144:145], v225 offset:28672
  v_mfma_f32_16x16x32_bf16 v[144:147], a[156:159], a[16:19], v[144:147]
  ds_read_b64_tr_b16 a[146:147], v225 offset:32256
  v_mfma_f32_16x16x32_bf16 v[148:151], a[156:159], a[20:23], v[148:151]
  ds_read_b64_tr_b16 a[148:149], v225 offset:35840
  v_mfma_f32_16x16x32_bf16 v[152:155], a[156:159], a[24:27], v[152:155]
  ds_read_b64_tr_b16 a[150:151], v225 offset:39424
  v_mfma_f32_16x16x32_bf16 v[156:159], a[156:159], a[28:31], v[156:159]
  ds_read_b64_tr_b16 a[152:153], v225 offset:28704
  v_mfma_f32_16x16x32_bf16 v[160:163], a[128:131], a[16:19], v[160:163]
  s_add_u32 s28, s22, 81920
  ds_read_b64_tr_b16 a[154:155], v225 offset:32288
  v_mfma_f32_16x16x32_bf16 v[164:167], a[128:131], a[20:23], v[164:167]
  buffer_load_dwordx4 a[92:95], v224, s[12:15], s28 offen offset:3072 sc1
  v_mfma_f32_16x16x32_bf16 v[168:171], a[128:131], a[24:27], v[168:171]
  ds_read_b64_tr_b16 a[156:157], v225 offset:35872
  v_mfma_f32_16x16x32_bf16 v[172:175], a[128:131], a[28:31], v[172:175]
  ds_read_b64_tr_b16 a[158:159], v225 offset:39456
  v_mfma_f32_16x16x32_bf16 v[176:179], a[132:135], a[16:19], v[176:179]
  s_add_u32 m0, s52, 86016
  s_add_u32 s57, s53, 1376256
  ds_read_b64_tr_b16 a[128:129], v225 offset:28736
  v_mfma_f32_16x16x32_bf16 v[180:183], a[132:135], a[20:23], v[180:183]
  buffer_load_dwordx4 v228, s[48:51], s57 offen lds
  v_mfma_f32_16x16x32_bf16 v[184:187], a[132:135], a[24:27], v[184:187]
  ds_read_b64_tr_b16 a[130:131], v225 offset:32320
  v_mfma_f32_16x16x32_bf16 v[188:191], a[132:135], a[28:31], v[188:191]
  ds_read_b64_tr_b16 a[132:133], v225 offset:35904
  v_mfma_f32_16x16x32_bf16 v[192:195], a[136:139], a[16:19], v[192:195]
  s_add_u32 m0, s52, 87040
  s_add_u32 s57, s53, 1376256
  ds_read_b64_tr_b16 a[134:135], v225 offset:39488
  v_mfma_f32_16x16x32_bf16 v[196:199], a[136:139], a[20:23], v[196:199]
  buffer_load_dwordx4 v229, s[48:51], s57 offen lds
  v_mfma_f32_16x16x32_bf16 v[200:203], a[136:139], a[24:27], v[200:203]
  v_mfma_f32_16x16x32_bf16 v[204:207], a[136:139], a[28:31], v[204:207]
  ds_read_b64_tr_b16 a[136:137], v225 offset:28768
  v_mfma_f32_16x16x32_bf16 v[208:211], a[140:143], a[16:19], v[208:211]
  ds_read_b64_tr_b16 a[138:139], v225 offset:32352
  v_mfma_f32_16x16x32_bf16 v[212:215], a[140:143], a[20:23], v[212:215]
  v_mfma_f32_16x16x32_bf16 v[216:219], a[140:143], a[24:27], v[216:219]
  v_mfma_f32_16x16x32_bf16 v[220:223], a[140:143], a[28:31], v[220:223]
  ds_read_b64_tr_b16 a[140:141], v225 offset:35936
  s_waitcnt vmcnt(28) lgkmcnt(13)
  v_mfma_f32_16x16x32_bf16 v[0:3], a[144:147], a[32:35], v[0:3]
  s_add_u32 m0, s52, 88064
  s_add_u32 s57, s53, 1376256
  ds_read_b64_tr_b16 a[142:143], v225 offset:39520
  s_waitcnt vmcnt(27)
  v_mfma_f32_16x16x32_bf16 v[4:7], a[144:147], a[36:39], v[4:7]
  buffer_load_dwordx4 v230, s[48:51], s57 offen lds
  s_waitcnt vmcnt(27)
  v_mfma_f32_16x16x32_bf16 v[8:11], a[144:147], a[40:43], v[8:11]
  s_waitcnt vmcnt(26)
  v_mfma_f32_16x16x32_bf16 v[12:15], a[144:147], a[44:47], v[12:15]
  ds_read_b64_tr_b16 a[144:145], v225 offset:28800
  s_waitcnt lgkmcnt(13)
  v_mfma_f32_16x16x32_bf16 v[16:19], a[148:151], a[32:35], v[16:19]
  s_add_u32 m0, s52, 89088
  s_add_u32 s57, s53, 1376256
  ds_read_b64_tr_b16 a[146:147], v225 offset:32384
  v_mfma_f32_16x16x32_bf16 v[20:23], a[148:151], a[36:39], v[20:23]
  buffer_load_dwordx4 v231, s[48:51], s57 offen lds
  v_mfma_f32_16x16x32_bf16 v[24:27], a[148:151], a[40:43], v[24:27]
  v_mfma_f32_16x16x32_bf16 v[28:31], a[148:151], a[44:47], v[28:31]
  ds_read_b64_tr_b16 a[148:149], v225 offset:35968
  s_waitcnt lgkmcnt(13)
  v_mfma_f32_16x16x32_bf16 v[32:35], a[152:155], a[32:35], v[32:35]
  s_add_u32 m0, s52, 90112
  s_add_u32 s57, s53, 1376256
  ds_read_b64_tr_b16 a[150:151], v225 offset:39552
  v_mfma_f32_16x16x32_bf16 v[36:39], a[152:155], a[36:39], v[36:39]
  buffer_load_dwordx4 v232, s[48:51], s57 offen lds
  v_mfma_f32_16x16x32_bf16 v[40:43], a[152:155], a[40:43], v[40:43]
  v_mfma_f32_16x16x32_bf16 v[44:47], a[152:155], a[44:47], v[44:47]
  ds_read_b64_tr_b16 a[152:153], v225 offset:28832
  s_waitcnt lgkmcnt(13)
  v_mfma_f32_16x16x32_bf16 v[48:51], a[156:159], a[32:35], v[48:51]
  ds_read_b64_tr_b16 a[154:155], v225 offset:32416
  v_mfma_f32_16x16x32_bf16 v[52:55], a[156:159], a[36:39], v[52:55]
  v_mfma_f32_16x16x32_bf16 v[56:59], a[156:159], a[40:43], v[56:59]
  v_mfma_f32_16x16x32_bf16 v[60:63], a[156:159], a[44:47], v[60:63]
  ds_read_b64_tr_b16 a[156:157], v225 offset:36000
  s_waitcnt lgkmcnt(13)
  v_mfma_f32_16x16x32_bf16 v[64:67], a[128:131], a[32:35], v[64:67]
  s_add_u32 m0, s52, 91136
  s_add_u32 s57, s53, 1376256
  ds_read_b64_tr_b16 a[158:159], v225 offset:39584
  v_mfma_f32_16x16x32_bf16 v[68:71], a[128:131], a[36:39], v[68:71]
  buffer_load_dwordx4 v233, s[48:51], s57 offen lds
  v_mfma_f32_16x16x32_bf16 v[72:75], a[128:131], a[40:43], v[72:75]
  v_mfma_f32_16x16x32_bf16 v[76:79], a[128:131], a[44:47], v[76:79]
  ds_read_b64_tr_b16 a[128:129], v225 offset:28864
  s_waitcnt lgkmcnt(13)
  v_mfma_f32_16x16x32_bf16 v[80:83], a[132:135], a[32:35], v[80:83]
  s_add_u32 m0, s52, 92160
  s_add_u32 s57, s53, 1376256
  ds_read_b64_tr_b16 a[130:131], v225 offset:32448
  v_mfma_f32_16x16x32_bf16 v[84:87], a[132:135], a[36:39], v[84:87]
  buffer_load_dwordx4 v234, s[48:51], s57 offen lds
  v_mfma_f32_16x16x32_bf16 v[88:91], a[132:135], a[40:43], v[88:91]
  v_mfma_f32_16x16x32_bf16 v[92:95], a[132:135], a[44:47], v[92:95]
  ds_read_b64_tr_b16 a[132:133], v225 offset:36032
  s_waitcnt lgkmcnt(13)
  v_mfma_f32_16x16x32_bf16 v[96:99], a[136:139], a[32:35], v[96:99]
  s_add_u32 s28, s22, 98304
  ds_read_b64_tr_b16 a[134:135], v225 offset:39616
  v_mfma_f32_16x16x32_bf16 v[100:103], a[136:139], a[36:39], v[100:103]
  buffer_load_dwordx4 a[96:99], v224, s[12:15], s28 offen offset:0 sc1
  v_mfma_f32_16x16x32_bf16 v[104:107], a[136:139], a[40:43], v[104:107]
  v_mfma_f32_16x16x32_bf16 v[108:111], a[136:139], a[44:47], v[108:111]
  ds_read_b64_tr_b16 a[136:137], v225 offset:43008
  s_waitcnt lgkmcnt(13)
  v_mfma_f32_16x16x32_bf16 v[112:115], a[140:143], a[32:35], v[112:115]
  ds_read_b64_tr_b16 a[138:139], v225 offset:46592
  v_mfma_f32_16x16x32_bf16 v[116:119], a[140:143], a[36:39], v[116:119]
  v_mfma_f32_16x16x32_bf16 v[120:123], a[140:143], a[40:43], v[120:123]
  v_mfma_f32_16x16x32_bf16 v[124:127], a[140:143], a[44:47], v[124:127]
  ds_read_b64_tr_b16 a[140:141], v225 offset:50176
  s_waitcnt lgkmcnt(13)
  v_mfma_f32_16x16x32_bf16 v[128:131], a[144:147], a[32:35], v[128:131]
  s_add_u32 s28, s22, 98304
  ds_read_b64_tr_b16 a[142:143], v225 offset:53760
  v_mfma_f32_16x16x32_bf16 v[132:135], a[144:147], a[36:39], v[132:135]
  buffer_load_dwordx4 a[100:103], v224, s[12:15], s28 offen offset:1024 sc1
  v_mfma_f32_16x16x32_bf16 v[136:139], a[144:147], a[40:43], v[136:139]
  v_mfma_f32_16x16x32_bf16 v[140:143], a[144:147], a[44:47], v[140:143]
  ds_read_b64_tr_b16 a[144:145], v225 offset:43040
  s_waitcnt lgkmcnt(13)
  v_mfma_f32_16x16x32_bf16 v[144:147], a[148:151], a[32:35], v[144:147]
  s_add_u32 s28, s22, 98304
  ds_read_b64_tr_b16 a[146:147], v225 offset:46624
  v_mfma_f32_16x16x32_bf16 v[148:151], a[148:151], a[36:39], v[148:151]
  buffer_load_dwordx4 a[104:107], v224, s[12:15], s28 offen offset:2048 sc1
  v_mfma_f32_16x16x32_bf16 v[152:155], a[148:151], a[40:43], v[152:155]
  v_mfma_f32_16x16x32_bf16 v[156:159], a[148:151], a[44:47], v[156:159]
  ds_read_b64_tr_b16 a[148:149], v225 offset:50208
  s_waitcnt lgkmcnt(13)
  v_mfma_f32_16x16x32_bf16 v[160:163], a[152:155], a[32:35], v[160:163]
  s_add_u32 s28, s22, 98304
  ds_read_b64_tr_b16 a[150:151], v225 offset:53792
  v_mfma_f32_16x16x32_bf16 v[164:167], a[152:155], a[36:39], v[164:167]
  buffer_load_dwordx4 a[108:111], v224, s[12:15], s28 offen offset:3072 sc1
  v_mfma_f32_16x16x32_bf16 v[168:171], a[152:155], a[40:43], v[168:171]
  v_mfma_f32_16x16x32_bf16 v[172:175], a[152:155], a[44:47], v[172:175]
  ds_read_b64_tr_b16 a[152:153], v225 offset:43072
  s_waitcnt lgkmcnt(13)
  v_mfma_f32_16x16x32_bf16 v[176:179], a[156:159], a[32:35], v[176:179]
  ds_read_b64_tr_b16 a[154:155], v225 offset:46656
  v_mfma_f32_16x16x32_bf16 v[180:183], a[156:159], a[36:39], v[180:183]
  v_mfma_f32_16x16x32_bf16 v[184:187], a[156:159], a[40:43], v[184:187]
  v_mfma_f32_16x16x32_bf16 v[188:191], a[156:159], a[44:47], v[188:191]
  ds_read_b64_tr_b16 a[156:157], v225 offset:50240
  s_waitcnt lgkmcnt(13)
  v_mfma_f32_16x16x32_bf16 v[192:195], a[128:131], a[32:35], v[192:195]
  s_add_u32 s28, s22, 114688
  ds_read_b64_tr_b16 a[158:159], v225 offset:53824
  v_mfma_f32_16x16x32_bf16 v[196:199], a[128:131], a[36:39], v[196:199]
  buffer_load_dwordx4 a[112:115], v224, s[12:15], s28 offen offset:0 sc1
  v_mfma_f32_16x16x32_bf16 v[200:203], a[128:131], a[40:43], v[200:203]
  v_mfma_f32_16x16x32_bf16 v[204:207], a[128:131], a[44:47], v[204:207]
  ds_read_b64_tr_b16 a[128:129], v225 offset:43104
  s_waitcnt lgkmcnt(13)
  v_mfma_f32_16x16x32_bf16 v[208:211], a[132:135], a[32:35], v[208:211]
  s_add_u32 s28, s22, 114688
  ds_read_b64_tr_b16 a[130:131], v225 offset:46688
  v_mfma_f32_16x16x32_bf16 v[212:215], a[132:135], a[36:39], v[212:215]
  buffer_load_dwordx4 a[116:119], v224, s[12:15], s28 offen offset:1024 sc1
  v_mfma_f32_16x16x32_bf16 v[216:219], a[132:135], a[40:43], v[216:219]
  v_mfma_f32_16x16x32_bf16 v[220:223], a[132:135], a[44:47], v[220:223]
  ds_read_b64_tr_b16 a[132:133], v225 offset:50272
  s_waitcnt vmcnt(31) lgkmcnt(13)
  v_mfma_f32_16x16x32_bf16 v[0:3], a[136:139], a[48:51], v[0:3]
  s_add_u32 s28, s22, 114688
  ds_read_b64_tr_b16 a[134:135], v225 offset:53856
  s_waitcnt vmcnt(30)
  v_mfma_f32_16x16x32_bf16 v[4:7], a[136:139], a[52:55], v[4:7]
  buffer_load_dwordx4 a[120:123], v224, s[12:15], s28 offen offset:2048 sc1
  s_waitcnt vmcnt(30)
  v_mfma_f32_16x16x32_bf16 v[8:11], a[136:139], a[56:59], v[8:11]
  s_waitcnt vmcnt(29)
  v_mfma_f32_16x16x32_bf16 v[12:15], a[136:139], a[60:63], v[12:15]
  ds_read_b64_tr_b16 a[136:137], v225 offset:43136
  s_waitcnt lgkmcnt(13)
  v_mfma_f32_16x16x32_bf16 v[16:19], a[140:143], a[48:51], v[16:19]
  ds_read_b64_tr_b16 a[138:139], v225 offset:46720
  v_mfma_f32_16x16x32_bf16 v[20:23], a[140:143], a[52:55], v[20:23]
  s_add_u32 s28, s22, 114688
  v_mfma_f32_16x16x32_bf16 v[24:27], a[140:143], a[56:59], v[24:27]
  buffer_load_dwordx4 a[124:127], v224, s[12:15], s28 offen offset:3072 sc1
  v_mfma_f32_16x16x32_bf16 v[28:31], a[140:143], a[60:63], v[28:31]
  ds_read_b64_tr_b16 a[140:141], v225 offset:50304
  s_waitcnt lgkmcnt(13)
  v_mfma_f32_16x16x32_bf16 v[32:35], a[144:147], a[48:51], v[32:35]
  ds_read_b64_tr_b16 a[142:143], v225 offset:53888
  v_mfma_f32_16x16x32_bf16 v[36:39], a[144:147], a[52:55], v[36:39]
  v_mfma_f32_16x16x32_bf16 v[40:43], a[144:147], a[56:59], v[40:43]
  v_mfma_f32_16x16x32_bf16 v[44:47], a[144:147], a[60:63], v[44:47]
  ds_read_b64_tr_b16 a[144:145], v225 offset:43168
  s_waitcnt lgkmcnt(13)
  v_mfma_f32_16x16x32_bf16 v[48:51], a[148:151], a[48:51], v[48:51]
  s_add_u32 m0, s52, 0
  s_add_u32 s57, s53, 1835008
  ds_read_b64_tr_b16 a[146:147], v225 offset:46752
  v_mfma_f32_16x16x32_bf16 v[52:55], a[148:151], a[52:55], v[52:55]
  buffer_load_dwordx4 v228, s[48:51], s57 offen lds
  v_mfma_f32_16x16x32_bf16 v[56:59], a[148:151], a[56:59], v[56:59]
  v_mfma_f32_16x16x32_bf16 v[60:63], a[148:151], a[60:63], v[60:63]
  ds_read_b64_tr_b16 a[148:149], v225 offset:50336
  s_waitcnt lgkmcnt(13)
  v_mfma_f32_16x16x32_bf16 v[64:67], a[152:155], a[48:51], v[64:67]
  s_add_u32 m0, s52, 1024
  s_add_u32 s57, s53, 1835008
  ds_read_b64_tr_b16 a[150:151], v225 offset:53920
  v_mfma_f32_16x16x32_bf16 v[68:71], a[152:155], a[52:55], v[68:71]
  buffer_load_dwordx4 v229, s[48:51], s57 offen lds
  v_mfma_f32_16x16x32_bf16 v[72:75], a[152:155], a[56:59], v[72:75]
  v_mfma_f32_16x16x32_bf16 v[76:79], a[152:155], a[60:63], v[76:79]
  ds_read_b64_tr_b16 a[152:153], v225 offset:43200
  s_waitcnt lgkmcnt(13)
  v_mfma_f32_16x16x32_bf16 v[80:83], a[156:159], a[48:51], v[80:83]
  ds_read_b64_tr_b16 a[154:155], v225 offset:46784
  v_mfma_f32_16x16x32_bf16 v[84:87], a[156:159], a[52:55], v[84:87]
  s_add_u32 m0, s52, 2048
  s_add_u32 s57, s53, 1835008
  v_mfma_f32_16x16x32_bf16 v[88:91], a[156:159], a[56:59], v[88:91]
  buffer_load_dwordx4 v230, s[48:51], s57 offen lds
  v_mfma_f32_16x16x32_bf16 v[92:95], a[156:159], a[60:63], v[92:95]
  ds_read_b64_tr_b16 a[156:157], v225 offset:50368
  s_waitcnt lgkmcnt(13)
  v_mfma_f32_16x16x32_bf16 v[96:99], a[128:131], a[48:51], v[96:99]
  ds_read_b64_tr_b16 a[158:159], v225 offset:53952
  v_mfma_f32_16x16x32_bf16 v[100:103], a[128:131], a[52:55], v[100:103]
  v_mfma_f32_16x16x32_bf16 v[104:107], a[128:131], a[56:59], v[104:107]
  v_mfma_f32_16x16x32_bf16 v[108:111], a[128:131], a[60:63], v[108:111]
  s_waitcnt lgkmcnt(12)
  v_mfma_f32_16x16x32_bf16 v[112:115], a[132:135], a[48:51], v[112:115]
  s_add_u32 m0, s52, 3072
  s_add_u32 s57, s53, 1835008
  v_mfma_f32_16x16x32_bf16 v[116:119], a[132:135], a[52:55], v[116:119]
  buffer_load_dwordx4 v231, s[48:51], s57 offen lds
  v_mfma_f32_16x16x32_bf16 v[120:123], a[132:135], a[56:59], v[120:123]
  v_mfma_f32_16x16x32_bf16 v[124:127], a[132:135], a[60:63], v[124:127]
  s_waitcnt lgkmcnt(10)
  v_mfma_f32_16x16x32_bf16 v[128:131], a[136:139], a[48:51], v[128:131]
  s_add_u32 m0, s52, 4096
  s_add_u32 s57, s53, 1835008
  v_mfma_f32_16x16x32_bf16 v[132:135], a[136:139], a[52:55], v[132:135]
  buffer_load_dwordx4 v232, s[48:51], s57 offen lds
  v_mfma_f32_16x16x32_bf16 v[136:139], a[136:139], a[56:59], v[136:139]
  v_mfma_f32_16x16x32_bf16 v[140:143], a[136:139], a[60:63], v[140:143]
  s_waitcnt vmcnt(28) lgkmcnt(0)
  s_barrier
  ds_read_b64_tr_b16 a[128:129], v226 offset:0
  v_mfma_f32_16x16x32_bf16 v[144:147], a[140:143], a[48:51], v[144:147]
  ds_read_b64_tr_b16 a[130:131], v226 offset:3584
  v_mfma_f32_16x16x32_bf16 v[148:151], a[140:143], a[52:55], v[148:151]
  s_add_u32 m0, s52, 5120
  s_add_u32 s57, s53, 1835008
  ds_read_b64_tr_b16 a[132:133], v226 offset:7168
  v_mfma_f32_16x16x32_bf16 v[152:155], a[140:143], a[56:59], v[152:155]
  buffer_load_dwordx4 v233, s[48:51], s57 offen lds
  v_mfma_f32_16x16x32_bf16 v[156:159], a[140:143], a[60:63], v[156:159]
  ds_read_b64_tr_b16 a[134:135], v226 offset:10752
  v_mfma_f32_16x16x32_bf16 v[160:163], a[144:147], a[48:51], v[160:163]
  ds_read_b64_tr_b16 a[136:137], v226 offset:32
  v_mfma_f32_16x16x32_bf16 v[164:167], a[144:147], a[52:55], v[164:167]
  ds_read_b64_tr_b16 a[138:139], v226 offset:3616
  v_mfma_f32_16x16x32_bf16 v[168:171], a[144:147], a[56:59], v[168:171]
  ds_read_b64_tr_b16 a[140:141], v226 offset:7200
  v_mfma_f32_16x16x32_bf16 v[172:175], a[144:147], a[60:63], v[172:175]
  ds_read_b64_tr_b16 a[142:143], v226 offset:10784
  v_mfma_f32_16x16x32_bf16 v[176:179], a[148:151], a[48:51], v[176:179]
  s_add_u32 m0, s52, 6144
  s_add_u32 s57, s53, 1835008
  ds_read_b64_tr_b16 a[144:145], v226 offset:64
  v_mfma_f32_16x16x32_bf16 v[180:183], a[148:151], a[52:55], v[180:183]
  buffer_load_dwordx4 v234, s[48:51], s57 offen lds
  v_mfma_f32_16x16x32_bf16 v[184:187], a[148:151], a[56:59], v[184:187]
  ds_read_b64_tr_b16 a[146:147], v226 offset:3648
  v_mfma_f32_16x16x32_bf16 v[188:191], a[148:151], a[60:63], v[188:191]
  ds_read_b64_tr_b16 a[148:149], v226 offset:7232
  v_mfma_f32_16x16x32_bf16 v[192:195], a[152:155], a[48:51], v[192:195]
  s_add_u32 s28, s22, 131072
  ds_read_b64_tr_b16 a[150:151], v226 offset:10816
  v_mfma_f32_16x16x32_bf16 v[196:199], a[152:155], a[52:55], v[196:199]
  buffer_load_dwordx4 a[0:3], v224, s[12:15], s28 offen offset:0 sc1
  v_mfma_f32_16x16x32_bf16 v[200:203], a[152:155], a[56:59], v[200:203]
  v_mfma_f32_16x16x32_bf16 v[204:207], a[152:155], a[60:63], v[204:207]
  ds_read_b64_tr_b16 a[152:153], v226 offset:96
  v_mfma_f32_16x16x32_bf16 v[208:211], a[156:159], a[48:51], v[208:211]
  ds_read_b64_tr_b16 a[154:155], v226 offset:3680
  v_mfma_f32_16x16x32_bf16 v[212:215], a[156:159], a[52:55], v[212:215]
  s_add_u32 s28, s22, 131072
  v_mfma_f32_16x16x32_bf16 v[216:219], a[156:159], a[56:59], v[216:219]
  buffer_load_dwordx4 a[4:7], v224, s[12:15], s28 offen offset:1024 sc1
  v_mfma_f32_16x16x32_bf16 v[220:223], a[156:159], a[60:63], v[220:223]
  ds_read_b64_tr_b16 a[156:157], v226 offset:7264
  s_waitcnt vmcnt(31) lgkmcnt(13)
  v_mfma_f32_16x16x32_bf16 v[0:3], a[128:131], a[64:67], v[0:3]
  ds_read_b64_tr_b16 a[158:159], v226 offset:10848
  s_waitcnt vmcnt(30)
  v_mfma_f32_16x16x32_bf16 v[4:7], a[128:131], a[68:71], v[4:7]
  s_waitcnt vmcnt(29)
  v_mfma_f32_16x16x32_bf16 v[8:11], a[128:131], a[72:75], v[8:11]
  s_waitcnt vmcnt(28)
  v_mfma_f32_16x16x32_bf16 v[12:15], a[128:131], a[76:79], v[12:15]
  ds_read_b64_tr_b16 a[128:129], v226 offset:128
  s_waitcnt lgkmcnt(13)
  v_mfma_f32_16x16x32_bf16 v[16:19], a[132:135], a[64:67], v[16:19]
  s_add_u32 s28, s22, 131072
  ds_read_b64_tr_b16 a[130:131], v226 offset:3712
  v_mfma_f32_16x16x32_bf16 v[20:23], a[132:135], a[68:71], v[20:23]
  buffer_load_dwordx4 a[8:11], v224, s[12:15], s28 offen offset:2048 sc1
  v_mfma_f32_16x16x32_bf16 v[24:27], a[132:135], a[72:75], v[24:27]
  v_mfma_f32_16x16x32_bf16 v[28:31], a[132:135], a[76:79], v[28:31]
  ds_read_b64_tr_b16 a[132:133], v226 offset:7296
  s_waitcnt lgkmcnt(13)
  v_mfma_f32_16x16x32_bf16 v[32:35], a[136:139], a[64:67], v[32:35]
  s_add_u32 s28, s22, 131072
  ds_read_b64_tr_b16 a[134:135], v226 offset:10880
  v_mfma_f32_16x16x32_bf16 v[36:39], a[136:139], a[68:71], v[36:39]
  buffer_load_dwordx4 a[12:15], v224, s[12:15], s28 offen offset:3072 sc1
  v_mfma_f32_16x16x32_bf16 v[40:43], a[136:139], a[72:75], v[40:43]
  v_mfma_f32_16x16x32_bf16 v[44:47], a[136:139], a[76:79], v[44:47]
  ds_read_b64_tr_b16 a[136:137], v226 offset:160
  s_waitcnt lgkmcnt(13)
  v_mfma_f32_16x16x32_bf16 v[48:51], a[140:143], a[64:67], v[48:51]
  ds_read_b64_tr_b16 a[138:139], v226 offset:3744
  v_mfma_f32_16x16x32_bf16 v[52:55], a[140:143], a[68:71], v[52:55]
  s_add_u32 m0, s52, 28672
  s_add_u32 s57, s53, 2293760
  v_mfma_f32_16x16x32_bf16 v[56:59], a[140:143], a[72:75], v[56:59]
  buffer_load_dwordx4 v228, s[48:51], s57 offen lds
  v_mfma_f32_16x16x32_bf16 v[60:63], a[140:143], a[76:79], v[60:63]
  ds_read_b64_tr_b16 a[140:141], v226 offset:7328
  s_waitcnt lgkmcnt(13)
  v_mfma_f32_16x16x32_bf16 v[64:67], a[144:147], a[64:67], v[64:67]
  ds_read_b64_tr_b16 a[142:143], v226 offset:10912
  v_mfma_f32_16x16x32_bf16 v[68:71], a[144:147], a[68:71], v[68:71]
  v_mfma_f32_16x16x32_bf16 v[72:75], a[144:147], a[72:75], v[72:75]
  v_mfma_f32_16x16x32_bf16 v[76:79], a[144:147], a[76:79], v[76:79]
  ds_read_b64_tr_b16 a[144:145], v226 offset:192
  s_waitcnt lgkmcnt(13)
  v_mfma_f32_16x16x32_bf16 v[80:83], a[148:151], a[64:67], v[80:83]
  s_add_u32 m0, s52, 29696
  s_add_u32 s57, s53, 2293760
  ds_read_b64_tr_b16 a[146:147], v226 offset:3776
  v_mfma_f32_16x16x32_bf16 v[84:87], a[148:151], a[68:71], v[84:87]
  buffer_load_dwordx4 v229, s[48:51], s57 offen lds
  v_mfma_f32_16x16x32_bf16 v[88:91], a[148:151], a[72:75], v[88:91]
  v_mfma_f32_16x16x32_bf16 v[92:95], a[148:151], a[76:79], v[92:95]
  ds_read_b64_tr_b16 a[148:149], v226 offset:7360
  s_waitcnt lgkmcnt(13)
  v_mfma_f32_16x16x32_bf16 v[96:99], a[152:155], a[64:67], v[96:99]
  s_add_u32 m0, s52, 30720
  s_add_u32 s57, s53, 2293760
  ds_read_b64_tr_b16 a[150:151], v226 offset:10944
  v_mfma_f32_16x16x32_bf16 v[100:103], a[152:155], a[68:71], v[100:103]
  buffer_load_dwordx4 v230, s[48:51], s57 offen lds
  v_mfma_f32_16x16x32_bf16 v[104:107], a[152:155], a[72:75], v[104:107]
  v_mfma_f32_16x16x32_bf16 v[108:111], a[152:155], a[76:79], v[108:111]
  ds_read_b64_tr_b16 a[152:153], v226 offset:14336
  s_waitcnt lgkmcnt(13)
  v_mfma_f32_16x16x32_bf16 v[112:115], a[156:159], a[64:67], v[112:115]
  ds_read_b64_tr_b16 a[154:155], v226 offset:17920
  v_mfma_f32_16x16x32_bf16 v[116:119], a[156:159], a[68:71], v[116:119]
  s_add_u32 m0, s52, 31744
  s_add_u32 s57, s53, 2293760
  v_mfma_f32_16x16x32_bf16 v[120:123], a[156:159], a[72:75], v[120:123]
  buffer_load_dwordx4 v231, s[48:51], s57 offen lds
  v_mfma_f32_16x16x32_bf16 v[124:127], a[156:159], a[76:79], v[124:127]
  ds_read_b64_tr_b16 a[156:157], v226 offset:21504
  s_waitcnt lgkmcnt(13)
  v_mfma_f32_16x16x32_bf16 v[128:131], a[128:131], a[64:67], v[128:131]
  ds_read_b64_tr_b16 a[158:159], v226 offset:25088
  v_mfma_f32_16x16x32_bf16 v[132:135], a[128:131], a[68:71], v[132:135]
  v_mfma_f32_16x16x32_bf16 v[136:139], a[128:131], a[72:75], v[136:139]
  v_mfma_f32_16x16x32_bf16 v[140:143], a[128:131], a[76:79], v[140:143]
  ds_read_b64_tr_b16 a[128:129], v226 offset:14368
  s_waitcnt lgkmcnt(13)
  v_mfma_f32_16x16x32_bf16 v[144:147], a[132:135], a[64:67], v[144:147]
  s_add_u32 m0, s52, 32768
  s_add_u32 s57, s53, 2293760
  ds_read_b64_tr_b16 a[130:131], v226 offset:17952
  v_mfma_f32_16x16x32_bf16 v[148:151], a[132:135], a[68:71], v[148:151]
  buffer_load_dwordx4 v232, s[48:51], s57 offen lds
  v_mfma_f32_16x16x32_bf16 v[152:155], a[132:135], a[72:75], v[152:155]
  v_mfma_f32_16x16x32_bf16 v[156:159], a[132:135], a[76:79], v[156:159]
  ds_read_b64_tr_b16 a[132:133], v226 offset:21536
  s_waitcnt lgkmcnt(13)
  v_mfma_f32_16x16x32_bf16 v[160:163], a[136:139], a[64:67], v[160:163]
  s_add_u32 s28, s22, 147456
  ds_read_b64_tr_b16 a[134:135], v226 offset:25120
  v_mfma_f32_16x16x32_bf16 v[164:167], a[136:139], a[68:71], v[164:167]
  buffer_load_dwordx4 a[16:19], v224, s[12:15], s28 offen offset:0 sc1
  v_mfma_f32_16x16x32_bf16 v[168:171], a[136:139], a[72:75], v[168:171]
  v_mfma_f32_16x16x32_bf16 v[172:175], a[136:139], a[76:79], v[172:175]
  ds_read_b64_tr_b16 a[136:137], v226 offset:14400
  s_waitcnt lgkmcnt(13)
  v_mfma_f32_16x16x32_bf16 v[176:179], a[140:143], a[64:67], v[176:179]
  ds_read_b64_tr_b16 a[138:139], v226 offset:17984
  v_mfma_f32_16x16x32_bf16 v[180:183], a[140:143], a[68:71], v[180:183]
  s_add_u32 s28, s22, 147456
  v_mfma_f32_16x16x32_bf16 v[184:187], a[140:143], a[72:75], v[184:187]
  buffer_load_dwordx4 a[20:23], v224, s[12:15], s28 offen offset:1024 sc1
  v_mfma_f32_16x16x32_bf16 v[188:191], a[140:143], a[76:79], v[188:191]
  ds_read_b64_tr_b16 a[140:141], v226 offset:21568
  s_waitcnt lgkmcnt(13)
  v_mfma_f32_16x16x32_bf16 v[192:195], a[144:147], a[64:67], v[192:195]
  ds_read_b64_tr_b16 a[142:143], v226 offset:25152
  v_mfma_f32_16x16x32_bf16 v[196:199], a[144:147], a[68:71], v[196:199]
  v_mfma_f32_16x16x32_bf16 v[200:203], a[144:147], a[72:75], v[200:203]
  v_mfma_f32_16x16x32_bf16 v[204:207], a[144:147], a[76:79], v[204:207]
  ds_read_b64_tr_b16 a[144:145], v226 offset:14432
  s_waitcnt lgkmcnt(13)
  v_mfma_f32_16x16x32_bf16 v[208:211], a[148:151], a[64:67], v[208:211]
  s_add_u32 s28, s22, 147456
  ds_read_b64_tr_b16 a[146:147], v226 offset:18016
  v_mfma_f32_16x16x32_bf16 v[212:215], a[148:151], a[68:71], v[212:215]
  buffer_load_dwordx4 a[24:27], v224, s[12:15], s28 offen offset:2048 sc1
  v_mfma_f32_16x16x32_bf16 v[216:219], a[148:151], a[72:75], v[216:219]
  v_mfma_f32_16x16x32_bf16 v[220:223], a[148:151], a[76:79], v[220:223]
  ds_read_b64_tr_b16 a[148:149], v226 offset:21600
  s_waitcnt vmcnt(37) lgkmcnt(13)
  v_mfma_f32_16x16x32_bf16 v[0:3], a[152:155], a[80:83], v[0:3]
  s_add_u32 s28, s22, 147456
  ds_read_b64_tr_b16 a[150:151], v226 offset:25184
  s_waitcnt vmcnt(36)
  v_mfma_f32_16x16x32_bf16 v[4:7], a[152:155], a[84:87], v[4:7]
  buffer_load_dwordx4 a[28:31], v224, s[12:15], s28 offen offset:3072 sc1
  s_waitcnt vmcnt(36)
  v_mfma_f32_16x16x32_bf16 v[8:11], a[152:155], a[88:91], v[8:11]
  s_waitcnt vmcnt(35)
  v_mfma_f32_16x16x32_bf16 v[12:15], a[152:155], a[92:95], v[12:15]
  ds_read_b64_tr_b16 a[152:153], v226 offset:14464
  s_waitcnt lgkmcnt(13)
  v_mfma_f32_16x16x32_bf16 v[16:19], a[156:159], a[80:83], v[16:19]
  ds_read_b64_tr_b16 a[154:155], v226 offset:18048
  v_mfma_f32_16x16x32_bf16 v[20:23], a[156:159], a[84:87], v[20:23]
  s_add_u32 m0, s52, 33792
  s_add_u32 s57, s53, 2293760
  v_mfma_f32_16x16x32_bf16 v[24:27], a[156:159], a[88:91], v[24:27]
  buffer_load_dwordx4 v233, s[48:51], s57 offen lds
  v_mfma_f32_16x16x32_bf16 v[28:31], a[156:159], a[92:95], v[28:31]
  ds_read_b64_tr_b16 a[156:157], v226 offset:21632
  s_waitcnt lgkmcnt(13)
  v_mfma_f32_16x16x32_bf16 v[32:35], a[128:131], a[80:83], v[32:35]
  ds_read_b64_tr_b16 a[158:159], v226 offset:25216
  v_mfma_f32_16x16x32_bf16 v[36:39], a[128:131], a[84:87], v[36:39]
  v_mfma_f32_16x16x32_bf16 v[40:43], a[128:131], a[88:91], v[40:43]
  v_mfma_f32_16x16x32_bf16 v[44:47], a[128:131], a[92:95], v[44:47]
  ds_read_b64_tr_b16 a[128:129], v226 offset:14496
  s_waitcnt lgkmcnt(13)
  v_mfma_f32_16x16x32_bf16 v[48:51], a[132:135], a[80:83], v[48:51]
  s_add_u32 m0, s52, 34816
  s_add_u32 s57, s53, 2293760
  ds_read_b64_tr_b16 a[130:131], v226 offset:18080
  v_mfma_f32_16x16x32_bf16 v[52:55], a[132:135], a[84:87], v[52:55]
  buffer_load_dwordx4 v234, s[48:51], s57 offen lds
  v_mfma_f32_16x16x32_bf16 v[56:59], a[132:135], a[88:91], v[56:59]
  v_mfma_f32_16x16x32_bf16 v[60:63], a[132:135], a[92:95], v[60:63]
  ds_read_b64_tr_b16 a[132:133], v226 offset:21664
  s_waitcnt lgkmcnt(13)
  v_mfma_f32_16x16x32_bf16 v[64:67], a[136:139], a[80:83], v[64:67]
  s_add_u32 s28, s22, 163840
  ds_read_b64_tr_b16 a[134:135], v226 offset:25248
  v_mfma_f32_16x16x32_bf16 v[68:71], a[136:139], a[84:87], v[68:71]
  buffer_load_dwordx4 a[32:35], v224, s[12:15], s28 offen offset:0 sc1
  v_mfma_f32_16x16x32_bf16 v[72:75], a[136:139], a[88:91], v[72:75]
  v_mfma_f32_16x16x32_bf16 v[76:79], a[136:139], a[92:95], v[76:79]
  ds_read_b64_tr_b16 a[136:137], v226 offset:14528
  s_waitcnt lgkmcnt(13)
  v_mfma_f32_16x16x32_bf16 v[80:83], a[140:143], a[80:83], v[80:83]
  ds_read_b64_tr_b16 a[138:139], v226 offset:18112
  v_mfma_f32_16x16x32_bf16 v[84:87], a[140:143], a[84:87], v[84:87]
  s_add_u32 s28, s22, 163840
  v_mfma_f32_16x16x32_bf16 v[88:91], a[140:143], a[88:91], v[88:91]
  buffer_load_dwordx4 a[36:39], v224, s[12:15], s28 offen offset:1024 sc1
  v_mfma_f32_16x16x32_bf16 v[92:95], a[140:143], a[92:95], v[92:95]
  ds_read_b64_tr_b16 a[140:141], v226 offset:21696
  s_waitcnt lgkmcnt(13)
  v_mfma_f32_16x16x32_bf16 v[96:99], a[144:147], a[80:83], v[96:99]
  ds_read_b64_tr_b16 a[142:143], v226 offset:25280
  v_mfma_f32_16x16x32_bf16 v[100:103], a[144:147], a[84:87], v[100:103]
  v_mfma_f32_16x16x32_bf16 v[104:107], a[144:147], a[88:91], v[104:107]
  v_mfma_f32_16x16x32_bf16 v[108:111], a[144:147], a[92:95], v[108:111]
  s_waitcnt lgkmcnt(12)
  v_mfma_f32_16x16x32_bf16 v[112:115], a[148:151], a[80:83], v[112:115]
  s_add_u32 s28, s22, 163840
  v_mfma_f32_16x16x32_bf16 v[116:119], a[148:151], a[84:87], v[116:119]
  buffer_load_dwordx4 a[40:43], v224, s[12:15], s28 offen offset:2048 sc1
  v_mfma_f32_16x16x32_bf16 v[120:123], a[148:151], a[88:91], v[120:123]
  v_mfma_f32_16x16x32_bf16 v[124:127], a[148:151], a[92:95], v[124:127]
  s_waitcnt lgkmcnt(10)
  v_mfma_f32_16x16x32_bf16 v[128:131], a[152:155], a[80:83], v[128:131]
  s_add_u32 s28, s22, 163840
  v_mfma_f32_16x16x32_bf16 v[132:135], a[152:155], a[84:87], v[132:135]
  buffer_load_dwordx4 a[44:47], v224, s[12:15], s28 offen offset:3072 sc1
  v_mfma_f32_16x16x32_bf16 v[136:139], a[152:155], a[88:91], v[136:139]
  v_mfma_f32_16x16x32_bf16 v[140:143], a[152:155], a[92:95], v[140:143]
  s_waitcnt vmcnt(34) lgkmcnt(0)
  s_barrier
  ds_read_b64_tr_b16 a[144:145], v226 offset:28672
  v_mfma_f32_16x16x32_bf16 v[144:147], a[156:159], a[80:83], v[144:147]
  ds_read_b64_tr_b16 a[146:147], v226 offset:32256
  v_mfma_f32_16x16x32_bf16 v[148:151], a[156:159], a[84:87], v[148:151]
  s_add_u32 m0, s52, 57344
  s_add_u32 s57, s53, 2752512
  ds_read_b64_tr_b16 a[148:149], v226 offset:35840
  v_mfma_f32_16x16x32_bf16 v[152:155], a[156:159], a[88:91], v[152:155]
  buffer_load_dwordx4 v228, s[48:51], s57 offen lds
  v_mfma_f32_16x16x32_bf16 v[156:159], a[156:159], a[92:95], v[156:159]
  ds_read_b64_tr_b16 a[150:151], v226 offset:39424
  v_mfma_f32_16x16x32_bf16 v[160:163], a[128:131], a[80:83], v[160:163]
  ds_read_b64_tr_b16 a[152:153], v226 offset:28704
  v_mfma_f32_16x16x32_bf16 v[164:167], a[128:131], a[84:87], v[164:167]
  ds_read_b64_tr_b16 a[154:155], v226 offset:32288
  v_mfma_f32_16x16x32_bf16 v[168:171], a[128:131], a[88:91], v[168:171]
  ds_read_b64_tr_b16 a[156:157], v226 offset:35872
  v_mfma_f32_16x16x32_bf16 v[172:175], a[128:131], a[92:95], v[172:175]
  ds_read_b64_tr_b16 a[158:159], v226 offset:39456
  v_mfma_f32_16x16x32_bf16 v[176:179], a[132:135], a[80:83], v[176:179]
  s_add_u32 m0, s52, 58368
  s_add_u32 s57, s53, 2752512
  ds_read_b64_tr_b16 a[128:129], v226 offset:28736
  v_mfma_f32_16x16x32_bf16 v[180:183], a[132:135], a[84:87], v[180:183]
  buffer_load_dwordx4 v229, s[48:51], s57 offen lds
  v_mfma_f32_16x16x32_bf16 v[184:187], a[132:135], a[88:91], v[184:187]
  ds_read_b64_tr_b16 a[130:131], v226 offset:32320
  v_mfma_f32_16x16x32_bf16 v[188:191], a[132:135], a[92:95], v[188:191]
  ds_read_b64_tr_b16 a[132:133], v226 offset:35904
  v_mfma_f32_16x16x32_bf16 v[192:195], a[136:139], a[80:83], v[192:195]
  ds_read_b64_tr_b16 a[134:135], v226 offset:39488
  v_mfma_f32_16x16x32_bf16 v[196:199], a[136:139], a[84:87], v[196:199]
  v_mfma_f32_16x16x32_bf16 v[200:203], a[136:139], a[88:91], v[200:203]
  v_mfma_f32_16x16x32_bf16 v[204:207], a[136:139], a[92:95], v[204:207]
  ds_read_b64_tr_b16 a[136:137], v226 offset:28768
  v_mfma_f32_16x16x32_bf16 v[208:211], a[140:143], a[80:83], v[208:211]
  s_add_u32 m0, s52, 59392
  s_add_u32 s57, s53, 2752512
  ds_read_b64_tr_b16 a[138:139], v226 offset:32352
  v_mfma_f32_16x16x32_bf16 v[212:215], a[140:143], a[84:87], v[212:215]
  buffer_load_dwordx4 v230, s[48:51], s57 offen lds
  v_mfma_f32_16x16x32_bf16 v[216:219], a[140:143], a[88:91], v[216:219]
  v_mfma_f32_16x16x32_bf16 v[220:223], a[140:143], a[92:95], v[220:223]
  ds_read_b64_tr_b16 a[140:141], v226 offset:35936
  s_waitcnt vmcnt(36) lgkmcnt(13)
  v_mfma_f32_16x16x32_bf16 v[0:3], a[144:147], a[96:99], v[0:3]
  ds_read_b64_tr_b16 a[142:143], v226 offset:39520
  s_waitcnt vmcnt(35)
  v_mfma_f32_16x16x32_bf16 v[4:7], a[144:147], a[100:103], v[4:7]
  s_waitcnt vmcnt(34)
  v_mfma_f32_16x16x32_bf16 v[8:11], a[144:147], a[104:107], v[8:11]
  s_waitcnt vmcnt(33)
  v_mfma_f32_16x16x32_bf16 v[12:15], a[144:147], a[108:111], v[12:15]
  ds_read_b64_tr_b16 a[144:145], v226 offset:28800
  s_waitcnt lgkmcnt(13)
  v_mfma_f32_16x16x32_bf16 v[16:19], a[148:151], a[96:99], v[16:19]
  ds_read_b64_tr_b16 a[146:147], v226 offset:32384
  v_mfma_f32_16x16x32_bf16 v[20:23], a[148:151], a[100:103], v[20:23]
  v_mfma_f32_16x16x32_bf16 v[24:27], a[148:151], a[104:107], v[24:27]
  v_mfma_f32_16x16x32_bf16 v[28:31], a[148:151], a[108:111], v[28:31]
  ds_read_b64_tr_b16 a[148:149], v226 offset:35968
  s_waitcnt lgkmcnt(13)
  v_mfma_f32_16x16x32_bf16 v[32:35], a[152:155], a[96:99], v[32:35]
  s_add_u32 m0, s52, 60416
  s_add_u32 s57, s53, 2752512
  ds_read_b64_tr_b16 a[150:151], v226 offset:39552
  v_mfma_f32_16x16x32_bf16 v[36:39], a[152:155], a[100:103], v[36:39]
  buffer_load_dwordx4 v231, s[48:51], s57 offen lds
  v_mfma_f32_16x16x32_bf16 v[40:43], a[152:155], a[104:107], v[40:43]
  v_mfma_f32_16x16x32_bf16 v[44:47], a[152:155], a[108:111], v[44:47]
  ds_read_b64_tr_b16 a[152:153], v226 offset:28832
  s_waitcnt lgkmcnt(13)
  v_mfma_f32_16x16x32_bf16 v[48:51], a[156:159], a[96:99], v[48:51]
  s_add_u32 m0, s52, 61440
  s_add_u32 s57, s53, 2752512
  ds_read_b64_tr_b16 a[154:155], v226 offset:32416
  v_mfma_f32_16x16x32_bf16 v[52:55], a[156:159], a[100:103], v[52:55]
  buffer_load_dwordx4 v232, s[48:51], s57 offen lds
  v_mfma_f32_16x16x32_bf16 v[56:59], a[156:159], a[104:107], v[56:59]
  v_mfma_f32_16x16x32_bf16 v[60:63], a[156:159], a[108:111], v[60:63]
  ds_read_b64_tr_b16 a[156:157], v226 offset:36000
  s_waitcnt lgkmcnt(13)
  v_mfma_f32_16x16x32_bf16 v[64:67], a[128:131], a[96:99], v[64:67]
  ds_read_b64_tr_b16 a[158:159], v226 offset:39584
  v_mfma_f32_16x16x32_bf16 v[68:71], a[128:131], a[100:103], v[68:71]
  v_mfma_f32_16x16x32_bf16 v[72:75], a[128:131], a[104:107], v[72:75]
  v_mfma_f32_16x16x32_bf16 v[76:79], a[128:131], a[108:111], v[76:79]
  ds_read_b64_tr_b16 a[128:129], v226 offset:28864
  s_waitcnt lgkmcnt(13)
  v_mfma_f32_16x16x32_bf16 v[80:83], a[132:135], a[96:99], v[80:83]
  s_add_u32 m0, s52, 62464
  s_add_u32 s57, s53, 2752512
  ds_read_b64_tr_b16 a[130:131], v226 offset:32448
  v_mfma_f32_16x16x32_bf16 v[84:87], a[132:135], a[100:103], v[84:87]
  buffer_load_dwordx4 v233, s[48:51], s57 offen lds
  v_mfma_f32_16x16x32_bf16 v[88:91], a[132:135], a[104:107], v[88:91]
  v_mfma_f32_16x16x32_bf16 v[92:95], a[132:135], a[108:111], v[92:95]
  ds_read_b64_tr_b16 a[132:133], v226 offset:36032
  s_waitcnt lgkmcnt(13)
  v_mfma_f32_16x16x32_bf16 v[96:99], a[136:139], a[96:99], v[96:99]
  s_add_u32 m0, s52, 63488
  s_add_u32 s57, s53, 2752512
  ds_read_b64_tr_b16 a[134:135], v226 offset:39616
  v_mfma_f32_16x16x32_bf16 v[100:103], a[136:139], a[100:103], v[100:103]
  buffer_load_dwordx4 v234, s[48:51], s57 offen lds
  v_mfma_f32_16x16x32_bf16 v[104:107], a[136:139], a[104:107], v[104:107]
  v_mfma_f32_16x16x32_bf16 v[108:111], a[136:139], a[108:111], v[108:111]
  ds_read_b64_tr_b16 a[136:137], v226 offset:43008
  s_waitcnt lgkmcnt(13)
  v_mfma_f32_16x16x32_bf16 v[112:115], a[140:143], a[96:99], v[112:115]
  ds_read_b64_tr_b16 a[138:139], v226 offset:46592
  v_mfma_f32_16x16x32_bf16 v[116:119], a[140:143], a[100:103], v[116:119]
  v_mfma_f32_16x16x32_bf16 v[120:123], a[140:143], a[104:107], v[120:123]
  v_mfma_f32_16x16x32_bf16 v[124:127], a[140:143], a[108:111], v[124:127]
  ds_read_b64_tr_b16 a[140:141], v226 offset:50176
  s_waitcnt lgkmcnt(13)
  v_mfma_f32_16x16x32_bf16 v[128:131], a[144:147], a[96:99], v[128:131]
  ds_read_b64_tr_b16 a[142:143], v226 offset:53760
  v_mfma_f32_16x16x32_bf16 v[132:135], a[144:147], a[100:103], v[132:135]
  v_mfma_f32_16x16x32_bf16 v[136:139], a[144:147], a[104:107], v[136:139]
  v_mfma_f32_16x16x32_bf16 v[140:143], a[144:147], a[108:111], v[140:143]
  ds_read_b64_tr_b16 a[144:145], v226 offset:43040
  s_waitcnt lgkmcnt(13)
  v_mfma_f32_16x16x32_bf16 v[144:147], a[148:151], a[96:99], v[144:147]
  ds_read_b64_tr_b16 a[146:147], v226 offset:46624
  v_mfma_f32_16x16x32_bf16 v[148:151], a[148:151], a[100:103], v[148:151]
  v_mfma_f32_16x16x32_bf16 v[152:155], a[148:151], a[104:107], v[152:155]
  v_mfma_f32_16x16x32_bf16 v[156:159], a[148:151], a[108:111], v[156:159]
  ds_read_b64_tr_b16 a[148:149], v226 offset:50208
  s_waitcnt lgkmcnt(13)
  v_mfma_f32_16x16x32_bf16 v[160:163], a[152:155], a[96:99], v[160:163]
  s_add_u32 s28, s22, 180224
  ds_read_b64_tr_b16 a[150:151], v226 offset:53792
  v_mfma_f32_16x16x32_bf16 v[164:167], a[152:155], a[100:103], v[164:167]
  buffer_load_dwordx4 a[48:51], v224, s[12:15], s28 offen offset:0 sc1
  v_mfma_f32_16x16x32_bf16 v[168:171], a[152:155], a[104:107], v[168:171]
  v_mfma_f32_16x16x32_bf16 v[172:175], a[152:155], a[108:111], v[172:175]
  ds_read_b64_tr_b16 a[152:153], v226 offset:43072
  s_waitcnt lgkmcnt(13)
  v_mfma_f32_16x16x32_bf16 v[176:179], a[156:159], a[96:99], v[176:179]
  s_add_u32 s28, s22, 180224
  ds_read_b64_tr_b16 a[154:155], v226 offset:46656
  v_mfma_f32_16x16x32_bf16 v[180:183], a[156:159], a[100:103], v[180:183]
  buffer_load_dwordx4 a[52:55], v224, s[12:15], s28 offen offset:1024 sc1
  v_mfma_f32_16x16x32_bf16 v[184:187], a[156:159], a[104:107], v[184:187]
  v_mfma_f32_16x16x32_bf16 v[188:191], a[156:159], a[108:111], v[188:191]
  ds_read_b64_tr_b16 a[156:157], v226 offset:50240
  s_waitcnt lgkmcnt(13)
  v_mfma_f32_16x16x32_bf16 v[192:195], a[128:131], a[96:99], v[192:195]
  ds_read_b64_tr_b16 a[158:159], v226 offset:53824
  v_mfma_f32_16x16x32_bf16 v[196:199], a[128:131], a[100:103], v[196:199]
  s_add_u32 s28, s22, 180224
  v_mfma_f32_16x16x32_bf16 v[200:203], a[128:131], a[104:107], v[200:203]
  buffer_load_dwordx4 a[56:59], v224, s[12:15], s28 offen offset:2048 sc1
  v_mfma_f32_16x16x32_bf16 v[204:207], a[128:131], a[108:111], v[204:207]
  ds_read_b64_tr_b16 a[128:129], v226 offset:43104
  s_waitcnt lgkmcnt(13)
  v_mfma_f32_16x16x32_bf16 v[208:211], a[132:135], a[96:99], v[208:211]
  ds_read_b64_tr_b16 a[130:131], v226 offset:46688
  v_mfma_f32_16x16x32_bf16 v[212:215], a[132:135], a[100:103], v[212:215]
  v_mfma_f32_16x16x32_bf16 v[216:219], a[132:135], a[104:107], v[216:219]
  v_mfma_f32_16x16x32_bf16 v[220:223], a[132:135], a[108:111], v[220:223]
  ds_read_b64_tr_b16 a[132:133], v226 offset:50272
  s_waitcnt vmcnt(39) lgkmcnt(13)
  v_mfma_f32_16x16x32_bf16 v[0:3], a[136:139], a[112:115], v[0:3]
  s_add_u32 s28, s22, 180224
  ds_read_b64_tr_b16 a[134:135], v226 offset:53856
  s_waitcnt vmcnt(38)
  v_mfma_f32_16x16x32_bf16 v[4:7], a[136:139], a[116:119], v[4:7]
  buffer_load_dwordx4 a[60:63], v224, s[12:15], s28 offen offset:3072 sc1
  s_waitcnt vmcnt(38)
  v_mfma_f32_16x16x32_bf16 v[8:11], a[136:139], a[120:123], v[8:11]
  s_waitcnt vmcnt(37)
  v_mfma_f32_16x16x32_bf16 v[12:15], a[136:139], a[124:127], v[12:15]
  ds_read_b64_tr_b16 a[136:137], v226 offset:43136
  s_waitcnt lgkmcnt(13)
  v_mfma_f32_16x16x32_bf16 v[16:19], a[140:143], a[112:115], v[16:19]
  ds_read_b64_tr_b16 a[138:139], v226 offset:46720
  v_mfma_f32_16x16x32_bf16 v[20:23], a[140:143], a[116:119], v[20:23]
  v_mfma_f32_16x16x32_bf16 v[24:27], a[140:143], a[120:123], v[24:27]
  v_mfma_f32_16x16x32_bf16 v[28:31], a[140:143], a[124:127], v[28:31]
  ds_read_b64_tr_b16 a[140:141], v226 offset:50304
  s_waitcnt lgkmcnt(13)
  v_mfma_f32_16x16x32_bf16 v[32:35], a[144:147], a[112:115], v[32:35]
  ds_read_b64_tr_b16 a[142:143], v226 offset:53888
  v_mfma_f32_16x16x32_bf16 v[36:39], a[144:147], a[116:119], v[36:39]
  v_mfma_f32_16x16x32_bf16 v[40:43], a[144:147], a[120:123], v[40:43]
  v_mfma_f32_16x16x32_bf16 v[44:47], a[144:147], a[124:127], v[44:47]
  ds_read_b64_tr_b16 a[144:145], v226 offset:43168
  s_waitcnt lgkmcnt(13)
  v_mfma_f32_16x16x32_bf16 v[48:51], a[148:151], a[112:115], v[48:51]
  s_add_u32 s28, s22, 196608
  ds_read_b64_tr_b16 a[146:147], v226 offset:46752
  v_mfma_f32_16x16x32_bf16 v[52:55], a[148:151], a[116:119], v[52:55]
  buffer_load_dwordx4 a[64:67], v224, s[12:15], s28 offen offset:0 sc1
  v_mfma_f32_16x16x32_bf16 v[56:59], a[148:151], a[120:123], v[56:59]
  v_mfma_f32_16x16x32_bf16 v[60:63], a[148:151], a[124:127], v[60:63]
  ds_read_b64_tr_b16 a[148:149], v226 offset:50336
  s_waitcnt lgkmcnt(13)
  v_mfma_f32_16x16x32_bf16 v[64:67], a[152:155], a[112:115], v[64:67]
  ds_read_b64_tr_b16 a[150:151], v226 offset:53920
  v_mfma_f32_16x16x32_bf16 v[68:71], a[152:155], a[116:119], v[68:71]
  v_mfma_f32_16x16x32_bf16 v[72:75], a[152:155], a[120:123], v[72:75]
  v_mfma_f32_16x16x32_bf16 v[76:79], a[152:155], a[124:127], v[76:79]
  ds_read_b64_tr_b16 a[152:153], v226 offset:43200
  s_waitcnt lgkmcnt(13)
  v_mfma_f32_16x16x32_bf16 v[80:83], a[156:159], a[112:115], v[80:83]
  s_add_u32 s28, s22, 196608
  ds_read_b64_tr_b16 a[154:155], v226 offset:46784
  v_mfma_f32_16x16x32_bf16 v[84:87], a[156:159], a[116:119], v[84:87]
  buffer_load_dwordx4 a[68:71], v224, s[12:15], s28 offen offset:1024 sc1
  v_mfma_f32_16x16x32_bf16 v[88:91], a[156:159], a[120:123], v[88:91]
  v_mfma_f32_16x16x32_bf16 v[92:95], a[156:159], a[124:127], v[92:95]
  ds_read_b64_tr_b16 a[156:157], v226 offset:50368
  s_waitcnt lgkmcnt(13)
  v_mfma_f32_16x16x32_bf16 v[96:99], a[128:131], a[112:115], v[96:99]
  s_add_u32 s28, s22, 196608
  ds_read_b64_tr_b16 a[158:159], v226 offset:53952
  v_mfma_f32_16x16x32_bf16 v[100:103], a[128:131], a[116:119], v[100:103]
  buffer_load_dwordx4 a[72:75], v224, s[12:15], s28 offen offset:2048 sc1
  v_mfma_f32_16x16x32_bf16 v[104:107], a[128:131], a[120:123], v[104:107]
  v_mfma_f32_16x16x32_bf16 v[108:111], a[128:131], a[124:127], v[108:111]
  s_waitcnt lgkmcnt(12)
  v_mfma_f32_16x16x32_bf16 v[112:115], a[132:135], a[112:115], v[112:115]
  v_mfma_f32_16x16x32_bf16 v[116:119], a[132:135], a[116:119], v[116:119]
  v_mfma_f32_16x16x32_bf16 v[120:123], a[132:135], a[120:123], v[120:123]
  v_mfma_f32_16x16x32_bf16 v[124:127], a[132:135], a[124:127], v[124:127]
  s_waitcnt lgkmcnt(10)
  v_mfma_f32_16x16x32_bf16 v[128:131], a[136:139], a[112:115], v[128:131]
  s_add_u32 s28, s22, 196608
  v_mfma_f32_16x16x32_bf16 v[132:135], a[136:139], a[116:119], v[132:135]
  buffer_load_dwordx4 a[76:79], v224, s[12:15], s28 offen offset:3072 sc1
  v_mfma_f32_16x16x32_bf16 v[136:139], a[136:139], a[120:123], v[136:139]
  v_mfma_f32_16x16x32_bf16 v[140:143], a[136:139], a[124:127], v[140:143]
.p2align 6
fa_kernel_g1loop:
  s_waitcnt vmcnt(34) lgkmcnt(0)
  s_barrier
  ds_read_b64_tr_b16 a[128:129], v225 offset:0
  v_mfma_f32_16x16x32_bf16 v[144:147], a[140:143], a[112:115], v[144:147]
  ds_read_b64_tr_b16 a[130:131], v225 offset:3584
  v_mfma_f32_16x16x32_bf16 v[148:151], a[140:143], a[116:119], v[148:151]
  s_add_u32 m0, s52, 86016
  s_add_u32 s57, s53, 3211264
  ds_read_b64_tr_b16 a[132:133], v225 offset:7168
  v_mfma_f32_16x16x32_bf16 v[152:155], a[140:143], a[120:123], v[152:155]
  buffer_load_dwordx4 v228, s[48:51], s57 offen lds
  v_mfma_f32_16x16x32_bf16 v[156:159], a[140:143], a[124:127], v[156:159]
  ds_read_b64_tr_b16 a[134:135], v225 offset:10752
  v_mfma_f32_16x16x32_bf16 v[160:163], a[144:147], a[112:115], v[160:163]
  ds_read_b64_tr_b16 a[136:137], v225 offset:32
  v_mfma_f32_16x16x32_bf16 v[164:167], a[144:147], a[116:119], v[164:167]
  ds_read_b64_tr_b16 a[138:139], v225 offset:3616
  v_mfma_f32_16x16x32_bf16 v[168:171], a[144:147], a[120:123], v[168:171]
  ds_read_b64_tr_b16 a[140:141], v225 offset:7200
  v_mfma_f32_16x16x32_bf16 v[172:175], a[144:147], a[124:127], v[172:175]
  ds_read_b64_tr_b16 a[142:143], v225 offset:10784
  v_mfma_f32_16x16x32_bf16 v[176:179], a[148:151], a[112:115], v[176:179]
  s_add_u32 m0, s52, 87040
  s_add_u32 s57, s53, 3211264
  ds_read_b64_tr_b16 a[144:145], v225 offset:64
  v_mfma_f32_16x16x32_bf16 v[180:183], a[148:151], a[116:119], v[180:183]
  buffer_load_dwordx4 v229, s[48:51], s57 offen lds
  v_mfma_f32_16x16x32_bf16 v[184:187], a[148:151], a[120:123], v[184:187]
  ds_read_b64_tr_b16 a[146:147], v225 offset:3648
  v_mfma_f32_16x16x32_bf16 v[188:191], a[148:151], a[124:127], v[188:191]
  ds_read_b64_tr_b16 a[148:149], v225 offset:7232
  v_mfma_f32_16x16x32_bf16 v[192:195], a[152:155], a[112:115], v[192:195]
  ds_read_b64_tr_b16 a[150:151], v225 offset:10816
  v_mfma_f32_16x16x32_bf16 v[196:199], a[152:155], a[116:119], v[196:199]
  s_add_u32 m0, s52, 88064
  s_add_u32 s57, s53, 3211264
  v_mfma_f32_16x16x32_bf16 v[200:203], a[152:155], a[120:123], v[200:203]
  buffer_load_dwordx4 v230, s[48:51], s57 offen lds
  v_mfma_f32_16x16x32_bf16 v[204:207], a[152:155], a[124:127], v[204:207]
  ds_read_b64_tr_b16 a[152:153], v225 offset:96
  v_mfma_f32_16x16x32_bf16 v[208:211], a[156:159], a[112:115], v[208:211]
  ds_read_b64_tr_b16 a[154:155], v225 offset:3680
  v_mfma_f32_16x16x32_bf16 v[212:215], a[156:159], a[116:119], v[212:215]
  v_mfma_f32_16x16x32_bf16 v[216:219], a[156:159], a[120:123], v[216:219]
  v_mfma_f32_16x16x32_bf16 v[220:223], a[156:159], a[124:127], v[220:223]
  ds_read_b64_tr_b16 a[156:157], v225 offset:7264
  s_waitcnt vmcnt(36) lgkmcnt(13)
  v_mfma_f32_16x16x32_bf16 v[0:3], a[128:131], a[0:3], v[0:3]
  ds_read_b64_tr_b16 a[158:159], v225 offset:10848
  s_waitcnt vmcnt(35)
  v_mfma_f32_16x16x32_bf16 v[4:7], a[128:131], a[4:7], v[4:7]
  buffer_load_dword a176, v248, s[60:63], s64 offen
  s_waitcnt vmcnt(35)
  v_mfma_f32_16x16x32_bf16 v[8:11], a[128:131], a[8:11], v[8:11]
  s_waitcnt vmcnt(34)
  v_mfma_f32_16x16x32_bf16 v[12:15], a[128:131], a[12:15], v[12:15]
  ds_read_b64_tr_b16 a[128:129], v225 offset:128
  s_waitcnt lgkmcnt(13)
  v_mfma_f32_16x16x32_bf16 v[16:19], a[132:135], a[0:3], v[16:19]
  ds_read_b64_tr_b16 a[130:131], v225 offset:3712
  v_mfma_f32_16x16x32_bf16 v[20:23], a[132:135], a[4:7], v[20:23]
  s_add_u32 m0, s52, 89088
  s_add_u32 s57, s53, 3211264
  v_mfma_f32_16x16x32_bf16 v[24:27], a[132:135], a[8:11], v[24:27]
  buffer_load_dwordx4 v231, s[48:51], s57 offen lds
  v_mfma_f32_16x16x32_bf16 v[28:31], a[132:135], a[12:15], v[28:31]
  ds_read_b64_tr_b16 a[132:133], v225 offset:7296
  s_waitcnt lgkmcnt(13)
  v_mfma_f32_16x16x32_bf16 v[32:35], a[136:139], a[0:3], v[32:35]
  ds_read_b64_tr_b16 a[134:135], v225 offset:10880
  v_mfma_f32_16x16x32_bf16 v[36:39], a[136:139], a[4:7], v[36:39]
  v_mfma_f32_16x16x32_bf16 v[40:43], a[136:139], a[8:11], v[40:43]
  v_mfma_f32_16x16x32_bf16 v[44:47], a[136:139], a[12:15], v[44:47]
  ds_read_b64_tr_b16 a[136:137], v225 offset:160
  s_waitcnt lgkmcnt(13)
  v_mfma_f32_16x16x32_bf16 v[48:51], a[140:143], a[0:3], v[48:51]
  s_add_u32 m0, s52, 90112
  s_add_u32 s57, s53, 3211264
  ds_read_b64_tr_b16 a[138:139], v225 offset:3744
  v_mfma_f32_16x16x32_bf16 v[52:55], a[140:143], a[4:7], v[52:55]
  buffer_load_dwordx4 v232, s[48:51], s57 offen lds
  v_mfma_f32_16x16x32_bf16 v[56:59], a[140:143], a[8:11], v[56:59]
  v_mfma_f32_16x16x32_bf16 v[60:63], a[140:143], a[12:15], v[60:63]
  ds_read_b64_tr_b16 a[140:141], v225 offset:7328
  s_waitcnt lgkmcnt(13)
  v_mfma_f32_16x16x32_bf16 v[64:67], a[144:147], a[0:3], v[64:67]
  ds_read_b64_tr_b16 a[142:143], v225 offset:10912
  v_mfma_f32_16x16x32_bf16 v[68:71], a[144:147], a[4:7], v[68:71]
  v_mfma_f32_16x16x32_bf16 v[72:75], a[144:147], a[8:11], v[72:75]
  v_mfma_f32_16x16x32_bf16 v[76:79], a[144:147], a[12:15], v[76:79]
  ds_read_b64_tr_b16 a[144:145], v225 offset:192
  s_waitcnt lgkmcnt(13)
  v_mfma_f32_16x16x32_bf16 v[80:83], a[148:151], a[0:3], v[80:83]
  s_add_u32 m0, s52, 91136
  s_add_u32 s57, s53, 3211264
  ds_read_b64_tr_b16 a[146:147], v225 offset:3776
  v_mfma_f32_16x16x32_bf16 v[84:87], a[148:151], a[4:7], v[84:87]
  buffer_load_dwordx4 v233, s[48:51], s57 offen lds
  v_mfma_f32_16x16x32_bf16 v[88:91], a[148:151], a[8:11], v[88:91]
  v_mfma_f32_16x16x32_bf16 v[92:95], a[148:151], a[12:15], v[92:95]
  ds_read_b64_tr_b16 a[148:149], v225 offset:7360
  s_waitcnt lgkmcnt(13)
  v_mfma_f32_16x16x32_bf16 v[96:99], a[152:155], a[0:3], v[96:99]
  s_add_u32 m0, s52, 92160
  s_add_u32 s57, s53, 3211264
  ds_read_b64_tr_b16 a[150:151], v225 offset:10944
  v_mfma_f32_16x16x32_bf16 v[100:103], a[152:155], a[4:7], v[100:103]
  buffer_load_dwordx4 v234, s[48:51], s57 offen lds
  v_mfma_f32_16x16x32_bf16 v[104:107], a[152:155], a[8:11], v[104:107]
  v_mfma_f32_16x16x32_bf16 v[108:111], a[152:155], a[12:15], v[108:111]
  ds_read_b64_tr_b16 a[152:153], v225 offset:14336
  s_waitcnt lgkmcnt(13)
  v_mfma_f32_16x16x32_bf16 v[112:115], a[156:159], a[0:3], v[112:115]
  ds_read_b64_tr_b16 a[154:155], v225 offset:17920
  v_mfma_f32_16x16x32_bf16 v[116:119], a[156:159], a[4:7], v[116:119]
  v_mfma_f32_16x16x32_bf16 v[120:123], a[156:159], a[8:11], v[120:123]
  v_mfma_f32_16x16x32_bf16 v[124:127], a[156:159], a[12:15], v[124:127]
  ds_read_b64_tr_b16 a[156:157], v225 offset:21504
  s_waitcnt lgkmcnt(13)
  v_mfma_f32_16x16x32_bf16 v[128:131], a[128:131], a[0:3], v[128:131]
  s_add_u32 m0, s52, 114688
  ds_read_b64_tr_b16 a[158:159], v225 offset:25088
  v_mfma_f32_16x16x32_bf16 v[132:135], a[128:131], a[4:7], v[132:135]
  buffer_load_dwordx4 v228, s[48:51], s56 offen lds
  v_mfma_f32_16x16x32_bf16 v[136:139], a[128:131], a[8:11], v[136:139]
  v_mfma_f32_16x16x32_bf16 v[140:143], a[128:131], a[12:15], v[140:143]
  ds_read_b64_tr_b16 a[128:129], v225 offset:14368
  s_waitcnt lgkmcnt(13)
  v_mfma_f32_16x16x32_bf16 v[144:147], a[132:135], a[0:3], v[144:147]
  ds_read_b64_tr_b16 a[130:131], v225 offset:17952
  v_mfma_f32_16x16x32_bf16 v[148:151], a[132:135], a[4:7], v[148:151]
  s_add_u32 s28, s22, 212992
  v_mfma_f32_16x16x32_bf16 v[152:155], a[132:135], a[8:11], v[152:155]
  buffer_load_dwordx4 a[80:83], v224, s[12:15], s28 offen offset:0 sc1
  v_mfma_f32_16x16x32_bf16 v[156:159], a[132:135], a[12:15], v[156:159]
  ds_read_b64_tr_b16 a[132:133], v225 offset:21536
  s_waitcnt lgkmcnt(13)
  v_mfma_f32_16x16x32_bf16 v[160:163], a[136:139], a[0:3], v[160:163]
  ds_read_b64_tr_b16 a[134:135], v225 offset:25120
  v_mfma_f32_16x16x32_bf16 v[164:167], a[136:139], a[4:7], v[164:167]
  v_mfma_f32_16x16x32_bf16 v[168:171], a[136:139], a[8:11], v[168:171]
  v_mfma_f32_16x16x32_bf16 v[172:175], a[136:139], a[12:15], v[172:175]
  ds_read_b64_tr_b16 a[136:137], v225 offset:14400
  s_waitcnt lgkmcnt(13)
  v_mfma_f32_16x16x32_bf16 v[176:179], a[140:143], a[0:3], v[176:179]
  s_add_u32 s28, s22, 212992
  ds_read_b64_tr_b16 a[138:139], v225 offset:17984
  v_mfma_f32_16x16x32_bf16 v[180:183], a[140:143], a[4:7], v[180:183]
  buffer_load_dwordx4 a[84:87], v224, s[12:15], s28 offen offset:1024 sc1
  v_mfma_f32_16x16x32_bf16 v[184:187], a[140:143], a[8:11], v[184:187]
  v_mfma_f32_16x16x32_bf16 v[188:191], a[140:143], a[12:15], v[188:191]
  ds_read_b64_tr_b16 a[140:141], v225 offset:21568
  s_waitcnt lgkmcnt(13)
  v_mfma_f32_16x16x32_bf16 v[192:195], a[144:147], a[0:3], v[192:195]
  ds_read_b64_tr_b16 a[142:143], v225 offset:25152
  v_mfma_f32_16x16x32_bf16 v[196:199], a[144:147], a[4:7], v[196:199]
  s_add_u32 s28, s22, 212992
  v_mfma_f32_16x16x32_bf16 v[200:203], a[144:147], a[8:11], v[200:203]
  buffer_load_dwordx4 a[88:91], v224, s[12:15], s28 offen offset:2048 sc1
  v_mfma_f32_16x16x32_bf16 v[204:207], a[144:147], a[12:15], v[204:207]
  ds_read_b64_tr_b16 a[144:145], v225 offset:14432
  s_waitcnt lgkmcnt(13)
  v_mfma_f32_16x16x32_bf16 v[208:211], a[148:151], a[0:3], v[208:211]
  ds_read_b64_tr_b16 a[146:147], v225 offset:18016
  v_mfma_f32_16x16x32_bf16 v[212:215], a[148:151], a[4:7], v[212:215]
  v_mfma_f32_16x16x32_bf16 v[216:219], a[148:151], a[8:11], v[216:219]
  v_mfma_f32_16x16x32_bf16 v[220:223], a[148:151], a[12:15], v[220:223]
  ds_read_b64_tr_b16 a[148:149], v225 offset:21600
  s_waitcnt vmcnt(36) lgkmcnt(13)
  v_mfma_f32_16x16x32_bf16 v[0:3], a[152:155], a[16:19], v[0:3]
  s_add_u32 s28, s22, 212992
  ds_read_b64_tr_b16 a[150:151], v225 offset:25184
  s_waitcnt vmcnt(35)
  v_mfma_f32_16x16x32_bf16 v[4:7], a[152:155], a[20:23], v[4:7]
  buffer_load_dwordx4 a[92:95], v224, s[12:15], s28 offen offset:3072 sc1
  s_waitcnt vmcnt(35)
  v_mfma_f32_16x16x32_bf16 v[8:11], a[152:155], a[24:27], v[8:11]
  s_waitcnt vmcnt(34)
  v_mfma_f32_16x16x32_bf16 v[12:15], a[152:155], a[28:31], v[12:15]
  ds_read_b64_tr_b16 a[152:153], v225 offset:14464
  s_waitcnt lgkmcnt(13)
  v_mfma_f32_16x16x32_bf16 v[16:19], a[156:159], a[16:19], v[16:19]
  ds_read_b64_tr_b16 a[154:155], v225 offset:18048
  v_mfma_f32_16x16x32_bf16 v[20:23], a[156:159], a[20:23], v[20:23]
  s_add_u32 m0, s52, 115712
  v_mfma_f32_16x16x32_bf16 v[24:27], a[156:159], a[24:27], v[24:27]
  buffer_load_dwordx4 v229, s[48:51], s56 offen lds
  v_mfma_f32_16x16x32_bf16 v[28:31], a[156:159], a[28:31], v[28:31]
  ds_read_b64_tr_b16 a[156:157], v225 offset:21632
  s_waitcnt lgkmcnt(13)
  v_mfma_f32_16x16x32_bf16 v[32:35], a[128:131], a[16:19], v[32:35]
  ds_read_b64_tr_b16 a[158:159], v225 offset:25216
  v_mfma_f32_16x16x32_bf16 v[36:39], a[128:131], a[20:23], v[36:39]
  v_mfma_f32_16x16x32_bf16 v[40:43], a[128:131], a[24:27], v[40:43]
  v_mfma_f32_16x16x32_bf16 v[44:47], a[128:131], a[28:31], v[44:47]
  ds_read_b64_tr_b16 a[128:129], v225 offset:14496
  s_waitcnt lgkmcnt(13)
  v_mfma_f32_16x16x32_bf16 v[48:51], a[132:135], a[16:19], v[48:51]
  s_add_u32 s28, s22, 229376
  ds_read_b64_tr_b16 a[130:131], v225 offset:18080
  v_mfma_f32_16x16x32_bf16 v[52:55], a[132:135], a[20:23], v[52:55]
  buffer_load_dwordx4 a[96:99], v224, s[12:15], s28 offen offset:0 sc1
  v_mfma_f32_16x16x32_bf16 v[56:59], a[132:135], a[24:27], v[56:59]
  v_mfma_f32_16x16x32_bf16 v[60:63], a[132:135], a[28:31], v[60:63]
  ds_read_b64_tr_b16 a[132:133], v225 offset:21664
  s_waitcnt lgkmcnt(13)
  v_mfma_f32_16x16x32_bf16 v[64:67], a[136:139], a[16:19], v[64:67]
  ds_read_b64_tr_b16 a[134:135], v225 offset:25248
  v_mfma_f32_16x16x32_bf16 v[68:71], a[136:139], a[20:23], v[68:71]
  v_mfma_f32_16x16x32_bf16 v[72:75], a[136:139], a[24:27], v[72:75]
  v_mfma_f32_16x16x32_bf16 v[76:79], a[136:139], a[28:31], v[76:79]
  ds_read_b64_tr_b16 a[136:137], v225 offset:14528
  s_waitcnt lgkmcnt(13)
  v_mfma_f32_16x16x32_bf16 v[80:83], a[140:143], a[16:19], v[80:83]
  s_add_u32 s28, s22, 229376
  ds_read_b64_tr_b16 a[138:139], v225 offset:18112
  v_mfma_f32_16x16x32_bf16 v[84:87], a[140:143], a[20:23], v[84:87]
  buffer_load_dwordx4 a[100:103], v224, s[12:15], s28 offen offset:1024 sc1
  v_mfma_f32_16x16x32_bf16 v[88:91], a[140:143], a[24:27], v[88:91]
  v_mfma_f32_16x16x32_bf16 v[92:95], a[140:143], a[28:31], v[92:95]
  ds_read_b64_tr_b16 a[140:141], v225 offset:21696
  s_waitcnt lgkmcnt(13)
  v_mfma_f32_16x16x32_bf16 v[96:99], a[144:147], a[16:19], v[96:99]
  s_add_u32 s28, s22, 229376
  ds_read_b64_tr_b16 a[142:143], v225 offset:25280
  v_mfma_f32_16x16x32_bf16 v[100:103], a[144:147], a[20:23], v[100:103]
  buffer_load_dwordx4 a[104:107], v224, s[12:15], s28 offen offset:2048 sc1
  v_mfma_f32_16x16x32_bf16 v[104:107], a[144:147], a[24:27], v[104:107]
  v_mfma_f32_16x16x32_bf16 v[108:111], a[144:147], a[28:31], v[108:111]
  s_waitcnt lgkmcnt(12)
  v_mfma_f32_16x16x32_bf16 v[112:115], a[148:151], a[16:19], v[112:115]
  v_mfma_f32_16x16x32_bf16 v[116:119], a[148:151], a[20:23], v[116:119]
  v_mfma_f32_16x16x32_bf16 v[120:123], a[148:151], a[24:27], v[120:123]
  v_mfma_f32_16x16x32_bf16 v[124:127], a[148:151], a[28:31], v[124:127]
  s_waitcnt lgkmcnt(10)
  v_mfma_f32_16x16x32_bf16 v[128:131], a[152:155], a[16:19], v[128:131]
  s_add_u32 s28, s22, 229376
  v_mfma_f32_16x16x32_bf16 v[132:135], a[152:155], a[20:23], v[132:135]
  buffer_load_dwordx4 a[108:111], v224, s[12:15], s28 offen offset:3072 sc1
  v_mfma_f32_16x16x32_bf16 v[136:139], a[152:155], a[24:27], v[136:139]
  v_mfma_f32_16x16x32_bf16 v[140:143], a[152:155], a[28:31], v[140:143]
  s_waitcnt vmcnt(37) lgkmcnt(0)
  s_barrier
  ds_read_b64_tr_b16 a[144:145], v225 offset:28672
  v_mfma_f32_16x16x32_bf16 v[144:147], a[156:159], a[16:19], v[144:147]
  ds_read_b64_tr_b16 a[146:147], v225 offset:32256
  v_mfma_f32_16x16x32_bf16 v[148:151], a[156:159], a[20:23], v[148:151]
  s_add_u32 m0, s52, 0
  s_add_u32 s57, s53, 3670016
  ds_read_b64_tr_b16 a[148:149], v225 offset:35840
  v_mfma_f32_16x16x32_bf16 v[152:155], a[156:159], a[24:27], v[152:155]
  buffer_load_dwordx4 v228, s[48:51], s57 offen lds
  v_mfma_f32_16x16x32_bf16 v[156:159], a[156:159], a[28:31], v[156:159]
  ds_read_b64_tr_b16 a[150:151], v225 offset:39424
  v_mfma_f32_16x16x32_bf16 v[160:163], a[128:131], a[16:19], v[160:163]
  ds_read_b64_tr_b16 a[152:153], v225 offset:28704
  v_mfma_f32_16x16x32_bf16 v[164:167], a[128:131], a[20:23], v[164:167]
  ds_read_b64_tr_b16 a[154:155], v225 offset:32288
  v_mfma_f32_16x16x32_bf16 v[168:171], a[128:131], a[24:27], v[168:171]
  ds_read_b64_tr_b16 a[156:157], v225 offset:35872
  v_mfma_f32_16x16x32_bf16 v[172:175], a[128:131], a[28:31], v[172:175]
  ds_read_b64_tr_b16 a[158:159], v225 offset:39456
  v_mfma_f32_16x16x32_bf16 v[176:179], a[132:135], a[16:19], v[176:179]
  s_add_u32 m0, s52, 1024
  s_add_u32 s57, s53, 3670016
  ds_read_b64_tr_b16 a[128:129], v225 offset:28736
  v_mfma_f32_16x16x32_bf16 v[180:183], a[132:135], a[20:23], v[180:183]
  buffer_load_dwordx4 v229, s[48:51], s57 offen lds
  v_mfma_f32_16x16x32_bf16 v[184:187], a[132:135], a[24:27], v[184:187]
  ds_read_b64_tr_b16 a[130:131], v225 offset:32320
  v_mfma_f32_16x16x32_bf16 v[188:191], a[132:135], a[28:31], v[188:191]
  ds_read_b64_tr_b16 a[132:133], v225 offset:35904
  v_mfma_f32_16x16x32_bf16 v[192:195], a[136:139], a[16:19], v[192:195]
  ds_read_b64_tr_b16 a[134:135], v225 offset:39488
  v_mfma_f32_16x16x32_bf16 v[196:199], a[136:139], a[20:23], v[196:199]
  s_add_u32 m0, s52, 2048
  s_add_u32 s57, s53, 3670016
  v_mfma_f32_16x16x32_bf16 v[200:203], a[136:139], a[24:27], v[200:203]
  buffer_load_dwordx4 v230, s[48:51], s57 offen lds
  v_mfma_f32_16x16x32_bf16 v[204:207], a[136:139], a[28:31], v[204:207]
  ds_read_b64_tr_b16 a[136:137], v225 offset:28768
  v_mfma_f32_16x16x32_bf16 v[208:211], a[140:143], a[16:19], v[208:211]
  ds_read_b64_tr_b16 a[138:139], v225 offset:32352
  v_mfma_f32_16x16x32_bf16 v[212:215], a[140:143], a[20:23], v[212:215]
  v_mfma_f32_16x16x32_bf16 v[216:219], a[140:143], a[24:27], v[216:219]
  v_mfma_f32_16x16x32_bf16 v[220:223], a[140:143], a[28:31], v[220:223]
  ds_read_b64_tr_b16 a[140:141], v225 offset:35936
  s_waitcnt vmcnt(39) lgkmcnt(13)
  v_mfma_f32_16x16x32_bf16 v[0:3], a[144:147], a[32:35], v[0:3]
  s_add_u32 m0, s52, 116736
  ds_read_b64_tr_b16 a[142:143], v225 offset:39520
  s_waitcnt vmcnt(38)
  v_mfma_f32_16x16x32_bf16 v[4:7], a[144:147], a[36:39], v[4:7]
  buffer_load_dwordx4 v230, s[48:51], s56 offen lds
  s_waitcnt vmcnt(38)
  v_mfma_f32_16x16x32_bf16 v[8:11], a[144:147], a[40:43], v[8:11]
  s_waitcnt vmcnt(37)
  v_mfma_f32_16x16x32_bf16 v[12:15], a[144:147], a[44:47], v[12:15]
  ds_read_b64_tr_b16 a[144:145], v225 offset:28800
  s_waitcnt lgkmcnt(13)
  v_mfma_f32_16x16x32_bf16 v[16:19], a[148:151], a[32:35], v[16:19]
  ds_read_b64_tr_b16 a[146:147], v225 offset:32384
  v_mfma_f32_16x16x32_bf16 v[20:23], a[148:151], a[36:39], v[20:23]
  s_add_u32 m0, s52, 3072
  s_add_u32 s57, s53, 3670016
  v_mfma_f32_16x16x32_bf16 v[24:27], a[148:151], a[40:43], v[24:27]
  buffer_load_dwordx4 v231, s[48:51], s57 offen lds
  v_mfma_f32_16x16x32_bf16 v[28:31], a[148:151], a[44:47], v[28:31]
  ds_read_b64_tr_b16 a[148:149], v225 offset:35968
  s_waitcnt lgkmcnt(13)
  v_mfma_f32_16x16x32_bf16 v[32:35], a[152:155], a[32:35], v[32:35]
  ds_read_b64_tr_b16 a[150:151], v225 offset:39552
  v_mfma_f32_16x16x32_bf16 v[36:39], a[152:155], a[36:39], v[36:39]
  v_mfma_f32_16x16x32_bf16 v[40:43], a[152:155], a[40:43], v[40:43]
  v_mfma_f32_16x16x32_bf16 v[44:47], a[152:155], a[44:47], v[44:47]
  ds_read_b64_tr_b16 a[152:153], v225 offset:28832
  s_waitcnt lgkmcnt(13)
  v_mfma_f32_16x16x32_bf16 v[48:51], a[156:159], a[32:35], v[48:51]
  s_add_u32 m0, s52, 4096
  s_add_u32 s57, s53, 3670016
  ds_read_b64_tr_b16 a[154:155], v225 offset:32416
  v_mfma_f32_16x16x32_bf16 v[52:55], a[156:159], a[36:39], v[52:55]
  buffer_load_dwordx4 v232, s[48:51], s57 offen lds
  v_mfma_f32_16x16x32_bf16 v[56:59], a[156:159], a[40:43], v[56:59]
  v_mfma_f32_16x16x32_bf16 v[60:63], a[156:159], a[44:47], v[60:63]
  ds_read_b64_tr_b16 a[156:157], v225 offset:36000
  s_waitcnt lgkmcnt(13)
  v_mfma_f32_16x16x32_bf16 v[64:67], a[128:131], a[32:35], v[64:67]
  ds_read_b64_tr_b16 a[158:159], v225 offset:39584
  v_mfma_f32_16x16x32_bf16 v[68:71], a[128:131], a[36:39], v[68:71]
  v_mfma_f32_16x16x32_bf16 v[72:75], a[128:131], a[40:43], v[72:75]
  v_mfma_f32_16x16x32_bf16 v[76:79], a[128:131], a[44:47], v[76:79]
  ds_read_b64_tr_b16 a[128:129], v225 offset:28864
  s_waitcnt lgkmcnt(13)
  v_mfma_f32_16x16x32_bf16 v[80:83], a[132:135], a[32:35], v[80:83]
  s_add_u32 m0, s52, 5120
  s_add_u32 s57, s53, 3670016
  ds_read_b64_tr_b16 a[130:131], v225 offset:32448
  v_mfma_f32_16x16x32_bf16 v[84:87], a[132:135], a[36:39], v[84:87]
  buffer_load_dwordx4 v233, s[48:51], s57 offen lds
  v_mfma_f32_16x16x32_bf16 v[88:91], a[132:135], a[40:43], v[88:91]
  v_mfma_f32_16x16x32_bf16 v[92:95], a[132:135], a[44:47], v[92:95]
  ds_read_b64_tr_b16 a[132:133], v225 offset:36032
  s_waitcnt lgkmcnt(13)
  v_mfma_f32_16x16x32_bf16 v[96:99], a[136:139], a[32:35], v[96:99]
  s_add_u32 m0, s52, 6144
  s_add_u32 s57, s53, 3670016
  ds_read_b64_tr_b16 a[134:135], v225 offset:39616
  v_mfma_f32_16x16x32_bf16 v[100:103], a[136:139], a[36:39], v[100:103]
  buffer_load_dwordx4 v234, s[48:51], s57 offen lds
  v_mfma_f32_16x16x32_bf16 v[104:107], a[136:139], a[40:43], v[104:107]
  v_mfma_f32_16x16x32_bf16 v[108:111], a[136:139], a[44:47], v[108:111]
  ds_read_b64_tr_b16 a[136:137], v225 offset:43008
  s_waitcnt lgkmcnt(13)
  v_mfma_f32_16x16x32_bf16 v[112:115], a[140:143], a[32:35], v[112:115]
  ds_read_b64_tr_b16 a[138:139], v225 offset:46592
  v_mfma_f32_16x16x32_bf16 v[116:119], a[140:143], a[36:39], v[116:119]
  v_mfma_f32_16x16x32_bf16 v[120:123], a[140:143], a[40:43], v[120:123]
  v_mfma_f32_16x16x32_bf16 v[124:127], a[140:143], a[44:47], v[124:127]
  ds_read_b64_tr_b16 a[140:141], v225 offset:50176
  s_waitcnt lgkmcnt(13)
  v_mfma_f32_16x16x32_bf16 v[128:131], a[144:147], a[32:35], v[128:131]
  s_add_u32 m0, s52, 117760
  ds_read_b64_tr_b16 a[142:143], v225 offset:53760
  v_mfma_f32_16x16x32_bf16 v[132:135], a[144:147], a[36:39], v[132:135]
  buffer_load_dwordx4 v231, s[48:51], s56 offen lds
  v_mfma_f32_16x16x32_bf16 v[136:139], a[144:147], a[40:43], v[136:139]
  v_mfma_f32_16x16x32_bf16 v[140:143], a[144:147], a[44:47], v[140:143]
  ds_read_b64_tr_b16 a[144:145], v225 offset:43040
  s_waitcnt lgkmcnt(13)
  v_mfma_f32_16x16x32_bf16 v[144:147], a[148:151], a[32:35], v[144:147]
  ds_read_b64_tr_b16 a[146:147], v225 offset:46624
  v_mfma_f32_16x16x32_bf16 v[148:151], a[148:151], a[36:39], v[148:151]
  s_add_u32 s28, s22, 245760
  v_mfma_f32_16x16x32_bf16 v[152:155], a[148:151], a[40:43], v[152:155]
  buffer_load_dwordx4 a[112:115], v224, s[12:15], s28 offen offset:0 sc1
  v_mfma_f32_16x16x32_bf16 v[156:159], a[148:151], a[44:47], v[156:159]
  ds_read_b64_tr_b16 a[148:149], v225 offset:50208
  s_waitcnt lgkmcnt(13)
  v_mfma_f32_16x16x32_bf16 v[160:163], a[152:155], a[32:35], v[160:163]
  ds_read_b64_tr_b16 a[150:151], v225 offset:53792
  v_mfma_f32_16x16x32_bf16 v[164:167], a[152:155], a[36:39], v[164:167]
  v_mfma_f32_16x16x32_bf16 v[168:171], a[152:155], a[40:43], v[168:171]
  v_mfma_f32_16x16x32_bf16 v[172:175], a[152:155], a[44:47], v[172:175]
  ds_read_b64_tr_b16 a[152:153], v225 offset:43072
  s_waitcnt lgkmcnt(13)
  v_mfma_f32_16x16x32_bf16 v[176:179], a[156:159], a[32:35], v[176:179]
  s_add_u32 s28, s22, 245760
  ds_read_b64_tr_b16 a[154:155], v225 offset:46656
  v_mfma_f32_16x16x32_bf16 v[180:183], a[156:159], a[36:39], v[180:183]
  buffer_load_dwordx4 a[116:119], v224, s[12:15], s28 offen offset:1024 sc1
  v_mfma_f32_16x16x32_bf16 v[184:187], a[156:159], a[40:43], v[184:187]
  v_mfma_f32_16x16x32_bf16 v[188:191], a[156:159], a[44:47], v[188:191]
  ds_read_b64_tr_b16 a[156:157], v225 offset:50240
  s_waitcnt lgkmcnt(13)
  v_mfma_f32_16x16x32_bf16 v[192:195], a[128:131], a[32:35], v[192:195]
  ds_read_b64_tr_b16 a[158:159], v225 offset:53824
  v_mfma_f32_16x16x32_bf16 v[196:199], a[128:131], a[36:39], v[196:199]
  s_add_u32 s28, s22, 245760
  v_mfma_f32_16x16x32_bf16 v[200:203], a[128:131], a[40:43], v[200:203]
  buffer_load_dwordx4 a[120:123], v224, s[12:15], s28 offen offset:2048 sc1
  v_mfma_f32_16x16x32_bf16 v[204:207], a[128:131], a[44:47], v[204:207]
  ds_read_b64_tr_b16 a[128:129], v225 offset:43104
  s_waitcnt lgkmcnt(13)
  v_mfma_f32_16x16x32_bf16 v[208:211], a[132:135], a[32:35], v[208:211]
  ds_read_b64_tr_b16 a[130:131], v225 offset:46688
  v_mfma_f32_16x16x32_bf16 v[212:215], a[132:135], a[36:39], v[212:215]
  v_mfma_f32_16x16x32_bf16 v[216:219], a[132:135], a[40:43], v[216:219]
  v_mfma_f32_16x16x32_bf16 v[220:223], a[132:135], a[44:47], v[220:223]
  ds_read_b64_tr_b16 a[132:133], v225 offset:50272
  s_waitcnt vmcnt(37) lgkmcnt(13)
  v_mfma_f32_16x16x32_bf16 v[0:3], a[136:139], a[48:51], v[0:3]
  s_add_u32 s28, s22, 245760
  ds_read_b64_tr_b16 a[134:135], v225 offset:53856
  s_waitcnt vmcnt(36)
  v_mfma_f32_16x16x32_bf16 v[4:7], a[136:139], a[52:55], v[4:7]
  buffer_load_dwordx4 a[124:127], v224, s[12:15], s28 offen offset:3072 sc1
  s_waitcnt vmcnt(36)
  v_mfma_f32_16x16x32_bf16 v[8:11], a[136:139], a[56:59], v[8:11]
  s_waitcnt vmcnt(35)
  v_mfma_f32_16x16x32_bf16 v[12:15], a[136:139], a[60:63], v[12:15]
  ds_read_b64_tr_b16 a[136:137], v225 offset:43136
  s_waitcnt lgkmcnt(13)
  v_mfma_f32_16x16x32_bf16 v[16:19], a[140:143], a[48:51], v[16:19]
  ds_read_b64_tr_b16 a[138:139], v225 offset:46720
  v_mfma_f32_16x16x32_bf16 v[20:23], a[140:143], a[52:55], v[20:23]
  s_add_u32 m0, s52, 118784
  v_mfma_f32_16x16x32_bf16 v[24:27], a[140:143], a[56:59], v[24:27]
  buffer_load_dwordx4 v232, s[48:51], s56 offen lds
  v_mfma_f32_16x16x32_bf16 v[28:31], a[140:143], a[60:63], v[28:31]
  ds_read_b64_tr_b16 a[140:141], v225 offset:50304
  s_waitcnt lgkmcnt(13)
  v_mfma_f32_16x16x32_bf16 v[32:35], a[144:147], a[48:51], v[32:35]
  ds_read_b64_tr_b16 a[142:143], v225 offset:53888
  v_mfma_f32_16x16x32_bf16 v[36:39], a[144:147], a[52:55], v[36:39]
  v_mfma_f32_16x16x32_bf16 v[40:43], a[144:147], a[56:59], v[40:43]
  v_mfma_f32_16x16x32_bf16 v[44:47], a[144:147], a[60:63], v[44:47]
  ds_read_b64_tr_b16 a[144:145], v225 offset:43168
  s_waitcnt lgkmcnt(13)
  v_mfma_f32_16x16x32_bf16 v[48:51], a[148:151], a[48:51], v[48:51]
  s_add_u32 s28, s22, 262144
  ds_read_b64_tr_b16 a[146:147], v225 offset:46752
  v_mfma_f32_16x16x32_bf16 v[52:55], a[148:151], a[52:55], v[52:55]
  buffer_load_dwordx4 a[0:3], v224, s[12:15], s28 offen offset:0 sc1
  v_mfma_f32_16x16x32_bf16 v[56:59], a[148:151], a[56:59], v[56:59]
  v_mfma_f32_16x16x32_bf16 v[60:63], a[148:151], a[60:63], v[60:63]
  ds_read_b64_tr_b16 a[148:149], v225 offset:50336
  s_waitcnt lgkmcnt(13)
  v_mfma_f32_16x16x32_bf16 v[64:67], a[152:155], a[48:51], v[64:67]
  ds_read_b64_tr_b16 a[150:151], v225 offset:53920
  v_mfma_f32_16x16x32_bf16 v[68:71], a[152:155], a[52:55], v[68:71]
  v_mfma_f32_16x16x32_bf16 v[72:75], a[152:155], a[56:59], v[72:75]
  v_mfma_f32_16x16x32_bf16 v[76:79], a[152:155], a[60:63], v[76:79]
  ds_read_b64_tr_b16 a[152:153], v225 offset:43200
  s_waitcnt lgkmcnt(13)
  v_mfma_f32_16x16x32_bf16 v[80:83], a[156:159], a[48:51], v[80:83]
  s_add_u32 s28, s22, 262144
  ds_read_b64_tr_b16 a[154:155], v225 offset:46784
  v_mfma_f32_16x16x32_bf16 v[84:87], a[156:159], a[52:55], v[84:87]
  buffer_load_dwordx4 a[4:7], v224, s[12:15], s28 offen offset:1024 sc1
  v_mfma_f32_16x16x32_bf16 v[88:91], a[156:159], a[56:59], v[88:91]
  v_mfma_f32_16x16x32_bf16 v[92:95], a[156:159], a[60:63], v[92:95]
  ds_read_b64_tr_b16 a[156:157], v225 offset:50368
  s_waitcnt lgkmcnt(13)
  v_mfma_f32_16x16x32_bf16 v[96:99], a[128:131], a[48:51], v[96:99]
  s_add_u32 s28, s22, 262144
  ds_read_b64_tr_b16 a[158:159], v225 offset:53952
  v_mfma_f32_16x16x32_bf16 v[100:103], a[128:131], a[52:55], v[100:103]
  buffer_load_dwordx4 a[8:11], v224, s[12:15], s28 offen offset:2048 sc1
  v_mfma_f32_16x16x32_bf16 v[104:107], a[128:131], a[56:59], v[104:107]
  v_mfma_f32_16x16x32_bf16 v[108:111], a[128:131], a[60:63], v[108:111]
  s_waitcnt lgkmcnt(12)
  v_mfma_f32_16x16x32_bf16 v[112:115], a[132:135], a[48:51], v[112:115]
  v_mfma_f32_16x16x32_bf16 v[116:119], a[132:135], a[52:55], v[116:119]
  v_mfma_f32_16x16x32_bf16 v[120:123], a[132:135], a[56:59], v[120:123]
  v_mfma_f32_16x16x32_bf16 v[124:127], a[132:135], a[60:63], v[124:127]
  s_waitcnt lgkmcnt(10)
  v_mfma_f32_16x16x32_bf16 v[128:131], a[136:139], a[48:51], v[128:131]
  s_add_u32 s28, s22, 262144
  v_mfma_f32_16x16x32_bf16 v[132:135], a[136:139], a[52:55], v[132:135]
  buffer_load_dwordx4 a[12:15], v224, s[12:15], s28 offen offset:3072 sc1
  v_mfma_f32_16x16x32_bf16 v[136:139], a[136:139], a[56:59], v[136:139]
  v_mfma_f32_16x16x32_bf16 v[140:143], a[136:139], a[60:63], v[140:143]
  s_waitcnt lgkmcnt(0)
  s_barrier
  ds_read_b64_tr_b16 a[128:129], v226 offset:0
  v_mfma_f32_16x16x32_bf16 v[144:147], a[140:143], a[48:51], v[144:147]
  ds_read_b64_tr_b16 a[130:131], v226 offset:3584
  v_mfma_f32_16x16x32_bf16 v[148:151], a[140:143], a[52:55], v[148:151]
  s_add_u32 m0, s52, 28672
  s_add_u32 s57, s53, 4128768
  ds_read_b64_tr_b16 a[132:133], v226 offset:7168
  v_mfma_f32_16x16x32_bf16 v[152:155], a[140:143], a[56:59], v[152:155]
  buffer_load_dwordx4 v228, s[48:51], s57 offen lds
  v_mfma_f32_16x16x32_bf16 v[156:159], a[140:143], a[60:63], v[156:159]
  ds_read_b64_tr_b16 a[134:135], v226 offset:10752
  v_mfma_f32_16x16x32_bf16 v[160:163], a[144:147], a[48:51], v[160:163]
  ds_read_b64_tr_b16 a[136:137], v226 offset:32
  v_mfma_f32_16x16x32_bf16 v[164:167], a[144:147], a[52:55], v[164:167]
  ds_read_b64_tr_b16 a[138:139], v226 offset:3616
  v_mfma_f32_16x16x32_bf16 v[168:171], a[144:147], a[56:59], v[168:171]
  ds_read_b64_tr_b16 a[140:141], v226 offset:7200
  v_mfma_f32_16x16x32_bf16 v[172:175], a[144:147], a[60:63], v[172:175]
  ds_read_b64_tr_b16 a[142:143], v226 offset:10784
  v_mfma_f32_16x16x32_bf16 v[176:179], a[148:151], a[48:51], v[176:179]
  s_add_u32 m0, s52, 29696
  s_add_u32 s57, s53, 4128768
  ds_read_b64_tr_b16 a[144:145], v226 offset:64
  v_mfma_f32_16x16x32_bf16 v[180:183], a[148:151], a[52:55], v[180:183]
  buffer_load_dwordx4 v229, s[48:51], s57 offen lds
  v_mfma_f32_16x16x32_bf16 v[184:187], a[148:151], a[56:59], v[184:187]
  ds_read_b64_tr_b16 a[146:147], v226 offset:3648
  v_mfma_f32_16x16x32_bf16 v[188:191], a[148:151], a[60:63], v[188:191]
  ds_read_b64_tr_b16 a[148:149], v226 offset:7232
  v_mfma_f32_16x16x32_bf16 v[192:195], a[152:155], a[48:51], v[192:195]
  ds_read_b64_tr_b16 a[150:151], v226 offset:10816
  v_mfma_f32_16x16x32_bf16 v[196:199], a[152:155], a[52:55], v[196:199]
  s_add_u32 m0, s52, 30720
  s_add_u32 s57, s53, 4128768
  v_mfma_f32_16x16x32_bf16 v[200:203], a[152:155], a[56:59], v[200:203]
  buffer_load_dwordx4 v230, s[48:51], s57 offen lds
  v_mfma_f32_16x16x32_bf16 v[204:207], a[152:155], a[60:63], v[204:207]
  ds_read_b64_tr_b16 a[152:153], v226 offset:96
  v_mfma_f32_16x16x32_bf16 v[208:211], a[156:159], a[48:51], v[208:211]
  ds_read_b64_tr_b16 a[154:155], v226 offset:3680
  v_mfma_f32_16x16x32_bf16 v[212:215], a[156:159], a[52:55], v[212:215]
  v_mfma_f32_16x16x32_bf16 v[216:219], a[156:159], a[56:59], v[216:219]
  v_mfma_f32_16x16x32_bf16 v[220:223], a[156:159], a[60:63], v[220:223]
  ds_read_b64_tr_b16 a[156:157], v226 offset:7264
  s_waitcnt vmcnt(42) lgkmcnt(13)
  v_mfma_f32_16x16x32_bf16 v[0:3], a[128:131], a[64:67], v[0:3]
  s_add_u32 m0, s52, 119808
  ds_read_b64_tr_b16 a[158:159], v226 offset:10848
  s_waitcnt vmcnt(41)
  v_mfma_f32_16x16x32_bf16 v[4:7], a[128:131], a[68:71], v[4:7]
  buffer_load_dwordx4 v233, s[48:51], s56 offen lds
  s_waitcnt vmcnt(41)
  v_mfma_f32_16x16x32_bf16 v[8:11], a[128:131], a[72:75], v[8:11]
  s_waitcnt vmcnt(40)
  v_mfma_f32_16x16x32_bf16 v[12:15], a[128:131], a[76:79], v[12:15]
  ds_read_b64_tr_b16 a[128:129], v226 offset:128
  s_waitcnt lgkmcnt(13)
  v_mfma_f32_16x16x32_bf16 v[16:19], a[132:135], a[64:67], v[16:19]
  ds_read_b64_tr_b16 a[130:131], v226 offset:3712
  v_mfma_f32_16x16x32_bf16 v[20:23], a[132:135], a[68:71], v[20:23]
  s_add_u32 m0, s52, 31744
  s_add_u32 s57, s53, 4128768
  v_mfma_f32_16x16x32_bf16 v[24:27], a[132:135], a[72:75], v[24:27]
  buffer_load_dwordx4 v231, s[48:51], s57 offen lds
  v_mfma_f32_16x16x32_bf16 v[28:31], a[132:135], a[76:79], v[28:31]
  ds_read_b64_tr_b16 a[132:133], v226 offset:7296
  s_waitcnt lgkmcnt(13)
  v_mfma_f32_16x16x32_bf16 v[32:35], a[136:139], a[64:67], v[32:35]
  ds_read_b64_tr_b16 a[134:135], v226 offset:10880
  v_mfma_f32_16x16x32_bf16 v[36:39], a[136:139], a[68:71], v[36:39]
  v_mfma_f32_16x16x32_bf16 v[40:43], a[136:139], a[72:75], v[40:43]
  v_mfma_f32_16x16x32_bf16 v[44:47], a[136:139], a[76:79], v[44:47]
  ds_read_b64_tr_b16 a[136:137], v226 offset:160
  s_waitcnt lgkmcnt(13)
  v_mfma_f32_16x16x32_bf16 v[48:51], a[140:143], a[64:67], v[48:51]
  s_add_u32 m0, s52, 32768
  s_add_u32 s57, s53, 4128768
  ds_read_b64_tr_b16 a[138:139], v226 offset:3744
  v_mfma_f32_16x16x32_bf16 v[52:55], a[140:143], a[68:71], v[52:55]
  buffer_load_dwordx4 v232, s[48:51], s57 offen lds
  v_mfma_f32_16x16x32_bf16 v[56:59], a[140:143], a[72:75], v[56:59]
  v_mfma_f32_16x16x32_bf16 v[60:63], a[140:143], a[76:79], v[60:63]
  ds_read_b64_tr_b16 a[140:141], v226 offset:7328
  s_waitcnt lgkmcnt(13)
  v_mfma_f32_16x16x32_bf16 v[64:67], a[144:147], a[64:67], v[64:67]
  ds_read_b64_tr_b16 a[142:143], v226 offset:10912
  v_mfma_f32_16x16x32_bf16 v[68:71], a[144:147], a[68:71], v[68:71]
  v_mfma_f32_16x16x32_bf16 v[72:75], a[144:147], a[72:75], v[72:75]
  v_mfma_f32_16x16x32_bf16 v[76:79], a[144:147], a[76:79], v[76:79]
  ds_read_b64_tr_b16 a[144:145], v226 offset:192
  s_waitcnt lgkmcnt(13)
  v_mfma_f32_16x16x32_bf16 v[80:83], a[148:151], a[64:67], v[80:83]
  s_add_u32 m0, s52, 33792
  s_add_u32 s57, s53, 4128768
  ds_read_b64_tr_b16 a[146:147], v226 offset:3776
  v_mfma_f32_16x16x32_bf16 v[84:87], a[148:151], a[68:71], v[84:87]
  buffer_load_dwordx4 v233, s[48:51], s57 offen lds
  v_mfma_f32_16x16x32_bf16 v[88:91], a[148:151], a[72:75], v[88:91]
  v_mfma_f32_16x16x32_bf16 v[92:95], a[148:151], a[76:79], v[92:95]
  ds_read_b64_tr_b16 a[148:149], v226 offset:7360
  s_waitcnt lgkmcnt(13)
  v_mfma_f32_16x16x32_bf16 v[96:99], a[152:155], a[64:67], v[96:99]
  s_add_u32 m0, s52, 34816
  s_add_u32 s57, s53, 4128768
  ds_read_b64_tr_b16 a[150:151], v226 offset:10944
  v_mfma_f32_16x16x32_bf16 v[100:103], a[152:155], a[68:71], v[100:103]
  buffer_load_dwordx4 v234, s[48:51], s57 offen lds
  v_mfma_f32_16x16x32_bf16 v[104:107], a[152:155], a[72:75], v[104:107]
  v_mfma_f32_16x16x32_bf16 v[108:111], a[152:155], a[76:79], v[108:111]
  ds_read_b64_tr_b16 a[152:153], v226 offset:14336
  s_waitcnt lgkmcnt(13)
  v_mfma_f32_16x16x32_bf16 v[112:115], a[156:159], a[64:67], v[112:115]
  ds_read_b64_tr_b16 a[154:155], v226 offset:17920
  v_mfma_f32_16x16x32_bf16 v[116:119], a[156:159], a[68:71], v[116:119]
  v_mfma_f32_16x16x32_bf16 v[120:123], a[156:159], a[72:75], v[120:123]
  v_mfma_f32_16x16x32_bf16 v[124:127], a[156:159], a[76:79], v[124:127]
  ds_read_b64_tr_b16 a[156:157], v226 offset:21504
  s_waitcnt lgkmcnt(13)
  v_mfma_f32_16x16x32_bf16 v[128:131], a[128:131], a[64:67], v[128:131]
  s_add_u32 m0, s52, 120832
  ds_read_b64_tr_b16 a[158:159], v226 offset:25088
  v_mfma_f32_16x16x32_bf16 v[132:135], a[128:131], a[68:71], v[132:135]
  buffer_load_dwordx4 v234, s[48:51], s56 offen lds
  v_mfma_f32_16x16x32_bf16 v[136:139], a[128:131], a[72:75], v[136:139]
  v_mfma_f32_16x16x32_bf16 v[140:143], a[128:131], a[76:79], v[140:143]
  ds_read_b64_tr_b16 a[128:129], v226 offset:14368
  s_waitcnt lgkmcnt(13)
  v_mfma_f32_16x16x32_bf16 v[144:147], a[132:135], a[64:67], v[144:147]
  ds_read_b64_tr_b16 a[130:131], v226 offset:17952
  v_mfma_f32_16x16x32_bf16 v[148:151], a[132:135], a[68:71], v[148:151]
  s_add_u32 s28, s22, 278528
  v_mfma_f32_16x16x32_bf16 v[152:155], a[132:135], a[72:75], v[152:155]
  buffer_load_dwordx4 a[16:19], v224, s[12:15], s28 offen offset:0 sc1
  v_mfma_f32_16x16x32_bf16 v[156:159], a[132:135], a[76:79], v[156:159]
  ds_read_b64_tr_b16 a[132:133], v226 offset:21536
  s_waitcnt lgkmcnt(13)
  v_mfma_f32_16x16x32_bf16 v[160:163], a[136:139], a[64:67], v[160:163]
  ds_read_b64_tr_b16 a[134:135], v226 offset:25120
  v_mfma_f32_16x16x32_bf16 v[164:167], a[136:139], a[68:71], v[164:167]
  v_mfma_f32_16x16x32_bf16 v[168:171], a[136:139], a[72:75], v[168:171]
  v_mfma_f32_16x16x32_bf16 v[172:175], a[136:139], a[76:79], v[172:175]
  ds_read_b64_tr_b16 a[136:137], v226 offset:14400
  s_waitcnt lgkmcnt(13)
  v_mfma_f32_16x16x32_bf16 v[176:179], a[140:143], a[64:67], v[176:179]
  s_add_u32 s28, s22, 278528
  ds_read_b64_tr_b16 a[138:139], v226 offset:17984
  v_mfma_f32_16x16x32_bf16 v[180:183], a[140:143], a[68:71], v[180:183]
  buffer_load_dwordx4 a[20:23], v224, s[12:15], s28 offen offset:1024 sc1
  v_mfma_f32_16x16x32_bf16 v[184:187], a[140:143], a[72:75], v[184:187]
  v_mfma_f32_16x16x32_bf16 v[188:191], a[140:143], a[76:79], v[188:191]
  ds_read_b64_tr_b16 a[140:141], v226 offset:21568
  s_waitcnt lgkmcnt(13)
  v_mfma_f32_16x16x32_bf16 v[192:195], a[144:147], a[64:67], v[192:195]
  ds_read_b64_tr_b16 a[142:143], v226 offset:25152
  v_mfma_f32_16x16x32_bf16 v[196:199], a[144:147], a[68:71], v[196:199]
  s_add_u32 s28, s22, 278528
  v_mfma_f32_16x16x32_bf16 v[200:203], a[144:147], a[72:75], v[200:203]
  buffer_load_dwordx4 a[24:27], v224, s[12:15], s28 offen offset:2048 sc1
  v_mfma_f32_16x16x32_bf16 v[204:207], a[144:147], a[76:79], v[204:207]
  ds_read_b64_tr_b16 a[144:145], v226 offset:14432
  s_waitcnt lgkmcnt(13)
  v_mfma_f32_16x16x32_bf16 v[208:211], a[148:151], a[64:67], v[208:211]
  ds_read_b64_tr_b16 a[146:147], v226 offset:18016
  v_mfma_f32_16x16x32_bf16 v[212:215], a[148:151], a[68:71], v[212:215]
  v_mfma_f32_16x16x32_bf16 v[216:219], a[148:151], a[72:75], v[216:219]
  v_mfma_f32_16x16x32_bf16 v[220:223], a[148:151], a[76:79], v[220:223]
  ds_read_b64_tr_b16 a[148:149], v226 offset:21600
  s_waitcnt vmcnt(38) lgkmcnt(13)
  v_mfma_f32_16x16x32_bf16 v[0:3], a[152:155], a[80:83], v[0:3]
  s_add_u32 s28, s22, 278528
  ds_read_b64_tr_b16 a[150:151], v226 offset:25184
  s_waitcnt vmcnt(37)
  v_mfma_f32_16x16x32_bf16 v[4:7], a[152:155], a[84:87], v[4:7]
  buffer_load_dwordx4 a[28:31], v224, s[12:15], s28 offen offset:3072 sc1
  s_waitcnt vmcnt(37)
  v_mfma_f32_16x16x32_bf16 v[8:11], a[152:155], a[88:91], v[8:11]
  s_waitcnt vmcnt(36)
  v_mfma_f32_16x16x32_bf16 v[12:15], a[152:155], a[92:95], v[12:15]
  ds_read_b64_tr_b16 a[152:153], v226 offset:14464
  s_waitcnt lgkmcnt(13)
  v_mfma_f32_16x16x32_bf16 v[16:19], a[156:159], a[80:83], v[16:19]
  ds_read_b64_tr_b16 a[154:155], v226 offset:18048
  v_mfma_f32_16x16x32_bf16 v[20:23], a[156:159], a[84:87], v[20:23]
  v_mfma_f32_16x16x32_bf16 v[24:27], a[156:159], a[88:91], v[24:27]
  buffer_load_dwordx4 a[160:163], v224, s[12:15], s31 offen offset:0 sc1
  v_mfma_f32_16x16x32_bf16 v[28:31], a[156:159], a[92:95], v[28:31]
  ds_read_b64_tr_b16 a[156:157], v226 offset:21632
  s_waitcnt lgkmcnt(13)
  v_mfma_f32_16x16x32_bf16 v[32:35], a[128:131], a[80:83], v[32:35]
  ds_read_b64_tr_b16 a[158:159], v226 offset:25216
  v_mfma_f32_16x16x32_bf16 v[36:39], a[128:131], a[84:87], v[36:39]
  v_mfma_f32_16x16x32_bf16 v[40:43], a[128:131], a[88:91], v[40:43]
  v_mfma_f32_16x16x32_bf16 v[44:47], a[128:131], a[92:95], v[44:47]
  ds_read_b64_tr_b16 a[128:129], v226 offset:14496
  s_waitcnt lgkmcnt(13)
  v_mfma_f32_16x16x32_bf16 v[48:51], a[132:135], a[80:83], v[48:51]
  s_add_u32 s28, s22, 294912
  ds_read_b64_tr_b16 a[130:131], v226 offset:18080
  v_mfma_f32_16x16x32_bf16 v[52:55], a[132:135], a[84:87], v[52:55]
  buffer_load_dwordx4 a[32:35], v224, s[12:15], s28 offen offset:0 sc1
  v_mfma_f32_16x16x32_bf16 v[56:59], a[132:135], a[88:91], v[56:59]
  v_mfma_f32_16x16x32_bf16 v[60:63], a[132:135], a[92:95], v[60:63]
  ds_read_b64_tr_b16 a[132:133], v226 offset:21664
  s_waitcnt lgkmcnt(13)
  v_mfma_f32_16x16x32_bf16 v[64:67], a[136:139], a[80:83], v[64:67]
  ds_read_b64_tr_b16 a[134:135], v226 offset:25248
  v_mfma_f32_16x16x32_bf16 v[68:71], a[136:139], a[84:87], v[68:71]
  v_mfma_f32_16x16x32_bf16 v[72:75], a[136:139], a[88:91], v[72:75]
  v_mfma_f32_16x16x32_bf16 v[76:79], a[136:139], a[92:95], v[76:79]
  ds_read_b64_tr_b16 a[136:137], v226 offset:14528
  s_waitcnt lgkmcnt(13)
  v_mfma_f32_16x16x32_bf16 v[80:83], a[140:143], a[80:83], v[80:83]
  s_add_u32 s28, s22, 294912
  ds_read_b64_tr_b16 a[138:139], v226 offset:18112
  v_mfma_f32_16x16x32_bf16 v[84:87], a[140:143], a[84:87], v[84:87]
  buffer_load_dwordx4 a[36:39], v224, s[12:15], s28 offen offset:1024 sc1
  v_mfma_f32_16x16x32_bf16 v[88:91], a[140:143], a[88:91], v[88:91]
  v_mfma_f32_16x16x32_bf16 v[92:95], a[140:143], a[92:95], v[92:95]
  ds_read_b64_tr_b16 a[140:141], v226 offset:21696
  s_waitcnt lgkmcnt(13)
  v_mfma_f32_16x16x32_bf16 v[96:99], a[144:147], a[80:83], v[96:99]
  s_add_u32 s28, s22, 294912
  ds_read_b64_tr_b16 a[142:143], v226 offset:25280
  v_mfma_f32_16x16x32_bf16 v[100:103], a[144:147], a[84:87], v[100:103]
  buffer_load_dwordx4 a[40:43], v224, s[12:15], s28 offen offset:2048 sc1
  v_mfma_f32_16x16x32_bf16 v[104:107], a[144:147], a[88:91], v[104:107]
  v_mfma_f32_16x16x32_bf16 v[108:111], a[144:147], a[92:95], v[108:111]
  s_waitcnt lgkmcnt(12)
  v_mfma_f32_16x16x32_bf16 v[112:115], a[148:151], a[80:83], v[112:115]
  v_mfma_f32_16x16x32_bf16 v[116:119], a[148:151], a[84:87], v[116:119]
  v_mfma_f32_16x16x32_bf16 v[120:123], a[148:151], a[88:91], v[120:123]
  v_mfma_f32_16x16x32_bf16 v[124:127], a[148:151], a[92:95], v[124:127]
  s_waitcnt lgkmcnt(10)
  v_mfma_f32_16x16x32_bf16 v[128:131], a[152:155], a[80:83], v[128:131]
  s_add_u32 s28, s22, 294912
  v_mfma_f32_16x16x32_bf16 v[132:135], a[152:155], a[84:87], v[132:135]
  buffer_load_dwordx4 a[44:47], v224, s[12:15], s28 offen offset:3072 sc1
  v_mfma_f32_16x16x32_bf16 v[136:139], a[152:155], a[88:91], v[136:139]
  v_mfma_f32_16x16x32_bf16 v[140:143], a[152:155], a[92:95], v[140:143]
  s_waitcnt lgkmcnt(0)
  s_barrier
  ds_read_b64_tr_b16 a[144:145], v226 offset:28672
  v_mfma_f32_16x16x32_bf16 v[144:147], a[156:159], a[80:83], v[144:147]
  ds_read_b64_tr_b16 a[146:147], v226 offset:32256
  v_mfma_f32_16x16x32_bf16 v[148:151], a[156:159], a[84:87], v[148:151]
  s_add_u32 m0, s52, 57344
  s_add_u32 s57, s53, 4587520
  ds_read_b64_tr_b16 a[148:149], v226 offset:35840
  v_mfma_f32_16x16x32_bf16 v[152:155], a[156:159], a[88:91], v[152:155]
  buffer_load_dwordx4 v228, s[48:51], s57 offen lds
  v_mfma_f32_16x16x32_bf16 v[156:159], a[156:159], a[92:95], v[156:159]
  ds_read_b64_tr_b16 a[150:151], v226 offset:39424
  v_mfma_f32_16x16x32_bf16 v[160:163], a[128:131], a[80:83], v[160:163]
  ds_read_b64_tr_b16 a[152:153], v226 offset:28704
  v_mfma_f32_16x16x32_bf16 v[164:167], a[128:131], a[84:87], v[164:167]
  ds_read_b64_tr_b16 a[154:155], v226 offset:32288
  v_mfma_f32_16x16x32_bf16 v[168:171], a[128:131], a[88:91], v[168:171]
  ds_read_b64_tr_b16 a[156:157], v226 offset:35872
  v_mfma_f32_16x16x32_bf16 v[172:175], a[128:131], a[92:95], v[172:175]
  ds_read_b64_tr_b16 a[158:159], v226 offset:39456
  v_mfma_f32_16x16x32_bf16 v[176:179], a[132:135], a[80:83], v[176:179]
  s_add_u32 m0, s52, 58368
  s_add_u32 s57, s53, 4587520
  ds_read_b64_tr_b16 a[128:129], v226 offset:28736
  v_mfma_f32_16x16x32_bf16 v[180:183], a[132:135], a[84:87], v[180:183]
  buffer_load_dwordx4 v229, s[48:51], s57 offen lds
  v_mfma_f32_16x16x32_bf16 v[184:187], a[132:135], a[88:91], v[184:187]
  ds_read_b64_tr_b16 a[130:131], v226 offset:32320
  v_mfma_f32_16x16x32_bf16 v[188:191], a[132:135], a[92:95], v[188:191]
  ds_read_b64_tr_b16 a[132:133], v226 offset:35904
  v_mfma_f32_16x16x32_bf16 v[192:195], a[136:139], a[80:83], v[192:195]
  ds_read_b64_tr_b16 a[134:135], v226 offset:39488
  v_mfma_f32_16x16x32_bf16 v[196:199], a[136:139], a[84:87], v[196:199]
  s_add_u32 m0, s52, 59392
  s_add_u32 s57, s53, 4587520
  v_mfma_f32_16x16x32_bf16 v[200:203], a[136:139], a[88:91], v[200:203]
  buffer_load_dwordx4 v230, s[48:51], s57 offen lds
  v_mfma_f32_16x16x32_bf16 v[204:207], a[136:139], a[92:95], v[204:207]
  ds_read_b64_tr_b16 a[136:137], v226 offset:28768
  v_mfma_f32_16x16x32_bf16 v[208:211], a[140:143], a[80:83], v[208:211]
  ds_read_b64_tr_b16 a[138:139], v226 offset:32352
  v_mfma_f32_16x16x32_bf16 v[212:215], a[140:143], a[84:87], v[212:215]
  v_mfma_f32_16x16x32_bf16 v[216:219], a[140:143], a[88:91], v[216:219]
  v_mfma_f32_16x16x32_bf16 v[220:223], a[140:143], a[92:95], v[220:223]
  ds_read_b64_tr_b16 a[140:141], v226 offset:35936
  s_waitcnt vmcnt(42) lgkmcnt(13)
  v_mfma_f32_16x16x32_bf16 v[0:3], a[144:147], a[96:99], v[0:3]
  ds_read_b64_tr_b16 a[142:143], v226 offset:39520
  s_waitcnt vmcnt(41)
  v_mfma_f32_16x16x32_bf16 v[4:7], a[144:147], a[100:103], v[4:7]
  buffer_load_dwordx4 a[164:167], v224, s[12:15], s31 offen offset:1024 sc1
  s_waitcnt vmcnt(41)
  v_mfma_f32_16x16x32_bf16 v[8:11], a[144:147], a[104:107], v[8:11]
  s_waitcnt vmcnt(40)
  v_mfma_f32_16x16x32_bf16 v[12:15], a[144:147], a[108:111], v[12:15]
  ds_read_b64_tr_b16 a[144:145], v226 offset:28800
  s_waitcnt lgkmcnt(13)
  v_mfma_f32_16x16x32_bf16 v[16:19], a[148:151], a[96:99], v[16:19]
  ds_read_b64_tr_b16 a[146:147], v226 offset:32384
  v_mfma_f32_16x16x32_bf16 v[20:23], a[148:151], a[100:103], v[20:23]
  s_add_u32 m0, s52, 60416
  s_add_u32 s57, s53, 4587520
  v_mfma_f32_16x16x32_bf16 v[24:27], a[148:151], a[104:107], v[24:27]
  buffer_load_dwordx4 v231, s[48:51], s57 offen lds
  v_mfma_f32_16x16x32_bf16 v[28:31], a[148:151], a[108:111], v[28:31]
  ds_read_b64_tr_b16 a[148:149], v226 offset:35968
  s_waitcnt lgkmcnt(13)
  v_mfma_f32_16x16x32_bf16 v[32:35], a[152:155], a[96:99], v[32:35]
  ds_read_b64_tr_b16 a[150:151], v226 offset:39552
  v_mfma_f32_16x16x32_bf16 v[36:39], a[152:155], a[100:103], v[36:39]
  v_mfma_f32_16x16x32_bf16 v[40:43], a[152:155], a[104:107], v[40:43]
  v_mfma_f32_16x16x32_bf16 v[44:47], a[152:155], a[108:111], v[44:47]
  ds_read_b64_tr_b16 a[152:153], v226 offset:28832
  s_waitcnt lgkmcnt(13)
  v_mfma_f32_16x16x32_bf16 v[48:51], a[156:159], a[96:99], v[48:51]
  s_add_u32 m0, s52, 61440
  s_add_u32 s57, s53, 4587520
  ds_read_b64_tr_b16 a[154:155], v226 offset:32416
  v_mfma_f32_16x16x32_bf16 v[52:55], a[156:159], a[100:103], v[52:55]
  buffer_load_dwordx4 v232, s[48:51], s57 offen lds
  v_mfma_f32_16x16x32_bf16 v[56:59], a[156:159], a[104:107], v[56:59]
  v_mfma_f32_16x16x32_bf16 v[60:63], a[156:159], a[108:111], v[60:63]
  ds_read_b64_tr_b16 a[156:157], v226 offset:36000
  s_waitcnt lgkmcnt(13)
  v_mfma_f32_16x16x32_bf16 v[64:67], a[128:131], a[96:99], v[64:67]
  ds_read_b64_tr_b16 a[158:159], v226 offset:39584
  v_mfma_f32_16x16x32_bf16 v[68:71], a[128:131], a[100:103], v[68:71]
  v_mfma_f32_16x16x32_bf16 v[72:75], a[128:131], a[104:107], v[72:75]
  v_mfma_f32_16x16x32_bf16 v[76:79], a[128:131], a[108:111], v[76:79]
  ds_read_b64_tr_b16 a[128:129], v226 offset:28864
  s_waitcnt lgkmcnt(13)
  v_mfma_f32_16x16x32_bf16 v[80:83], a[132:135], a[96:99], v[80:83]
  s_add_u32 m0, s52, 62464
  s_add_u32 s57, s53, 4587520
  ds_read_b64_tr_b16 a[130:131], v226 offset:32448
  v_mfma_f32_16x16x32_bf16 v[84:87], a[132:135], a[100:103], v[84:87]
  buffer_load_dwordx4 v233, s[48:51], s57 offen lds
  v_mfma_f32_16x16x32_bf16 v[88:91], a[132:135], a[104:107], v[88:91]
  v_mfma_f32_16x16x32_bf16 v[92:95], a[132:135], a[108:111], v[92:95]
  ds_read_b64_tr_b16 a[132:133], v226 offset:36032
  s_waitcnt lgkmcnt(13)
  v_mfma_f32_16x16x32_bf16 v[96:99], a[136:139], a[96:99], v[96:99]
  s_add_u32 m0, s52, 63488
  s_add_u32 s57, s53, 4587520
  ds_read_b64_tr_b16 a[134:135], v226 offset:39616
  v_mfma_f32_16x16x32_bf16 v[100:103], a[136:139], a[100:103], v[100:103]
  buffer_load_dwordx4 v234, s[48:51], s57 offen lds
  v_mfma_f32_16x16x32_bf16 v[104:107], a[136:139], a[104:107], v[104:107]
  v_mfma_f32_16x16x32_bf16 v[108:111], a[136:139], a[108:111], v[108:111]
  ds_read_b64_tr_b16 a[136:137], v226 offset:43008
  s_waitcnt lgkmcnt(13)
  v_mfma_f32_16x16x32_bf16 v[112:115], a[140:143], a[96:99], v[112:115]
  ds_read_b64_tr_b16 a[138:139], v226 offset:46592
  v_mfma_f32_16x16x32_bf16 v[116:119], a[140:143], a[100:103], v[116:119]
  v_mfma_f32_16x16x32_bf16 v[120:123], a[140:143], a[104:107], v[120:123]
  v_mfma_f32_16x16x32_bf16 v[124:127], a[140:143], a[108:111], v[124:127]
  ds_read_b64_tr_b16 a[140:141], v226 offset:50176
  s_waitcnt lgkmcnt(13)
  v_mfma_f32_16x16x32_bf16 v[128:131], a[144:147], a[96:99], v[128:131]
  ds_read_b64_tr_b16 a[142:143], v226 offset:53760
  v_mfma_f32_16x16x32_bf16 v[132:135], a[144:147], a[100:103], v[132:135]
  buffer_load_dwordx4 a[168:171], v224, s[12:15], s31 offen offset:2048 sc1
  v_mfma_f32_16x16x32_bf16 v[136:139], a[144:147], a[104:107], v[136:139]
  v_mfma_f32_16x16x32_bf16 v[140:143], a[144:147], a[108:111], v[140:143]
  ds_read_b64_tr_b16 a[144:145], v226 offset:43040
  s_waitcnt lgkmcnt(13)
  v_mfma_f32_16x16x32_bf16 v[144:147], a[148:151], a[96:99], v[144:147]
  ds_read_b64_tr_b16 a[146:147], v226 offset:46624
  v_mfma_f32_16x16x32_bf16 v[148:151], a[148:151], a[100:103], v[148:151]
  s_add_u32 s28, s22, 311296
  v_mfma_f32_16x16x32_bf16 v[152:155], a[148:151], a[104:107], v[152:155]
  buffer_load_dwordx4 a[48:51], v224, s[12:15], s28 offen offset:0 sc1
  v_mfma_f32_16x16x32_bf16 v[156:159], a[148:151], a[108:111], v[156:159]
  ds_read_b64_tr_b16 a[148:149], v226 offset:50208
  s_waitcnt lgkmcnt(13)
  v_mfma_f32_16x16x32_bf16 v[160:163], a[152:155], a[96:99], v[160:163]
  ds_read_b64_tr_b16 a[150:151], v226 offset:53792
  v_mfma_f32_16x16x32_bf16 v[164:167], a[152:155], a[100:103], v[164:167]
  v_mfma_f32_16x16x32_bf16 v[168:171], a[152:155], a[104:107], v[168:171]
  v_mfma_f32_16x16x32_bf16 v[172:175], a[152:155], a[108:111], v[172:175]
  ds_read_b64_tr_b16 a[152:153], v226 offset:43072
  s_waitcnt lgkmcnt(13)
  v_mfma_f32_16x16x32_bf16 v[176:179], a[156:159], a[96:99], v[176:179]
  s_add_u32 s28, s22, 311296
  ds_read_b64_tr_b16 a[154:155], v226 offset:46656
  v_mfma_f32_16x16x32_bf16 v[180:183], a[156:159], a[100:103], v[180:183]
  buffer_load_dwordx4 a[52:55], v224, s[12:15], s28 offen offset:1024 sc1
  v_mfma_f32_16x16x32_bf16 v[184:187], a[156:159], a[104:107], v[184:187]
  v_mfma_f32_16x16x32_bf16 v[188:191], a[156:159], a[108:111], v[188:191]
  ds_read_b64_tr_b16 a[156:157], v226 offset:50240
  s_waitcnt lgkmcnt(13)
  v_mfma_f32_16x16x32_bf16 v[192:195], a[128:131], a[96:99], v[192:195]
  ds_read_b64_tr_b16 a[158:159], v226 offset:53824
  v_mfma_f32_16x16x32_bf16 v[196:199], a[128:131], a[100:103], v[196:199]
  s_add_u32 s28, s22, 311296
  v_mfma_f32_16x16x32_bf16 v[200:203], a[128:131], a[104:107], v[200:203]
  buffer_load_dwordx4 a[56:59], v224, s[12:15], s28 offen offset:2048 sc1
  v_mfma_f32_16x16x32_bf16 v[204:207], a[128:131], a[108:111], v[204:207]
  ds_read_b64_tr_b16 a[128:129], v226 offset:43104
  s_waitcnt lgkmcnt(13)
  v_mfma_f32_16x16x32_bf16 v[208:211], a[132:135], a[96:99], v[208:211]
  ds_read_b64_tr_b16 a[130:131], v226 offset:46688
  v_mfma_f32_16x16x32_bf16 v[212:215], a[132:135], a[100:103], v[212:215]
  v_mfma_f32_16x16x32_bf16 v[216:219], a[132:135], a[104:107], v[216:219]
  v_mfma_f32_16x16x32_bf16 v[220:223], a[132:135], a[108:111], v[220:223]
  ds_read_b64_tr_b16 a[132:133], v226 offset:50272
  s_waitcnt vmcnt(38) lgkmcnt(13)
  v_mfma_f32_16x16x32_bf16 v[0:3], a[136:139], a[112:115], v[0:3]
  s_add_u32 s28, s22, 311296
  ds_read_b64_tr_b16 a[134:135], v226 offset:53856
  s_waitcnt vmcnt(37)
  v_mfma_f32_16x16x32_bf16 v[4:7], a[136:139], a[116:119], v[4:7]
  buffer_load_dwordx4 a[60:63], v224, s[12:15], s28 offen offset:3072 sc1
  s_waitcnt vmcnt(37)
  v_mfma_f32_16x16x32_bf16 v[8:11], a[136:139], a[120:123], v[8:11]
  s_waitcnt vmcnt(36)
  v_mfma_f32_16x16x32_bf16 v[12:15], a[136:139], a[124:127], v[12:15]
  ds_read_b64_tr_b16 a[136:137], v226 offset:43136
  s_waitcnt lgkmcnt(13)
  v_mfma_f32_16x16x32_bf16 v[16:19], a[140:143], a[112:115], v[16:19]
  ds_read_b64_tr_b16 a[138:139], v226 offset:46720
  v_mfma_f32_16x16x32_bf16 v[20:23], a[140:143], a[116:119], v[20:23]
  v_mfma_f32_16x16x32_bf16 v[24:27], a[140:143], a[120:123], v[24:27]
  buffer_load_dwordx4 a[172:175], v224, s[12:15], s31 offen offset:3072 sc1
  v_mfma_f32_16x16x32_bf16 v[28:31], a[140:143], a[124:127], v[28:31]
  ds_read_b64_tr_b16 a[140:141], v226 offset:50304
  s_waitcnt lgkmcnt(13)
  v_mfma_f32_16x16x32_bf16 v[32:35], a[144:147], a[112:115], v[32:35]
  ds_read_b64_tr_b16 a[142:143], v226 offset:53888
  v_mfma_f32_16x16x32_bf16 v[36:39], a[144:147], a[116:119], v[36:39]
  v_mfma_f32_16x16x32_bf16 v[40:43], a[144:147], a[120:123], v[40:43]
  v_mfma_f32_16x16x32_bf16 v[44:47], a[144:147], a[124:127], v[44:47]
  ds_read_b64_tr_b16 a[144:145], v226 offset:43168
  s_waitcnt lgkmcnt(13)
  v_mfma_f32_16x16x32_bf16 v[48:51], a[148:151], a[112:115], v[48:51]
  s_add_u32 s28, s22, 327680
  ds_read_b64_tr_b16 a[146:147], v226 offset:46752
  v_mfma_f32_16x16x32_bf16 v[52:55], a[148:151], a[116:119], v[52:55]
  buffer_load_dwordx4 a[64:67], v224, s[12:15], s28 offen offset:0 sc1
  v_mfma_f32_16x16x32_bf16 v[56:59], a[148:151], a[120:123], v[56:59]
  v_mfma_f32_16x16x32_bf16 v[60:63], a[148:151], a[124:127], v[60:63]
  ds_read_b64_tr_b16 a[148:149], v226 offset:50336
  s_waitcnt lgkmcnt(13)
  v_mfma_f32_16x16x32_bf16 v[64:67], a[152:155], a[112:115], v[64:67]
  ds_read_b64_tr_b16 a[150:151], v226 offset:53920
  v_mfma_f32_16x16x32_bf16 v[68:71], a[152:155], a[116:119], v[68:71]
  v_mfma_f32_16x16x32_bf16 v[72:75], a[152:155], a[120:123], v[72:75]
  v_mfma_f32_16x16x32_bf16 v[76:79], a[152:155], a[124:127], v[76:79]
  ds_read_b64_tr_b16 a[152:153], v226 offset:43200
  s_waitcnt lgkmcnt(13)
  v_mfma_f32_16x16x32_bf16 v[80:83], a[156:159], a[112:115], v[80:83]
  s_add_u32 s28, s22, 327680
  ds_read_b64_tr_b16 a[154:155], v226 offset:46784
  v_mfma_f32_16x16x32_bf16 v[84:87], a[156:159], a[116:119], v[84:87]
  buffer_load_dwordx4 a[68:71], v224, s[12:15], s28 offen offset:1024 sc1
  v_mfma_f32_16x16x32_bf16 v[88:91], a[156:159], a[120:123], v[88:91]
  v_mfma_f32_16x16x32_bf16 v[92:95], a[156:159], a[124:127], v[92:95]
  ds_read_b64_tr_b16 a[156:157], v226 offset:50368
  s_waitcnt lgkmcnt(13)
  v_mfma_f32_16x16x32_bf16 v[96:99], a[128:131], a[112:115], v[96:99]
  s_add_u32 s28, s22, 327680
  ds_read_b64_tr_b16 a[158:159], v226 offset:53952
  v_mfma_f32_16x16x32_bf16 v[100:103], a[128:131], a[116:119], v[100:103]
  buffer_load_dwordx4 a[72:75], v224, s[12:15], s28 offen offset:2048 sc1
  v_mfma_f32_16x16x32_bf16 v[104:107], a[128:131], a[120:123], v[104:107]
  v_mfma_f32_16x16x32_bf16 v[108:111], a[128:131], a[124:127], v[108:111]
  s_waitcnt lgkmcnt(12)
  v_mfma_f32_16x16x32_bf16 v[112:115], a[132:135], a[112:115], v[112:115]
  v_mfma_f32_16x16x32_bf16 v[116:119], a[132:135], a[116:119], v[116:119]
  v_mfma_f32_16x16x32_bf16 v[120:123], a[132:135], a[120:123], v[120:123]
  v_mfma_f32_16x16x32_bf16 v[124:127], a[132:135], a[124:127], v[124:127]
  s_waitcnt lgkmcnt(10)
  v_mfma_f32_16x16x32_bf16 v[128:131], a[136:139], a[112:115], v[128:131]
  s_add_u32 s28, s22, 327680
  v_mfma_f32_16x16x32_bf16 v[132:135], a[136:139], a[116:119], v[132:135]
  buffer_load_dwordx4 a[76:79], v224, s[12:15], s28 offen offset:3072 sc1
  v_mfma_f32_16x16x32_bf16 v[136:139], a[136:139], a[120:123], v[136:139]
  v_mfma_f32_16x16x32_bf16 v[140:143], a[136:139], a[124:127], v[140:143]
  s_add_u32 s53, s53, 1835008
  s_add_u32 s22, s22, 131072
  s_add_u32 s64, s64, 4096
  s_sub_u32 s23, s23, 1
  s_cmp_lg_u32 s23, 0
  s_cbranch_scc1 fa_kernel_g1loop
  s_waitcnt vmcnt(27)
  s_barrier
  ds_read_b64_tr_b16 a[128:129], v225 offset:0
  s_waitcnt lgkmcnt(9)
  v_mfma_f32_16x16x32_bf16 v[144:147], a[140:143], a[112:115], v[144:147]
  ds_read_b64_tr_b16 a[130:131], v225 offset:3584
  v_mfma_f32_16x16x32_bf16 v[148:151], a[140:143], a[116:119], v[148:151]
  s_add_u32 s28, s22, 212992
  ds_read_b64_tr_b16 a[132:133], v225 offset:7168
  v_mfma_f32_16x16x32_bf16 v[152:155], a[140:143], a[120:123], v[152:155]
  buffer_load_dwordx4 a[80:83], v224, s[12:15], s28 offen offset:0 sc1
  v_mfma_f32_16x16x32_bf16 v[156:159], a[140:143], a[124:127], v[156:159]
  ds_read_b64_tr_b16 a[134:135], v225 offset:10752
  s_waitcnt lgkmcnt(10)
  v_mfma_f32_16x16x32_bf16 v[160:163], a[144:147], a[112:115], v[160:163]
  ds_read_b64_tr_b16 a[136:137], v225 offset:14336
  v_mfma_f32_16x16x32_bf16 v[164:167], a[144:147], a[116:119], v[164:167]
  ds_read_b64_tr_b16 a[138:139], v225 offset:17920
  v_mfma_f32_16x16x32_bf16 v[168:171], a[144:147], a[120:123], v[168:171]
  ds_read_b64_tr_b16 a[140:141], v225 offset:21504
  v_mfma_f32_16x16x32_bf16 v[172:175], a[144:147], a[124:127], v[172:175]
  ds_read_b64_tr_b16 a[142:143], v225 offset:25088
  s_waitcnt lgkmcnt(12)
  v_mfma_f32_16x16x32_bf16 v[176:179], a[148:151], a[112:115], v[176:179]
  s_add_u32 s28, s22, 212992
  ds_read_b64_tr_b16 a[144:145], v225 offset:28672
  v_mfma_f32_16x16x32_bf16 v[180:183], a[148:151], a[116:119], v[180:183]
  buffer_load_dwordx4 a[84:87], v224, s[12:15], s28 offen offset:1024 sc1
  v_mfma_f32_16x16x32_bf16 v[184:187], a[148:151], a[120:123], v[184:187]
  ds_read_b64_tr_b16 a[146:147], v225 offset:32256
  v_mfma_f32_16x16x32_bf16 v[188:191], a[148:151], a[124:127], v[188:191]
  ds_read_b64_tr_b16 a[148:149], v225 offset:35840
  s_waitcnt lgkmcnt(13)
  v_mfma_f32_16x16x32_bf16 v[192:195], a[152:155], a[112:115], v[192:195]
  s_add_u32 s28, s22, 212992
  ds_read_b64_tr_b16 a[150:151], v225 offset:39424
  v_mfma_f32_16x16x32_bf16 v[196:199], a[152:155], a[116:119], v[196:199]
  buffer_load_dwordx4 a[88:91], v224, s[12:15], s28 offen offset:2048 sc1
  v_mfma_f32_16x16x32_bf16 v[200:203], a[152:155], a[120:123], v[200:203]
  v_mfma_f32_16x16x32_bf16 v[204:207], a[152:155], a[124:127], v[204:207]
  ds_read_b64_tr_b16 a[152:153], v225 offset:43008
  s_waitcnt lgkmcnt(13)
  v_mfma_f32_16x16x32_bf16 v[208:211], a[156:159], a[112:115], v[208:211]
  s_add_u32 s28, s22, 212992
  ds_read_b64_tr_b16 a[154:155], v225 offset:46592
  v_mfma_f32_16x16x32_bf16 v[212:215], a[156:159], a[116:119], v[212:215]
  buffer_load_dwordx4 a[92:95], v224, s[12:15], s28 offen offset:3072 sc1
  v_mfma_f32_16x16x32_bf16 v[216:219], a[156:159], a[120:123], v[216:219]
  v_mfma_f32_16x16x32_bf16 v[220:223], a[156:159], a[124:127], v[220:223]
  ds_read_b64_tr_b16 a[156:157], v225 offset:50176
  s_waitcnt lgkmcnt(13)
  v_mfma_f32_16x16x32_bf16 v[0:3], a[128:131], a[0:3], v[0:3]
  ds_read_b64_tr_b16 a[158:159], v225 offset:53760
  v_mfma_f32_16x16x32_bf16 v[4:7], a[128:131], a[4:7], v[4:7]
  s_add_u32 s28, s22, 229376
  v_mfma_f32_16x16x32_bf16 v[8:11], a[128:131], a[8:11], v[8:11]
  buffer_load_dwordx4 a[96:99], v224, s[12:15], s28 offen offset:0 sc1
  v_mfma_f32_16x16x32_bf16 v[12:15], a[128:131], a[12:15], v[12:15]
  ds_read_b64_tr_b16 a[128:129], v227 offset:14336
  s_waitcnt lgkmcnt(13)
  v_mfma_f32_16x16x32_bf16 v[16:19], a[132:135], a[0:3], v[16:19]
  ds_read_b64_tr_b16 a[130:131], v227 offset:17920
  v_mfma_f32_16x16x32_bf16 v[20:23], a[132:135], a[4:7], v[20:23]
  v_mfma_f32_16x16x32_bf16 v[24:27], a[132:135], a[8:11], v[24:27]
  v_mfma_f32_16x16x32_bf16 v[28:31], a[132:135], a[12:15], v[28:31]
  ds_read_b64_tr_b16 a[132:133], v227 offset:21504
  s_waitcnt vmcnt(31) lgkmcnt(13)
  v_mfma_f32_16x16x32_bf16 v[0:3], a[136:139], a[16:19], v[0:3]
  s_add_u32 s28, s22, 229376
  ds_read_b64_tr_b16 a[134:135], v227 offset:25088
  s_waitcnt vmcnt(30)
  v_mfma_f32_16x16x32_bf16 v[4:7], a[136:139], a[20:23], v[4:7]
  buffer_load_dwordx4 a[100:103], v224, s[12:15], s28 offen offset:1024 sc1
  s_waitcnt vmcnt(30)
  v_mfma_f32_16x16x32_bf16 v[8:11], a[136:139], a[24:27], v[8:11]
  s_waitcnt vmcnt(29)
  v_mfma_f32_16x16x32_bf16 v[12:15], a[136:139], a[28:31], v[12:15]
  s_waitcnt lgkmcnt(12)
  v_mfma_f32_16x16x32_bf16 v[16:19], a[140:143], a[16:19], v[16:19]
  s_add_u32 s28, s22, 229376
  v_mfma_f32_16x16x32_bf16 v[20:23], a[140:143], a[20:23], v[20:23]
  buffer_load_dwordx4 a[104:107], v224, s[12:15], s28 offen offset:2048 sc1
  v_mfma_f32_16x16x32_bf16 v[24:27], a[140:143], a[24:27], v[24:27]
  v_mfma_f32_16x16x32_bf16 v[28:31], a[140:143], a[28:31], v[28:31]
  s_waitcnt vmcnt(28) lgkmcnt(10)
  v_mfma_f32_16x16x32_bf16 v[0:3], a[144:147], a[32:35], v[0:3]
  s_add_u32 s28, s22, 229376
  s_waitcnt vmcnt(27)
  v_mfma_f32_16x16x32_bf16 v[4:7], a[144:147], a[36:39], v[4:7]
  buffer_load_dwordx4 a[108:111], v224, s[12:15], s28 offen offset:3072 sc1
  s_waitcnt vmcnt(27)
  v_mfma_f32_16x16x32_bf16 v[8:11], a[144:147], a[40:43], v[8:11]
  s_waitcnt vmcnt(26)
  v_mfma_f32_16x16x32_bf16 v[12:15], a[144:147], a[44:47], v[12:15]
  s_waitcnt vmcnt(18)
  s_barrier
  ds_read_b64_tr_b16 a[136:137], v226 offset:0
  s_waitcnt lgkmcnt(9)
  v_mfma_f32_16x16x32_bf16 v[16:19], a[148:151], a[32:35], v[16:19]
  ds_read_b64_tr_b16 a[138:139], v226 offset:3584
  v_mfma_f32_16x16x32_bf16 v[20:23], a[148:151], a[36:39], v[20:23]
  ds_read_b64_tr_b16 a[140:141], v226 offset:7168
  v_mfma_f32_16x16x32_bf16 v[24:27], a[148:151], a[40:43], v[24:27]
  ds_read_b64_tr_b16 a[142:143], v226 offset:10752
  v_mfma_f32_16x16x32_bf16 v[28:31], a[148:151], a[44:47], v[28:31]
  ds_read_b64_tr_b16 a[144:145], v226 offset:14336
  s_waitcnt vmcnt(16) lgkmcnt(11)
  v_mfma_f32_16x16x32_bf16 v[0:3], a[152:155], a[48:51], v[0:3]
  ds_read_b64_tr_b16 a[146:147], v226 offset:17920
  s_waitcnt vmcnt(15)
  v_mfma_f32_16x16x32_bf16 v[4:7], a[152:155], a[52:55], v[4:7]
  ds_read_b64_tr_b16 a[148:149], v226 offset:21504
  s_waitcnt vmcnt(14)
  v_mfma_f32_16x16x32_bf16 v[8:11], a[152:155], a[56:59], v[8:11]
  ds_read_b64_tr_b16 a[150:151], v226 offset:25088
  s_waitcnt vmcnt(13)
  v_mfma_f32_16x16x32_bf16 v[12:15], a[152:155], a[60:63], v[12:15]
  ds_read_b64_tr_b16 a[152:153], v227 offset:0
  s_waitcnt lgkmcnt(13)
  v_mfma_f32_16x16x32_bf16 v[16:19], a[156:159], a[48:51], v[16:19]
  ds_read_b64_tr_b16 a[154:155], v227 offset:3584
  v_mfma_f32_16x16x32_bf16 v[20:23], a[156:159], a[52:55], v[20:23]
  v_mfma_f32_16x16x32_bf16 v[24:27], a[156:159], a[56:59], v[24:27]
  v_mfma_f32_16x16x32_bf16 v[28:31], a[156:159], a[60:63], v[28:31]
  ds_read_b64_tr_b16 a[156:157], v227 offset:7168
  s_waitcnt lgkmcnt(13)
  v_mfma_f32_16x16x32_bf16 v[0:3], a[128:131], a[160:163], v[0:3]
  ds_read_b64_tr_b16 a[158:159], v227 offset:10752
  v_mfma_f32_16x16x32_bf16 v[4:7], a[128:131], a[164:167], v[4:7]
  v_mfma_f32_16x16x32_bf16 v[8:11], a[128:131], a[168:171], v[8:11]
  s_waitcnt vmcnt(12)
  v_mfma_f32_16x16x32_bf16 v[12:15], a[128:131], a[172:175], v[12:15]
  ds_read_b64_tr_b16 a[128:129], v225 offset:32
  s_waitcnt lgkmcnt(13)
  v_mfma_f32_16x16x32_bf16 v[16:19], a[132:135], a[160:163], v[16:19]
  ds_read_b64_tr_b16 a[130:131], v225 offset:3616
  v_mfma_f32_16x16x32_bf16 v[20:23], a[132:135], a[164:167], v[20:23]
  v_mfma_f32_16x16x32_bf16 v[24:27], a[132:135], a[168:171], v[24:27]
  v_mfma_f32_16x16x32_bf16 v[28:31], a[132:135], a[172:175], v[28:31]
  ds_read_b64_tr_b16 a[132:133], v225 offset:7200
  s_waitcnt vmcnt(11) lgkmcnt(13)
  v_mfma_f32_16x16x32_bf16 v[0:3], a[136:139], a[64:67], v[0:3]
  ds_read_b64_tr_b16 a[134:135], v225 offset:10784
  s_waitcnt vmcnt(10)
  v_mfma_f32_16x16x32_bf16 v[4:7], a[136:139], a[68:71], v[4:7]
  s_waitcnt vmcnt(9)
  v_mfma_f32_16x16x32_bf16 v[8:11], a[136:139], a[72:75], v[8:11]
  s_waitcnt vmcnt(8)
  v_mfma_f32_16x16x32_bf16 v[12:15], a[136:139], a[76:79], v[12:15]
  ds_read_b64_tr_b16 a[136:137], v225 offset:14368
  s_waitcnt lgkmcnt(13)
  v_mfma_f32_16x16x32_bf16 v[16:19], a[140:143], a[64:67], v[16:19]
  ds_read_b64_tr_b16 a[138:139], v225 offset:17952
  v_mfma_f32_16x16x32_bf16 v[20:23], a[140:143], a[68:71], v[20:23]
  v_mfma_f32_16x16x32_bf16 v[24:27], a[140:143], a[72:75], v[24:27]
  v_mfma_f32_16x16x32_bf16 v[28:31], a[140:143], a[76:79], v[28:31]
  ds_read_b64_tr_b16 a[140:141], v225 offset:21536
  s_waitcnt vmcnt(7) lgkmcnt(13)
  v_mfma_f32_16x16x32_bf16 v[0:3], a[144:147], a[80:83], v[0:3]
  ds_read_b64_tr_b16 a[142:143], v225 offset:25120
  s_waitcnt vmcnt(6)
  v_mfma_f32_16x16x32_bf16 v[4:7], a[144:147], a[84:87], v[4:7]
  s_waitcnt vmcnt(5)
  v_mfma_f32_16x16x32_bf16 v[8:11], a[144:147], a[88:91], v[8:11]
  s_waitcnt vmcnt(4)
  v_mfma_f32_16x16x32_bf16 v[12:15], a[144:147], a[92:95], v[12:15]
  ds_read_b64_tr_b16 a[144:145], v225 offset:28704
  s_waitcnt lgkmcnt(13)
  v_mfma_f32_16x16x32_bf16 v[16:19], a[148:151], a[80:83], v[16:19]
  ds_read_b64_tr_b16 a[146:147], v225 offset:32288
  v_mfma_f32_16x16x32_bf16 v[20:23], a[148:151], a[84:87], v[20:23]
  v_mfma_f32_16x16x32_bf16 v[24:27], a[148:151], a[88:91], v[24:27]
  v_mfma_f32_16x16x32_bf16 v[28:31], a[148:151], a[92:95], v[28:31]
  ds_read_b64_tr_b16 a[148:149], v225 offset:35872
  s_waitcnt vmcnt(3) lgkmcnt(13)
  v_mfma_f32_16x16x32_bf16 v[0:3], a[152:155], a[96:99], v[0:3]
  ds_read_b64_tr_b16 a[150:151], v225 offset:39456
  s_waitcnt vmcnt(2)
  v_mfma_f32_16x16x32_bf16 v[4:7], a[152:155], a[100:103], v[4:7]
  s_waitcnt vmcnt(1)
  v_mfma_f32_16x16x32_bf16 v[8:11], a[152:155], a[104:107], v[8:11]
  s_waitcnt vmcnt(0)
  v_mfma_f32_16x16x32_bf16 v[12:15], a[152:155], a[108:111], v[12:15]
  ds_read_b64_tr_b16 a[152:153], v225 offset:43040
  s_waitcnt lgkmcnt(13)
  v_mfma_f32_16x16x32_bf16 v[16:19], a[156:159], a[96:99], v[16:19]
  ds_read_b64_tr_b16 a[154:155], v225 offset:46624
  v_mfma_f32_16x16x32_bf16 v[20:23], a[156:159], a[100:103], v[20:23]
  v_mfma_f32_16x16x32_bf16 v[24:27], a[156:159], a[104:107], v[24:27]
  v_mfma_f32_16x16x32_bf16 v[28:31], a[156:159], a[108:111], v[28:31]
  ds_read_b64_tr_b16 a[156:157], v225 offset:50208
  s_waitcnt lgkmcnt(13)
  v_mfma_f32_16x16x32_bf16 v[32:35], a[128:131], a[0:3], v[32:35]
  ds_read_b64_tr_b16 a[158:159], v225 offset:53792
  v_mfma_f32_16x16x32_bf16 v[36:39], a[128:131], a[4:7], v[36:39]
  v_mfma_f32_16x16x32_bf16 v[40:43], a[128:131], a[8:11], v[40:43]
  v_mul_f32 v236, v0, v0
  v_mul_f32 v237, v1, v1
  v_mul_f32 v238, v2, v2
  v_mfma_f32_16x16x32_bf16 v[44:47], a[128:131], a[12:15], v[44:47]
  ds_read_b64_tr_b16 a[128:129], v226 offset:32
  s_waitcnt lgkmcnt(13)
  v_mfma_f32_16x16x32_bf16 v[48:51], a[132:135], a[0:3], v[48:51]
  ds_read_b64_tr_b16 a[130:131], v226 offset:3616
  v_mul_f32 v239, v3, v3
  v_mfma_f32_16x16x32_bf16 v[52:55], a[132:135], a[4:7], v[52:55]
  v_fma_f32 v236, v236, v244, v246
  v_fma_f32 v237, v237, v244, v246
  v_mfma_f32_16x16x32_bf16 v[56:59], a[132:135], a[8:11], v[56:59]
  v_fma_f32 v238, v238, v244, v246
  v_fma_f32 v239, v239, v244, v246
  v_mfma_f32_16x16x32_bf16 v[60:63], a[132:135], a[12:15], v[60:63]
  ds_read_b64_tr_b16 a[132:133], v226 offset:7200
  s_waitcnt lgkmcnt(13)
  v_mfma_f32_16x16x32_bf16 v[32:35], a[136:139], a[16:19], v[32:35]
  ds_read_b64_tr_b16 a[134:135], v226 offset:10784
  v_mul_f32 v236, v236, v0
  v_mfma_f32_16x16x32_bf16 v[36:39], a[136:139], a[20:23], v[36:39]
  v_mul_f32 v237, v237, v1
  v_mul_f32 v238, v238, v2
  v_mul_f32 v239, v239, v3
  v_mfma_f32_16x16x32_bf16 v[40:43], a[136:139], a[24:27], v[40:43]
  v_exp_f32 v236, v236
  v_mfma_f32_16x16x32_bf16 v[44:47], a[136:139], a[28:31], v[44:47]
  ds_read_b64_tr_b16 a[136:137], v226 offset:14368
  s_waitcnt lgkmcnt(13)
  v_mfma_f32_16x16x32_bf16 v[48:51], a[140:143], a[16:19], v[48:51]
  ds_read_b64_tr_b16 a[138:139], v226 offset:17952
  v_mul_f32 v16, v0, v16
  v_mfma_f32_16x16x32_bf16 v[52:55], a[140:143], a[20:23], v[52:55]
  v_exp_f32 v237, v237
  v_mfma_f32_16x16x32_bf16 v[56:59], a[140:143], a[24:27], v[56:59]
  v_mul_f32 v17, v1, v17
  v_exp_f32 v238, v238
  v_mfma_f32_16x16x32_bf16 v[60:63], a[140:143], a[28:31], v[60:63]
  ds_read_b64_tr_b16 a[140:141], v226 offset:21536
  s_waitcnt lgkmcnt(13)
  v_mfma_f32_16x16x32_bf16 v[32:35], a[144:147], a[32:35], v[32:35]
  ds_read_b64_tr_b16 a[142:143], v226 offset:25120
  v_mfma_f32_16x16x32_bf16 v[36:39], a[144:147], a[36:39], v[36:39]
  v_mul_f32 v18, v2, v18
  v_exp_f32 v239, v239
  v_mfma_f32_16x16x32_bf16 v[40:43], a[144:147], a[40:43], v[40:43]
  v_mul_f32 v19, v3, v19
  v_add_f32 v236, 1.0, v236
  v_mfma_f32_16x16x32_bf16 v[44:47], a[144:147], a[44:47], v[44:47]
  ds_read_b64_tr_b16 a[144:145], v227 offset:32
  s_waitcnt lgkmcnt(13)
  v_mfma_f32_16x16x32_bf16 v[48:51], a[148:151], a[32:35], v[48:51]
  ds_read_b64_tr_b16 a[146:147], v227 offset:3616
  v_add_f32 v237, 1.0, v237
  v_mfma_f32_16x16x32_bf16 v[52:55], a[148:151], a[36:39], v[52:55]
  v_add_f32 v238, 1.0, v238
  v_add_f32 v239, 1.0, v239
  v_mfma_f32_16x16x32_bf16 v[56:59], a[148:151], a[40:43], v[56:59]
  v_rcp_f32 v236, v236
  v_rcp_f32 v237, v237
  v_mfma_f32_16x16x32_bf16 v[60:63], a[148:151], a[44:47], v[60:63]
  ds_read_b64_tr_b16 a[148:149], v227 offset:7200
  s_waitcnt lgkmcnt(13)
  v_mfma_f32_16x16x32_bf16 v[32:35], a[152:155], a[48:51], v[32:35]
  ds_read_b64_tr_b16 a[150:151], v227 offset:10784
  v_mfma_f32_16x16x32_bf16 v[36:39], a[152:155], a[52:55], v[36:39]
  v_rcp_f32 v238, v238
  v_mfma_f32_16x16x32_bf16 v[40:43], a[152:155], a[56:59], v[40:43]
  v_rcp_f32 v239, v239
  v_mfma_f32_16x16x32_bf16 v[44:47], a[152:155], a[60:63], v[44:47]
  ds_read_b64_tr_b16 a[152:153], v227 offset:14368
  s_waitcnt lgkmcnt(13)
  v_mfma_f32_16x16x32_bf16 v[48:51], a[156:159], a[48:51], v[48:51]
  ds_read_b64_tr_b16 a[154:155], v227 offset:17952
  v_mul_f32 v16, v16, v236
  v_mfma_f32_16x16x32_bf16 v[52:55], a[156:159], a[52:55], v[52:55]
  v_mul_f32 v17, v17, v237
  v_mul_f32 v18, v18, v238
  v_mfma_f32_16x16x32_bf16 v[56:59], a[156:159], a[56:59], v[56:59]
  v_mul_f32 v19, v19, v239
  v_cvt_pk_bf16_f32 v0, v16, v17
  v_cvt_pk_bf16_f32 v1, v18, v19
  v_mfma_f32_16x16x32_bf16 v[60:63], a[156:159], a[60:63], v[60:63]
  ds_read_b64_tr_b16 a[156:157], v227 offset:21536
  s_waitcnt lgkmcnt(13)
  v_mfma_f32_16x16x32_bf16 v[32:35], a[128:131], a[64:67], v[32:35]
  ds_read_b64_tr_b16 a[158:159], v227 offset:25120
  v_mul_f32 v240, v4, v4
  v_mfma_f32_16x16x32_bf16 v[36:39], a[128:131], a[68:71], v[36:39]
  v_mul_f32 v241, v5, v5
  v_mul_f32 v242, v6, v6
  v_mfma_f32_16x16x32_bf16 v[40:43], a[128:131], a[72:75], v[40:43]
  v_mul_f32 v243, v7, v7
  v_fma_f32 v240, v240, v244, v246
  v_mfma_f32_16x16x32_bf16 v[44:47], a[128:131], a[76:79], v[44:47]
  ds_read_b64_tr_b16 a[128:129], v225 offset:64
  s_waitcnt lgkmcnt(13)
  v_mfma_f32_16x16x32_bf16 v[48:51], a[132:135], a[64:67], v[48:51]
  ds_read_b64_tr_b16 a[130:131], v225 offset:3648
  v_fma_f32 v241, v241, v244, v246
  v_mfma_f32_16x16x32_bf16 v[52:55], a[132:135], a[68:71], v[52:55]
  v_fma_f32 v242, v242, v244, v246
  v_fma_f32 v243, v243, v244, v246
  v_mul_f32 v240, v240, v4
  v_mfma_f32_16x16x32_bf16 v[56:59], a[132:135], a[72:75], v[56:59]
  v_mul_f32 v241, v241, v5
  v_mul_f32 v242, v242, v6
  v_mfma_f32_16x16x32_bf16 v[60:63], a[132:135], a[76:79], v[60:63]
  ds_read_b64_tr_b16 a[132:133], v225 offset:7232
  s_waitcnt lgkmcnt(13)
  v_mfma_f32_16x16x32_bf16 v[32:35], a[136:139], a[80:83], v[32:35]
  ds_read_b64_tr_b16 a[134:135], v225 offset:10816
  v_mul_f32 v243, v243, v7
  v_mfma_f32_16x16x32_bf16 v[36:39], a[136:139], a[84:87], v[36:39]
  v_exp_f32 v240, v240
  v_mfma_f32_16x16x32_bf16 v[40:43], a[136:139], a[88:91], v[40:43]
  v_mul_f32 v20, v4, v20
  v_exp_f32 v241, v241
  v_mfma_f32_16x16x32_bf16 v[44:47], a[136:139], a[92:95], v[44:47]
  ds_read_b64_tr_b16 a[136:137], v225 offset:14400
  s_waitcnt lgkmcnt(13)
  v_mfma_f32_16x16x32_bf16 v[48:51], a[140:143], a[80:83], v[48:51]
  ds_read_b64_tr_b16 a[138:139], v225 offset:17984
  v_mfma_f32_16x16x32_bf16 v[52:55], a[140:143], a[84:87], v[52:55]
  v_mul_f32 v21, v5, v21
  v_exp_f32 v242, v242
  v_mfma_f32_16x16x32_bf16 v[56:59], a[140:143], a[88:91], v[56:59]
  v_mul_f32 v22, v6, v22
  v_exp_f32 v243, v243
  v_mfma_f32_16x16x32_bf16 v[60:63], a[140:143], a[92:95], v[60:63]
  ds_read_b64_tr_b16 a[140:141], v225 offset:21568
  s_waitcnt lgkmcnt(13)
  v_mfma_f32_16x16x32_bf16 v[32:35], a[144:147], a[96:99], v[32:35]
  ds_read_b64_tr_b16 a[142:143], v225 offset:25152
  v_mfma_f32_16x16x32_bf16 v[36:39], a[144:147], a[100:103], v[36:39]
  v_mul_f32 v23, v7, v23
  v_add_f32 v240, 1.0, v240
  v_mfma_f32_16x16x32_bf16 v[40:43], a[144:147], a[104:107], v[40:43]
  v_add_f32 v241, 1.0, v241
  v_add_f32 v242, 1.0, v242
  v_mfma_f32_16x16x32_bf16 v[44:47], a[144:147], a[108:111], v[44:47]
  ds_read_b64_tr_b16 a[144:145], v225 offset:28736
  s_waitcnt lgkmcnt(13)
  v_mfma_f32_16x16x32_bf16 v[48:51], a[148:151], a[96:99], v[48:51]
  ds_read_b64_tr_b16 a[146:147], v225 offset:32320
  v_add_f32 v243, 1.0, v243
  v_rcp_f32 v240, v240
  v_mfma_f32_16x16x32_bf16 v[52:55], a[148:151], a[100:103], v[52:55]
  v_rcp_f32 v241, v241
  v_mfma_f32_16x16x32_bf16 v[56:59], a[148:151], a[104:107], v[56:59]
  v_rcp_f32 v242, v242
  v_mfma_f32_16x16x32_bf16 v[60:63], a[148:151], a[108:111], v[60:63]
  ds_read_b64_tr_b16 a[148:149], v225 offset:35904
  s_waitcnt lgkmcnt(13)
  v_mfma_f32_16x16x32_bf16 v[32:35], a[152:155], a[160:163], v[32:35]
  ds_read_b64_tr_b16 a[150:151], v225 offset:39488
  v_mfma_f32_16x16x32_bf16 v[36:39], a[152:155], a[164:167], v[36:39]
  v_rcp_f32 v243, v243
  v_mfma_f32_16x16x32_bf16 v[40:43], a[152:155], a[168:171], v[40:43]
  v_mul_f32 v20, v20, v240
  v_mul_f32 v21, v21, v241
  v_mul_f32 v22, v22, v242
  v_mfma_f32_16x16x32_bf16 v[44:47], a[152:155], a[172:175], v[44:47]
  ds_read_b64_tr_b16 a[152:153], v225 offset:43072
  s_waitcnt lgkmcnt(13)
  v_mfma_f32_16x16x32_bf16 v[48:51], a[156:159], a[160:163], v[48:51]
  ds_read_b64_tr_b16 a[154:155], v225 offset:46656
  v_mul_f32 v23, v23, v243
  v_mfma_f32_16x16x32_bf16 v[52:55], a[156:159], a[164:167], v[52:55]
  v_cvt_pk_bf16_f32 v4, v20, v21
  v_cvt_pk_bf16_f32 v5, v22, v23
  v_mfma_f32_16x16x32_bf16 v[56:59], a[156:159], a[168:171], v[56:59]
  v_pk_mul_f32 v[236:237], v[8:9], v[8:9]
  v_pk_mul_f32 v[240:241], v[12:13], v[12:13]
  v_pk_mul_f32 v[238:239], v[10:11], v[10:11]
  v_pk_mul_f32 v[242:243], v[14:15], v[14:15]
  v_pk_fma_f32 v[236:237], v[236:237], v[244:245], v[246:247]
  v_pk_fma_f32 v[240:241], v[240:241], v[244:245], v[246:247]
  v_pk_fma_f32 v[238:239], v[238:239], v[244:245], v[246:247]
  v_pk_fma_f32 v[242:243], v[242:243], v[244:245], v[246:247]
  v_pk_mul_f32 v[236:237], v[236:237], v[8:9]
  v_pk_mul_f32 v[240:241], v[240:241], v[12:13]
  v_pk_mul_f32 v[238:239], v[238:239], v[10:11]
  v_pk_mul_f32 v[242:243], v[242:243], v[14:15]
  v_exp_f32 v236, v236
  v_exp_f32 v240, v240
  v_exp_f32 v237, v237
  v_exp_f32 v241, v241
  v_exp_f32 v238, v238
  v_exp_f32 v242, v242
  v_exp_f32 v239, v239
  v_exp_f32 v243, v243
  v_pk_mul_f32 v[24:25], v[8:9], v[24:25]
  v_pk_mul_f32 v[28:29], v[12:13], v[28:29]
  v_pk_mul_f32 v[26:27], v[10:11], v[26:27]
  v_pk_mul_f32 v[30:31], v[14:15], v[30:31]
  v_pk_add_f32 v[236:237], v[236:237], 1.0 op_sel_hi:[1,0]
  v_pk_add_f32 v[240:241], v[240:241], 1.0 op_sel_hi:[1,0]
  v_pk_add_f32 v[238:239], v[238:239], 1.0 op_sel_hi:[1,0]
  v_pk_add_f32 v[242:243], v[242:243], 1.0 op_sel_hi:[1,0]
  v_rcp_f32 v236, v236
  v_rcp_f32 v240, v240
  v_rcp_f32 v237, v237
  v_rcp_f32 v241, v241
  v_rcp_f32 v238, v238
  v_rcp_f32 v242, v242
  v_rcp_f32 v239, v239
  v_rcp_f32 v243, v243
  v_pk_mul_f32 v[24:25], v[24:25], v[236:237]
  v_pk_mul_f32 v[28:29], v[28:29], v[240:241]
  v_pk_mul_f32 v[26:27], v[26:27], v[238:239]
  v_pk_mul_f32 v[30:31], v[30:31], v[242:243]
  v_cvt_pk_bf16_f32 v8, v24, v25
  v_cvt_pk_bf16_f32 v12, v28, v29
  v_cvt_pk_bf16_f32 v9, v26, v27
  v_cvt_pk_bf16_f32 v13, v30, v31
  v_mfma_f32_16x16x32_bf16 v[60:63], a[156:159], a[172:175], v[60:63]
  ds_read_b64_tr_b16 a[156:157], v225 offset:50240
  s_waitcnt lgkmcnt(13)
  v_mfma_f32_16x16x32_bf16 v[64:67], a[128:131], a[0:3], v[64:67]
  ds_read_b64_tr_b16 a[158:159], v225 offset:53824
  v_mfma_f32_16x16x32_bf16 v[68:71], a[128:131], a[4:7], v[68:71]
  v_mfma_f32_16x16x32_bf16 v[72:75], a[128:131], a[8:11], v[72:75]
  v_mul_f32 v236, v32, v32
  v_mul_f32 v237, v33, v33
  v_mul_f32 v238, v34, v34
  v_mfma_f32_16x16x32_bf16 v[76:79], a[128:131], a[12:15], v[76:79]
  ds_read_b64_tr_b16 a[128:129], v226 offset:64
  s_waitcnt lgkmcnt(13)
  v_mfma_f32_16x16x32_bf16 v[80:83], a[132:135], a[0:3], v[80:83]
  ds_read_b64_tr_b16 a[130:131], v226 offset:3648
  v_mul_f32 v239, v35, v35
  v_mfma_f32_16x16x32_bf16 v[84:87], a[132:135], a[4:7], v[84:87]
  v_fma_f32 v236, v236, v244, v246
  v_fma_f32 v237, v237, v244, v246
  v_mfma_f32_16x16x32_bf16 v[88:91], a[132:135], a[8:11], v[88:91]
  v_fma_f32 v238, v238, v244, v246
  v_fma_f32 v239, v239, v244, v246
  v_mfma_f32_16x16x32_bf16 v[92:95], a[132:135], a[12:15], v[92:95]
  ds_read_b64_tr_b16 a[132:133], v226 offset:7232
  s_waitcnt lgkmcnt(13)
  v_mfma_f32_16x16x32_bf16 v[64:67], a[136:139], a[16:19], v[64:67]
  ds_read_b64_tr_b16 a[134:135], v226 offset:10816
  v_mul_f32 v236, v236, v32
  v_mfma_f32_16x16x32_bf16 v[68:71], a[136:139], a[20:23], v[68:71]
  v_mul_f32 v237, v237, v33
  v_mul_f32 v238, v238, v34
  v_mul_f32 v239, v239, v35
  v_mfma_f32_16x16x32_bf16 v[72:75], a[136:139], a[24:27], v[72:75]
  v_exp_f32 v236, v236
  v_mfma_f32_16x16x32_bf16 v[76:79], a[136:139], a[28:31], v[76:79]
  ds_read_b64_tr_b16 a[136:137], v226 offset:14400
  s_waitcnt lgkmcnt(13)
  v_mfma_f32_16x16x32_bf16 v[80:83], a[140:143], a[16:19], v[80:83]
  ds_read_b64_tr_b16 a[138:139], v226 offset:17984
  v_mul_f32 v48, v32, v48
  v_mfma_f32_16x16x32_bf16 v[84:87], a[140:143], a[20:23], v[84:87]
  v_exp_f32 v237, v237
  v_mfma_f32_16x16x32_bf16 v[88:91], a[140:143], a[24:27], v[88:91]
  v_mul_f32 v49, v33, v49
  v_exp_f32 v238, v238
  v_mfma_f32_16x16x32_bf16 v[92:95], a[140:143], a[28:31], v[92:95]
  ds_read_b64_tr_b16 a[140:141], v226 offset:21568
  s_waitcnt lgkmcnt(13)
  v_mfma_f32_16x16x32_bf16 v[64:67], a[144:147], a[32:35], v[64:67]
  ds_read_b64_tr_b16 a[142:143], v226 offset:25152
  v_mfma_f32_16x16x32_bf16 v[68:71], a[144:147], a[36:39], v[68:71]
  v_mul_f32 v50, v34, v50
  v_exp_f32 v239, v239
  v_mfma_f32_16x16x32_bf16 v[72:75], a[144:147], a[40:43], v[72:75]
  v_mul_f32 v51, v35, v51
  v_add_f32 v236, 1.0, v236
  v_mfma_f32_16x16x32_bf16 v[76:79], a[144:147], a[44:47], v[76:79]
  ds_read_b64_tr_b16 a[144:145], v227 offset:64
  s_waitcnt lgkmcnt(13)
  v_mfma_f32_16x16x32_bf16 v[80:83], a[148:151], a[32:35], v[80:83]
  ds_read_b64_tr_b16 a[146:147], v227 offset:3648
  v_add_f32 v237, 1.0, v237
  v_mfma_f32_16x16x32_bf16 v[84:87], a[148:151], a[36:39], v[84:87]
  v_add_f32 v238, 1.0, v238
  v_add_f32 v239, 1.0, v239
  v_mfma_f32_16x16x32_bf16 v[88:91], a[148:151], a[40:43], v[88:91]
  v_rcp_f32 v236, v236
  v_rcp_f32 v237, v237
  v_mfma_f32_16x16x32_bf16 v[92:95], a[148:151], a[44:47], v[92:95]
  ds_read_b64_tr_b16 a[148:149], v227 offset:7232
  s_waitcnt lgkmcnt(13)
  v_mfma_f32_16x16x32_bf16 v[64:67], a[152:155], a[48:51], v[64:67]
  ds_read_b64_tr_b16 a[150:151], v227 offset:10816
  v_mfma_f32_16x16x32_bf16 v[68:71], a[152:155], a[52:55], v[68:71]
  v_rcp_f32 v238, v238
  v_mfma_f32_16x16x32_bf16 v[72:75], a[152:155], a[56:59], v[72:75]
  v_rcp_f32 v239, v239
  v_mfma_f32_16x16x32_bf16 v[76:79], a[152:155], a[60:63], v[76:79]
  ds_read_b64_tr_b16 a[152:153], v227 offset:14400
  s_waitcnt lgkmcnt(13)
  v_mfma_f32_16x16x32_bf16 v[80:83], a[156:159], a[48:51], v[80:83]
  ds_read_b64_tr_b16 a[154:155], v227 offset:17984
  v_mul_f32 v48, v48, v236
  v_mfma_f32_16x16x32_bf16 v[84:87], a[156:159], a[52:55], v[84:87]
  v_mul_f32 v49, v49, v237
  v_mul_f32 v50, v50, v238
  v_mfma_f32_16x16x32_bf16 v[88:91], a[156:159], a[56:59], v[88:91]
  v_mul_f32 v51, v51, v239
  v_cvt_pk_bf16_f32 v2, v48, v49
  v_cvt_pk_bf16_f32 v3, v50, v51
  v_mfma_f32_16x16x32_bf16 v[92:95], a[156:159], a[60:63], v[92:95]
  ds_read_b64_tr_b16 a[156:157], v227 offset:21568
  s_waitcnt lgkmcnt(13)
  v_mfma_f32_16x16x32_bf16 v[64:67], a[128:131], a[64:67], v[64:67]
  ds_read_b64_tr_b16 a[158:159], v227 offset:25152
  buffer_store_dwordx4 v[0:3], v224, s[16:19], s25 offen offset:0 sc1
  v_mfma_f32_16x16x32_bf16 v[68:71], a[128:131], a[68:71], v[68:71]
  v_mul_f32 v240, v36, v36
  v_mul_f32 v241, v37, v37
  v_mfma_f32_16x16x32_bf16 v[72:75], a[128:131], a[72:75], v[72:75]
  v_mul_f32 v242, v38, v38
  v_mul_f32 v243, v39, v39
  v_mfma_f32_16x16x32_bf16 v[76:79], a[128:131], a[76:79], v[76:79]
  ds_read_b64_tr_b16 a[128:129], v225 offset:96
  s_waitcnt lgkmcnt(13)
  v_mfma_f32_16x16x32_bf16 v[80:83], a[132:135], a[64:67], v[80:83]
  ds_read_b64_tr_b16 a[130:131], v225 offset:3680
  v_fma_f32 v240, v240, v244, v246
  v_mfma_f32_16x16x32_bf16 v[84:87], a[132:135], a[68:71], v[84:87]
  v_fma_f32 v241, v241, v244, v246
  v_fma_f32 v242, v242, v244, v246
  v_fma_f32 v243, v243, v244, v246
  v_mfma_f32_16x16x32_bf16 v[88:91], a[132:135], a[72:75], v[88:91]
  v_mul_f32 v240, v240, v36
  v_mul_f32 v241, v241, v37
  v_mfma_f32_16x16x32_bf16 v[92:95], a[132:135], a[76:79], v[92:95]
  ds_read_b64_tr_b16 a[132:133], v225 offset:7264
  s_waitcnt lgkmcnt(13)
  v_mfma_f32_16x16x32_bf16 v[64:67], a[136:139], a[80:83], v[64:67]
  ds_read_b64_tr_b16 a[134:135], v225 offset:10848
  v_mul_f32 v242, v242, v38
  v_mfma_f32_16x16x32_bf16 v[68:71], a[136:139], a[84:87], v[68:71]
  v_mul_f32 v243, v243, v39
  v_exp_f32 v240, v240
  v_mfma_f32_16x16x32_bf16 v[72:75], a[136:139], a[88:91], v[72:75]
  v_mul_f32 v52, v36, v52
  v_mfma_f32_16x16x32_bf16 v[76:79], a[136:139], a[92:95], v[76:79]
  ds_read_b64_tr_b16 a[136:137], v225 offset:14432
  s_waitcnt lgkmcnt(13)
  v_mfma_f32_16x16x32_bf16 v[80:83], a[140:143], a[80:83], v[80:83]
  ds_read_b64_tr_b16 a[138:139], v225 offset:18016
  v_exp_f32 v241, v241
  v_mfma_f32_16x16x32_bf16 v[84:87], a[140:143], a[84:87], v[84:87]
  v_mul_f32 v53, v37, v53
  v_exp_f32 v242, v242
  v_mfma_f32_16x16x32_bf16 v[88:91], a[140:143], a[88:91], v[88:91]
  v_mul_f32 v54, v38, v54
  v_mfma_f32_16x16x32_bf16 v[92:95], a[140:143], a[92:95], v[92:95]
  ds_read_b64_tr_b16 a[140:141], v225 offset:21600
  s_waitcnt lgkmcnt(13)
  v_mfma_f32_16x16x32_bf16 v[64:67], a[144:147], a[96:99], v[64:67]
  ds_read_b64_tr_b16 a[142:143], v225 offset:25184
  v_exp_f32 v243, v243
  v_mfma_f32_16x16x32_bf16 v[68:71], a[144:147], a[100:103], v[68:71]
  v_mul_f32 v55, v39, v55
  v_mfma_f32_16x16x32_bf16 v[72:75], a[144:147], a[104:107], v[72:75]
  v_add_f32 v240, 1.0, v240
  v_add_f32 v241, 1.0, v241
  v_mfma_f32_16x16x32_bf16 v[76:79], a[144:147], a[108:111], v[76:79]
  ds_read_b64_tr_b16 a[144:145], v225 offset:28768
  s_waitcnt lgkmcnt(13)
  v_mfma_f32_16x16x32_bf16 v[80:83], a[148:151], a[96:99], v[80:83]
  ds_read_b64_tr_b16 a[146:147], v225 offset:32352
  v_add_f32 v242, 1.0, v242
  v_add_f32 v243, 1.0, v243
  v_mfma_f32_16x16x32_bf16 v[84:87], a[148:151], a[100:103], v[84:87]
  v_rcp_f32 v240, v240
  v_mfma_f32_16x16x32_bf16 v[88:91], a[148:151], a[104:107], v[88:91]
  v_rcp_f32 v241, v241
  v_mfma_f32_16x16x32_bf16 v[92:95], a[148:151], a[108:111], v[92:95]
  ds_read_b64_tr_b16 a[148:149], v225 offset:35936
  s_waitcnt lgkmcnt(13)
  v_mfma_f32_16x16x32_bf16 v[64:67], a[152:155], a[160:163], v[64:67]
  ds_read_b64_tr_b16 a[150:151], v225 offset:39520
  v_rcp_f32 v242, v242
  v_mfma_f32_16x16x32_bf16 v[68:71], a[152:155], a[164:167], v[68:71]
  v_rcp_f32 v243, v243
  v_mfma_f32_16x16x32_bf16 v[72:75], a[152:155], a[168:171], v[72:75]
  v_mul_f32 v52, v52, v240
  v_mul_f32 v53, v53, v241
  v_mfma_f32_16x16x32_bf16 v[76:79], a[152:155], a[172:175], v[76:79]
  ds_read_b64_tr_b16 a[152:153], v225 offset:43104
  s_waitcnt lgkmcnt(13)
  v_mfma_f32_16x16x32_bf16 v[80:83], a[156:159], a[160:163], v[80:83]
  ds_read_b64_tr_b16 a[154:155], v225 offset:46688
  v_mul_f32 v54, v54, v242
  v_mfma_f32_16x16x32_bf16 v[84:87], a[156:159], a[164:167], v[84:87]
  v_mul_f32 v55, v55, v243
  v_cvt_pk_bf16_f32 v6, v52, v53
  v_cvt_pk_bf16_f32 v7, v54, v55
  buffer_store_dwordx4 v[4:7], v224, s[16:19], s25 offen offset:1024 sc1
  v_mfma_f32_16x16x32_bf16 v[88:91], a[156:159], a[168:171], v[88:91]
  v_pk_mul_f32 v[236:237], v[40:41], v[40:41]
  v_pk_mul_f32 v[240:241], v[44:45], v[44:45]
  v_pk_mul_f32 v[238:239], v[42:43], v[42:43]
  v_pk_mul_f32 v[242:243], v[46:47], v[46:47]
  v_pk_fma_f32 v[236:237], v[236:237], v[244:245], v[246:247]
  v_pk_fma_f32 v[240:241], v[240:241], v[244:245], v[246:247]
  v_pk_fma_f32 v[238:239], v[238:239], v[244:245], v[246:247]
  v_pk_fma_f32 v[242:243], v[242:243], v[244:245], v[246:247]
  v_pk_mul_f32 v[236:237], v[236:237], v[40:41]
  v_pk_mul_f32 v[240:241], v[240:241], v[44:45]
  v_pk_mul_f32 v[238:239], v[238:239], v[42:43]
  v_pk_mul_f32 v[242:243], v[242:243], v[46:47]
  v_exp_f32 v236, v236
  v_exp_f32 v240, v240
  v_exp_f32 v237, v237
  v_exp_f32 v241, v241
  v_exp_f32 v238, v238
  v_exp_f32 v242, v242
  v_exp_f32 v239, v239
  v_exp_f32 v243, v243
  v_pk_mul_f32 v[56:57], v[40:41], v[56:57]
  v_pk_mul_f32 v[60:61], v[44:45], v[60:61]
  v_pk_mul_f32 v[58:59], v[42:43], v[58:59]
  v_pk_mul_f32 v[62:63], v[46:47], v[62:63]
  v_pk_add_f32 v[236:237], v[236:237], 1.0 op_sel_hi:[1,0]
  v_pk_add_f32 v[240:241], v[240:241], 1.0 op_sel_hi:[1,0]
  v_pk_add_f32 v[238:239], v[238:239], 1.0 op_sel_hi:[1,0]
  v_pk_add_f32 v[242:243], v[242:243], 1.0 op_sel_hi:[1,0]
  v_rcp_f32 v236, v236
  v_rcp_f32 v240, v240
  v_rcp_f32 v237, v237
  v_rcp_f32 v241, v241
  v_rcp_f32 v238, v238
  v_rcp_f32 v242, v242
  v_rcp_f32 v239, v239
  v_rcp_f32 v243, v243
  v_pk_mul_f32 v[56:57], v[56:57], v[236:237]
  v_pk_mul_f32 v[60:61], v[60:61], v[240:241]
  v_pk_mul_f32 v[58:59], v[58:59], v[238:239]
  v_pk_mul_f32 v[62:63], v[62:63], v[242:243]
  v_cvt_pk_bf16_f32 v10, v56, v57
  v_cvt_pk_bf16_f32 v14, v60, v61
  v_cvt_pk_bf16_f32 v11, v58, v59
  v_cvt_pk_bf16_f32 v15, v62, v63
  buffer_store_dwordx4 v[8:11], v224, s[16:19], s25 offen offset:2048 sc1
  buffer_store_dwordx4 v[12:15], v224, s[16:19], s25 offen offset:3072 sc1
  s_add_u32 s25, s25, 4096
  v_mfma_f32_16x16x32_bf16 v[92:95], a[156:159], a[172:175], v[92:95]
  ds_read_b64_tr_b16 a[156:157], v225 offset:50272
  s_waitcnt lgkmcnt(13)
  v_mfma_f32_16x16x32_bf16 v[96:99], a[128:131], a[0:3], v[96:99]
  ds_read_b64_tr_b16 a[158:159], v225 offset:53856
  v_mfma_f32_16x16x32_bf16 v[100:103], a[128:131], a[4:7], v[100:103]
  v_mfma_f32_16x16x32_bf16 v[104:107], a[128:131], a[8:11], v[104:107]
  v_mul_f32 v236, v64, v64
  v_mul_f32 v237, v65, v65
  v_mul_f32 v238, v66, v66
  v_mfma_f32_16x16x32_bf16 v[108:111], a[128:131], a[12:15], v[108:111]
  ds_read_b64_tr_b16 a[128:129], v226 offset:96
  s_waitcnt lgkmcnt(13)
  v_mfma_f32_16x16x32_bf16 v[112:115], a[132:135], a[0:3], v[112:115]
  ds_read_b64_tr_b16 a[130:131], v226 offset:3680
  v_mul_f32 v239, v67, v67
  v_mfma_f32_16x16x32_bf16 v[116:119], a[132:135], a[4:7], v[116:119]
  v_fma_f32 v236, v236, v244, v246
  v_fma_f32 v237, v237, v244, v246
  v_mfma_f32_16x16x32_bf16 v[120:123], a[132:135], a[8:11], v[120:123]
  v_fma_f32 v238, v238, v244, v246
  v_fma_f32 v239, v239, v244, v246
  v_mfma_f32_16x16x32_bf16 v[124:127], a[132:135], a[12:15], v[124:127]
  ds_read_b64_tr_b16 a[132:133], v226 offset:7264
  s_waitcnt lgkmcnt(13)
  v_mfma_f32_16x16x32_bf16 v[96:99], a[136:139], a[16:19], v[96:99]
  ds_read_b64_tr_b16 a[134:135], v226 offset:10848
  v_mul_f32 v236, v236, v64
  v_mfma_f32_16x16x32_bf16 v[100:103], a[136:139], a[20:23], v[100:103]
  v_mul_f32 v237, v237, v65
  v_mul_f32 v238, v238, v66
  v_mul_f32 v239, v239, v67
  v_mfma_f32_16x16x32_bf16 v[104:107], a[136:139], a[24:27], v[104:107]
  v_exp_f32 v236, v236
  v_mfma_f32_16x16x32_bf16 v[108:111], a[136:139], a[28:31], v[108:111]
  ds_read_b64_tr_b16 a[136:137], v226 offset:14432
  s_waitcnt lgkmcnt(13)
  v_mfma_f32_16x16x32_bf16 v[112:115], a[140:143], a[16:19], v[112:115]
  ds_read_b64_tr_b16 a[138:139], v226 offset:18016
  v_mul_f32 v80, v64, v80
  v_mfma_f32_16x16x32_bf16 v[116:119], a[140:143], a[20:23], v[116:119]
  v_exp_f32 v237, v237
  v_mfma_f32_16x16x32_bf16 v[120:123], a[140:143], a[24:27], v[120:123]
  v_mul_f32 v81, v65, v81
  v_exp_f32 v238, v238
  v_mfma_f32_16x16x32_bf16 v[124:127], a[140:143], a[28:31], v[124:127]
  ds_read_b64_tr_b16 a[140:141], v226 offset:21600
  s_waitcnt lgkmcnt(13)
  v_mfma_f32_16x16x32_bf16 v[96:99], a[144:147], a[32:35], v[96:99]
  ds_read_b64_tr_b16 a[142:143], v226 offset:25184
  v_mfma_f32_16x16x32_bf16 v[100:103], a[144:147], a[36:39], v[100:103]
  v_mul_f32 v82, v66, v82
  v_exp_f32 v239, v239
  v_mfma_f32_16x16x32_bf16 v[104:107], a[144:147], a[40:43], v[104:107]
  v_mul_f32 v83, v67, v83
  v_add_f32 v236, 1.0, v236
  v_mfma_f32_16x16x32_bf16 v[108:111], a[144:147], a[44:47], v[108:111]
  ds_read_b64_tr_b16 a[144:145], v227 offset:96
  s_waitcnt lgkmcnt(13)
  v_mfma_f32_16x16x32_bf16 v[112:115], a[148:151], a[32:35], v[112:115]
  ds_read_b64_tr_b16 a[146:147], v227 offset:3680
  v_add_f32 v237, 1.0, v237
  v_mfma_f32_16x16x32_bf16 v[116:119], a[148:151], a[36:39], v[116:119]
  v_add_f32 v238, 1.0, v238
  v_add_f32 v239, 1.0, v239
  v_mfma_f32_16x16x32_bf16 v[120:123], a[148:151], a[40:43], v[120:123]
  v_rcp_f32 v236, v236
  v_rcp_f32 v237, v237
  v_mfma_f32_16x16x32_bf16 v[124:127], a[148:151], a[44:47], v[124:127]
  ds_read_b64_tr_b16 a[148:149], v227 offset:7264
  s_waitcnt lgkmcnt(13)
  v_mfma_f32_16x16x32_bf16 v[96:99], a[152:155], a[48:51], v[96:99]
  ds_read_b64_tr_b16 a[150:151], v227 offset:10848
  v_mfma_f32_16x16x32_bf16 v[100:103], a[152:155], a[52:55], v[100:103]
  v_rcp_f32 v238, v238
  v_mfma_f32_16x16x32_bf16 v[104:107], a[152:155], a[56:59], v[104:107]
  v_rcp_f32 v239, v239
  v_mfma_f32_16x16x32_bf16 v[108:111], a[152:155], a[60:63], v[108:111]
  ds_read_b64_tr_b16 a[152:153], v227 offset:14432
  s_waitcnt lgkmcnt(13)
  v_mfma_f32_16x16x32_bf16 v[112:115], a[156:159], a[48:51], v[112:115]
  ds_read_b64_tr_b16 a[154:155], v227 offset:18016
  v_mul_f32 v80, v80, v236
  v_mfma_f32_16x16x32_bf16 v[116:119], a[156:159], a[52:55], v[116:119]
  v_mul_f32 v81, v81, v237
  v_mul_f32 v82, v82, v238
  v_mfma_f32_16x16x32_bf16 v[120:123], a[156:159], a[56:59], v[120:123]
  v_mul_f32 v83, v83, v239
  v_cvt_pk_bf16_f32 v64, v80, v81
  v_cvt_pk_bf16_f32 v65, v82, v83
  v_mfma_f32_16x16x32_bf16 v[124:127], a[156:159], a[60:63], v[124:127]
  ds_read_b64_tr_b16 a[156:157], v227 offset:21600
  s_waitcnt lgkmcnt(13)
  v_mfma_f32_16x16x32_bf16 v[96:99], a[128:131], a[64:67], v[96:99]
  ds_read_b64_tr_b16 a[158:159], v227 offset:25184
  v_mul_f32 v240, v68, v68
  v_mfma_f32_16x16x32_bf16 v[100:103], a[128:131], a[68:71], v[100:103]
  v_mul_f32 v241, v69, v69
  v_mul_f32 v242, v70, v70
  v_mfma_f32_16x16x32_bf16 v[104:107], a[128:131], a[72:75], v[104:107]
  v_mul_f32 v243, v71, v71
  v_fma_f32 v240, v240, v244, v246
  v_mfma_f32_16x16x32_bf16 v[108:111], a[128:131], a[76:79], v[108:111]
  ds_read_b64_tr_b16 a[128:129], v225 offset:128
  s_waitcnt lgkmcnt(13)
  v_mfma_f32_16x16x32_bf16 v[112:115], a[132:135], a[64:67], v[112:115]
  ds_read_b64_tr_b16 a[130:131], v225 offset:3712
  v_fma_f32 v241, v241, v244, v246
  v_mfma_f32_16x16x32_bf16 v[116:119], a[132:135], a[68:71], v[116:119]
  v_fma_f32 v242, v242, v244, v246
  v_fma_f32 v243, v243, v244, v246
  v_mul_f32 v240, v240, v68
  v_mfma_f32_16x16x32_bf16 v[120:123], a[132:135], a[72:75], v[120:123]
  v_mul_f32 v241, v241, v69
  v_mul_f32 v242, v242, v70
  v_mfma_f32_16x16x32_bf16 v[124:127], a[132:135], a[76:79], v[124:127]
  ds_read_b64_tr_b16 a[132:133], v225 offset:7296
  s_waitcnt lgkmcnt(13)
  v_mfma_f32_16x16x32_bf16 v[96:99], a[136:139], a[80:83], v[96:99]
  ds_read_b64_tr_b16 a[134:135], v225 offset:10880
  v_mul_f32 v243, v243, v71
  v_mfma_f32_16x16x32_bf16 v[100:103], a[136:139], a[84:87], v[100:103]
  v_exp_f32 v240, v240
  v_mfma_f32_16x16x32_bf16 v[104:107], a[136:139], a[88:91], v[104:107]
  v_mul_f32 v84, v68, v84
  v_exp_f32 v241, v241
  v_mfma_f32_16x16x32_bf16 v[108:111], a[136:139], a[92:95], v[108:111]
  ds_read_b64_tr_b16 a[136:137], v225 offset:14464
  s_waitcnt lgkmcnt(13)
  v_mfma_f32_16x16x32_bf16 v[112:115], a[140:143], a[80:83], v[112:115]
  ds_read_b64_tr_b16 a[138:139], v225 offset:18048
  v_mfma_f32_16x16x32_bf16 v[116:119], a[140:143], a[84:87], v[116:119]
  v_mul_f32 v85, v69, v85
  v_exp_f32 v242, v242
  v_mfma_f32_16x16x32_bf16 v[120:123], a[140:143], a[88:91], v[120:123]
  v_mul_f32 v86, v70, v86
  v_exp_f32 v243, v243
  v_mfma_f32_16x16x32_bf16 v[124:127], a[140:143], a[92:95], v[124:127]
  ds_read_b64_tr_b16 a[140:141], v225 offset:21632
  s_waitcnt lgkmcnt(13)
  v_mfma_f32_16x16x32_bf16 v[96:99], a[144:147], a[96:99], v[96:99]
  ds_read_b64_tr_b16 a[142:143], v225 offset:25216
  v_mfma_f32_16x16x32_bf16 v[100:103], a[144:147], a[100:103], v[100:103]
  v_mul_f32 v87, v71, v87
  v_add_f32 v240, 1.0, v240
  v_mfma_f32_16x16x32_bf16 v[104:107], a[144:147], a[104:107], v[104:107]
  v_add_f32 v241, 1.0, v241
  v_add_f32 v242, 1.0, v242
  v_mfma_f32_16x16x32_bf16 v[108:111], a[144:147], a[108:111], v[108:111]
  ds_read_b64_tr_b16 a[144:145], v225 offset:28800
  s_waitcnt lgkmcnt(13)
  v_mfma_f32_16x16x32_bf16 v[112:115], a[148:151], a[96:99], v[112:115]
  ds_read_b64_tr_b16 a[146:147], v225 offset:32384
  v_add_f32 v243, 1.0, v243
  v_rcp_f32 v240, v240
  v_mfma_f32_16x16x32_bf16 v[116:119], a[148:151], a[100:103], v[116:119]
  v_rcp_f32 v241, v241
  v_mfma_f32_16x16x32_bf16 v[120:123], a[148:151], a[104:107], v[120:123]
  v_rcp_f32 v242, v242
  v_mfma_f32_16x16x32_bf16 v[124:127], a[148:151], a[108:111], v[124:127]
  ds_read_b64_tr_b16 a[148:149], v225 offset:35968
  s_waitcnt lgkmcnt(13)
  v_mfma_f32_16x16x32_bf16 v[96:99], a[152:155], a[160:163], v[96:99]
  ds_read_b64_tr_b16 a[150:151], v225 offset:39552
  v_mfma_f32_16x16x32_bf16 v[100:103], a[152:155], a[164:167], v[100:103]
  v_rcp_f32 v243, v243
  v_mfma_f32_16x16x32_bf16 v[104:107], a[152:155], a[168:171], v[104:107]
  v_mul_f32 v84, v84, v240
  v_mul_f32 v85, v85, v241
  v_mul_f32 v86, v86, v242
  v_mfma_f32_16x16x32_bf16 v[108:111], a[152:155], a[172:175], v[108:111]
  ds_read_b64_tr_b16 a[152:153], v225 offset:43136
  s_waitcnt lgkmcnt(13)
  v_mfma_f32_16x16x32_bf16 v[112:115], a[156:159], a[160:163], v[112:115]
  ds_read_b64_tr_b16 a[154:155], v225 offset:46720
  v_mul_f32 v87, v87, v243
  v_mfma_f32_16x16x32_bf16 v[116:119], a[156:159], a[164:167], v[116:119]
  v_cvt_pk_bf16_f32 v68, v84, v85
  v_cvt_pk_bf16_f32 v69, v86, v87
  v_mfma_f32_16x16x32_bf16 v[120:123], a[156:159], a[168:171], v[120:123]
  v_pk_mul_f32 v[236:237], v[72:73], v[72:73]
  v_pk_mul_f32 v[240:241], v[76:77], v[76:77]
  v_pk_mul_f32 v[238:239], v[74:75], v[74:75]
  v_pk_mul_f32 v[242:243], v[78:79], v[78:79]
  v_pk_fma_f32 v[236:237], v[236:237], v[244:245], v[246:247]
  v_pk_fma_f32 v[240:241], v[240:241], v[244:245], v[246:247]
  v_pk_fma_f32 v[238:239], v[238:239], v[244:245], v[246:247]
  v_pk_fma_f32 v[242:243], v[242:243], v[244:245], v[246:247]
  v_pk_mul_f32 v[236:237], v[236:237], v[72:73]
  v_pk_mul_f32 v[240:241], v[240:241], v[76:77]
  v_pk_mul_f32 v[238:239], v[238:239], v[74:75]
  v_pk_mul_f32 v[242:243], v[242:243], v[78:79]
  v_exp_f32 v236, v236
  v_exp_f32 v240, v240
  v_exp_f32 v237, v237
  v_exp_f32 v241, v241
  v_exp_f32 v238, v238
  v_exp_f32 v242, v242
  v_exp_f32 v239, v239
  v_exp_f32 v243, v243
  v_pk_mul_f32 v[88:89], v[72:73], v[88:89]
  v_pk_mul_f32 v[92:93], v[76:77], v[92:93]
  v_pk_mul_f32 v[90:91], v[74:75], v[90:91]
  v_pk_mul_f32 v[94:95], v[78:79], v[94:95]
  v_pk_add_f32 v[236:237], v[236:237], 1.0 op_sel_hi:[1,0]
  v_pk_add_f32 v[240:241], v[240:241], 1.0 op_sel_hi:[1,0]
  v_pk_add_f32 v[238:239], v[238:239], 1.0 op_sel_hi:[1,0]
  v_pk_add_f32 v[242:243], v[242:243], 1.0 op_sel_hi:[1,0]
  v_rcp_f32 v236, v236
  v_rcp_f32 v240, v240
  v_rcp_f32 v237, v237
  v_rcp_f32 v241, v241
  v_rcp_f32 v238, v238
  v_rcp_f32 v242, v242
  v_rcp_f32 v239, v239
  v_rcp_f32 v243, v243
  v_pk_mul_f32 v[88:89], v[88:89], v[236:237]
  v_pk_mul_f32 v[92:93], v[92:93], v[240:241]
  v_pk_mul_f32 v[90:91], v[90:91], v[238:239]
  v_pk_mul_f32 v[94:95], v[94:95], v[242:243]
  v_cvt_pk_bf16_f32 v72, v88, v89
  v_cvt_pk_bf16_f32 v76, v92, v93
  v_cvt_pk_bf16_f32 v73, v90, v91
  v_cvt_pk_bf16_f32 v77, v94, v95
  v_mfma_f32_16x16x32_bf16 v[124:127], a[156:159], a[172:175], v[124:127]
  ds_read_b64_tr_b16 a[156:157], v225 offset:50304
  s_waitcnt lgkmcnt(13)
  v_mfma_f32_16x16x32_bf16 v[128:131], a[128:131], a[0:3], v[128:131]
  ds_read_b64_tr_b16 a[158:159], v225 offset:53888
  v_mfma_f32_16x16x32_bf16 v[132:135], a[128:131], a[4:7], v[132:135]
  v_mfma_f32_16x16x32_bf16 v[136:139], a[128:131], a[8:11], v[136:139]
  v_mul_f32 v236, v96, v96
  v_mul_f32 v237, v97, v97
  v_mul_f32 v238, v98, v98
  v_mfma_f32_16x16x32_bf16 v[140:143], a[128:131], a[12:15], v[140:143]
  ds_read_b64_tr_b16 a[128:129], v226 offset:128
  s_waitcnt lgkmcnt(13)
  v_mfma_f32_16x16x32_bf16 v[144:147], a[132:135], a[0:3], v[144:147]
  ds_read_b64_tr_b16 a[130:131], v226 offset:3712
  v_mul_f32 v239, v99, v99
  v_mfma_f32_16x16x32_bf16 v[148:151], a[132:135], a[4:7], v[148:151]
  v_fma_f32 v236, v236, v244, v246
  v_fma_f32 v237, v237, v244, v246
  v_mfma_f32_16x16x32_bf16 v[152:155], a[132:135], a[8:11], v[152:155]
  v_fma_f32 v238, v238, v244, v246
  v_fma_f32 v239, v239, v244, v246
  v_mfma_f32_16x16x32_bf16 v[156:159], a[132:135], a[12:15], v[156:159]
  ds_read_b64_tr_b16 a[132:133], v226 offset:7296
  s_waitcnt lgkmcnt(13)
  v_mfma_f32_16x16x32_bf16 v[128:131], a[136:139], a[16:19], v[128:131]
  ds_read_b64_tr_b16 a[134:135], v226 offset:10880
  v_mul_f32 v236, v236, v96
  v_mfma_f32_16x16x32_bf16 v[132:135], a[136:139], a[20:23], v[132:135]
  v_mul_f32 v237, v237, v97
  v_mul_f32 v238, v238, v98
  v_mul_f32 v239, v239, v99
  v_mfma_f32_16x16x32_bf16 v[136:139], a[136:139], a[24:27], v[136:139]
  v_exp_f32 v236, v236
  v_mfma_f32_16x16x32_bf16 v[140:143], a[136:139], a[28:31], v[140:143]
  ds_read_b64_tr_b16 a[136:137], v226 offset:14464
  s_waitcnt lgkmcnt(13)
  v_mfma_f32_16x16x32_bf16 v[144:147], a[140:143], a[16:19], v[144:147]
  ds_read_b64_tr_b16 a[138:139], v226 offset:18048
  v_mul_f32 v112, v96, v112
  v_mfma_f32_16x16x32_bf16 v[148:151], a[140:143], a[20:23], v[148:151]
  v_exp_f32 v237, v237
  v_mfma_f32_16x16x32_bf16 v[152:155], a[140:143], a[24:27], v[152:155]
  v_mul_f32 v113, v97, v113
  v_exp_f32 v238, v238
  v_mfma_f32_16x16x32_bf16 v[156:159], a[140:143], a[28:31], v[156:159]
  ds_read_b64_tr_b16 a[140:141], v226 offset:21632
  s_waitcnt lgkmcnt(13)
  v_mfma_f32_16x16x32_bf16 v[128:131], a[144:147], a[32:35], v[128:131]
  ds_read_b64_tr_b16 a[142:143], v226 offset:25216
  v_mfma_f32_16x16x32_bf16 v[132:135], a[144:147], a[36:39], v[132:135]
  v_mul_f32 v114, v98, v114
  v_exp_f32 v239, v239
  v_mfma_f32_16x16x32_bf16 v[136:139], a[144:147], a[40:43], v[136:139]
  v_mul_f32 v115, v99, v115
  v_add_f32 v236, 1.0, v236
  v_mfma_f32_16x16x32_bf16 v[140:143], a[144:147], a[44:47], v[140:143]
  ds_read_b64_tr_b16 a[144:145], v227 offset:128
  s_waitcnt lgkmcnt(13)
  v_mfma_f32_16x16x32_bf16 v[144:147], a[148:151], a[32:35], v[144:147]
  ds_read_b64_tr_b16 a[146:147], v227 offset:3712
  v_add_f32 v237, 1.0, v237
  v_mfma_f32_16x16x32_bf16 v[148:151], a[148:151], a[36:39], v[148:151]
  v_add_f32 v238, 1.0, v238
  v_add_f32 v239, 1.0, v239
  v_mfma_f32_16x16x32_bf16 v[152:155], a[148:151], a[40:43], v[152:155]
  v_rcp_f32 v236, v236
  v_rcp_f32 v237, v237
  v_mfma_f32_16x16x32_bf16 v[156:159], a[148:151], a[44:47], v[156:159]
  ds_read_b64_tr_b16 a[148:149], v227 offset:7296
  s_waitcnt lgkmcnt(13)
  v_mfma_f32_16x16x32_bf16 v[128:131], a[152:155], a[48:51], v[128:131]
  ds_read_b64_tr_b16 a[150:151], v227 offset:10880
  v_mfma_f32_16x16x32_bf16 v[132:135], a[152:155], a[52:55], v[132:135]
  v_rcp_f32 v238, v238
  v_mfma_f32_16x16x32_bf16 v[136:139], a[152:155], a[56:59], v[136:139]
  v_rcp_f32 v239, v239
  v_mfma_f32_16x16x32_bf16 v[140:143], a[152:155], a[60:63], v[140:143]
  ds_read_b64_tr_b16 a[152:153], v227 offset:14464
  s_waitcnt lgkmcnt(13)
  v_mfma_f32_16x16x32_bf16 v[144:147], a[156:159], a[48:51], v[144:147]
  ds_read_b64_tr_b16 a[154:155], v227 offset:18048
  v_mul_f32 v112, v112, v236
  v_mfma_f32_16x16x32_bf16 v[148:151], a[156:159], a[52:55], v[148:151]
  v_mul_f32 v113, v113, v237
  v_mul_f32 v114, v114, v238
  v_mfma_f32_16x16x32_bf16 v[152:155], a[156:159], a[56:59], v[152:155]
  v_mul_f32 v115, v115, v239
  v_cvt_pk_bf16_f32 v66, v112, v113
  v_cvt_pk_bf16_f32 v67, v114, v115
  v_mfma_f32_16x16x32_bf16 v[156:159], a[156:159], a[60:63], v[156:159]
  ds_read_b64_tr_b16 a[156:157], v227 offset:21632
  s_waitcnt lgkmcnt(13)
  v_mfma_f32_16x16x32_bf16 v[128:131], a[128:131], a[64:67], v[128:131]
  ds_read_b64_tr_b16 a[158:159], v227 offset:25216
  buffer_store_dwordx4 v[64:67], v224, s[16:19], s25 offen offset:0 sc1
  v_mfma_f32_16x16x32_bf16 v[132:135], a[128:131], a[68:71], v[132:135]
  v_mul_f32 v240, v100, v100
  v_mul_f32 v241, v101, v101
  v_mfma_f32_16x16x32_bf16 v[136:139], a[128:131], a[72:75], v[136:139]
  v_mul_f32 v242, v102, v102
  v_mul_f32 v243, v103, v103
  v_mfma_f32_16x16x32_bf16 v[140:143], a[128:131], a[76:79], v[140:143]
  ds_read_b64_tr_b16 a[128:129], v225 offset:160
  s_waitcnt lgkmcnt(13)
  v_mfma_f32_16x16x32_bf16 v[144:147], a[132:135], a[64:67], v[144:147]
  ds_read_b64_tr_b16 a[130:131], v225 offset:3744
  v_fma_f32 v240, v240, v244, v246
  v_mfma_f32_16x16x32_bf16 v[148:151], a[132:135], a[68:71], v[148:151]
  v_fma_f32 v241, v241, v244, v246
  v_fma_f32 v242, v242, v244, v246
  v_fma_f32 v243, v243, v244, v246
  v_mfma_f32_16x16x32_bf16 v[152:155], a[132:135], a[72:75], v[152:155]
  v_mul_f32 v240, v240, v100
  v_mul_f32 v241, v241, v101
  v_mfma_f32_16x16x32_bf16 v[156:159], a[132:135], a[76:79], v[156:159]
  ds_read_b64_tr_b16 a[132:133], v225 offset:7328
  s_waitcnt lgkmcnt(13)
  v_mfma_f32_16x16x32_bf16 v[128:131], a[136:139], a[80:83], v[128:131]
  ds_read_b64_tr_b16 a[134:135], v225 offset:10912
  v_mul_f32 v242, v242, v102
  v_mfma_f32_16x16x32_bf16 v[132:135], a[136:139], a[84:87], v[132:135]
  v_mul_f32 v243, v243, v103
  v_exp_f32 v240, v240
  v_mfma_f32_16x16x32_bf16 v[136:139], a[136:139], a[88:91], v[136:139]
  v_mul_f32 v116, v100, v116
  v_mfma_f32_16x16x32_bf16 v[140:143], a[136:139], a[92:95], v[140:143]
  ds_read_b64_tr_b16 a[136:137], v225 offset:14496
  s_waitcnt lgkmcnt(13)
  v_mfma_f32_16x16x32_bf16 v[144:147], a[140:143], a[80:83], v[144:147]
  ds_read_b64_tr_b16 a[138:139], v225 offset:18080
  v_exp_f32 v241, v241
  v_mfma_f32_16x16x32_bf16 v[148:151], a[140:143], a[84:87], v[148:151]
  v_mul_f32 v117, v101, v117
  v_exp_f32 v242, v242
  v_mfma_f32_16x16x32_bf16 v[152:155], a[140:143], a[88:91], v[152:155]
  v_mul_f32 v118, v102, v118
  v_mfma_f32_16x16x32_bf16 v[156:159], a[140:143], a[92:95], v[156:159]
  ds_read_b64_tr_b16 a[140:141], v225 offset:21664
  s_waitcnt lgkmcnt(13)
  v_mfma_f32_16x16x32_bf16 v[128:131], a[144:147], a[96:99], v[128:131]
  ds_read_b64_tr_b16 a[142:143], v225 offset:25248
  v_exp_f32 v243, v243
  v_mfma_f32_16x16x32_bf16 v[132:135], a[144:147], a[100:103], v[132:135]
  v_mul_f32 v119, v103, v119
  v_mfma_f32_16x16x32_bf16 v[136:139], a[144:147], a[104:107], v[136:139]
  v_add_f32 v240, 1.0, v240
  v_add_f32 v241, 1.0, v241
  v_mfma_f32_16x16x32_bf16 v[140:143], a[144:147], a[108:111], v[140:143]
  ds_read_b64_tr_b16 a[144:145], v225 offset:28832
  s_waitcnt lgkmcnt(13)
  v_mfma_f32_16x16x32_bf16 v[144:147], a[148:151], a[96:99], v[144:147]
  ds_read_b64_tr_b16 a[146:147], v225 offset:32416
  v_add_f32 v242, 1.0, v242
  v_add_f32 v243, 1.0, v243
  v_mfma_f32_16x16x32_bf16 v[148:151], a[148:151], a[100:103], v[148:151]
  v_rcp_f32 v240, v240
  v_mfma_f32_16x16x32_bf16 v[152:155], a[148:151], a[104:107], v[152:155]
  v_rcp_f32 v241, v241
  v_mfma_f32_16x16x32_bf16 v[156:159], a[148:151], a[108:111], v[156:159]
  ds_read_b64_tr_b16 a[148:149], v225 offset:36000
  s_waitcnt lgkmcnt(13)
  v_mfma_f32_16x16x32_bf16 v[128:131], a[152:155], a[160:163], v[128:131]
  ds_read_b64_tr_b16 a[150:151], v225 offset:39584
  v_rcp_f32 v242, v242
  v_mfma_f32_16x16x32_bf16 v[132:135], a[152:155], a[164:167], v[132:135]
  v_rcp_f32 v243, v243
  v_mfma_f32_16x16x32_bf16 v[136:139], a[152:155], a[168:171], v[136:139]
  v_mul_f32 v116, v116, v240
  v_mul_f32 v117, v117, v241
  v_mfma_f32_16x16x32_bf16 v[140:143], a[152:155], a[172:175], v[140:143]
  ds_read_b64_tr_b16 a[152:153], v225 offset:43168
  s_waitcnt lgkmcnt(13)
  v_mfma_f32_16x16x32_bf16 v[144:147], a[156:159], a[160:163], v[144:147]
  ds_read_b64_tr_b16 a[154:155], v225 offset:46752
  v_mul_f32 v118, v118, v242
  v_mfma_f32_16x16x32_bf16 v[148:151], a[156:159], a[164:167], v[148:151]
  v_mul_f32 v119, v119, v243
  v_cvt_pk_bf16_f32 v70, v116, v117
  v_cvt_pk_bf16_f32 v71, v118, v119
  buffer_store_dwordx4 v[68:71], v224, s[16:19], s25 offen offset:1024 sc1
  v_mfma_f32_16x16x32_bf16 v[152:155], a[156:159], a[168:171], v[152:155]
  v_pk_mul_f32 v[236:237], v[104:105], v[104:105]
  v_pk_mul_f32 v[240:241], v[108:109], v[108:109]
  v_pk_mul_f32 v[238:239], v[106:107], v[106:107]
  v_pk_mul_f32 v[242:243], v[110:111], v[110:111]
  v_pk_fma_f32 v[236:237], v[236:237], v[244:245], v[246:247]
  v_pk_fma_f32 v[240:241], v[240:241], v[244:245], v[246:247]
  v_pk_fma_f32 v[238:239], v[238:239], v[244:245], v[246:247]
  v_pk_fma_f32 v[242:243], v[242:243], v[244:245], v[246:247]
  v_pk_mul_f32 v[236:237], v[236:237], v[104:105]
  v_pk_mul_f32 v[240:241], v[240:241], v[108:109]
  v_pk_mul_f32 v[238:239], v[238:239], v[106:107]
  v_pk_mul_f32 v[242:243], v[242:243], v[110:111]
  v_exp_f32 v236, v236
  v_exp_f32 v240, v240
  v_exp_f32 v237, v237
  v_exp_f32 v241, v241
  v_exp_f32 v238, v238
  v_exp_f32 v242, v242
  v_exp_f32 v239, v239
  v_exp_f32 v243, v243
  v_pk_mul_f32 v[120:121], v[104:105], v[120:121]
  v_pk_mul_f32 v[124:125], v[108:109], v[124:125]
  v_pk_mul_f32 v[122:123], v[106:107], v[122:123]
  v_pk_mul_f32 v[126:127], v[110:111], v[126:127]
  v_pk_add_f32 v[236:237], v[236:237], 1.0 op_sel_hi:[1,0]
  v_pk_add_f32 v[240:241], v[240:241], 1.0 op_sel_hi:[1,0]
  v_pk_add_f32 v[238:239], v[238:239], 1.0 op_sel_hi:[1,0]
  v_pk_add_f32 v[242:243], v[242:243], 1.0 op_sel_hi:[1,0]
  v_rcp_f32 v236, v236
  v_rcp_f32 v240, v240
  v_rcp_f32 v237, v237
  v_rcp_f32 v241, v241
  v_rcp_f32 v238, v238
  v_rcp_f32 v242, v242
  v_rcp_f32 v239, v239
  v_rcp_f32 v243, v243
  v_pk_mul_f32 v[120:121], v[120:121], v[236:237]
  v_pk_mul_f32 v[124:125], v[124:125], v[240:241]
  v_pk_mul_f32 v[122:123], v[122:123], v[238:239]
  v_pk_mul_f32 v[126:127], v[126:127], v[242:243]
  v_cvt_pk_bf16_f32 v74, v120, v121
  v_cvt_pk_bf16_f32 v78, v124, v125
  v_cvt_pk_bf16_f32 v75, v122, v123
  v_cvt_pk_bf16_f32 v79, v126, v127
  buffer_store_dwordx4 v[72:75], v224, s[16:19], s25 offen offset:2048 sc1
  buffer_store_dwordx4 v[76:79], v224, s[16:19], s25 offen offset:3072 sc1
  s_add_u32 s25, s25, 4096
  v_mfma_f32_16x16x32_bf16 v[156:159], a[156:159], a[172:175], v[156:159]
  ds_read_b64_tr_b16 a[156:157], v225 offset:50336
  s_waitcnt lgkmcnt(13)
  v_mfma_f32_16x16x32_bf16 v[160:163], a[128:131], a[0:3], v[160:163]
  ds_read_b64_tr_b16 a[158:159], v225 offset:53920
  v_mfma_f32_16x16x32_bf16 v[164:167], a[128:131], a[4:7], v[164:167]
  v_mfma_f32_16x16x32_bf16 v[168:171], a[128:131], a[8:11], v[168:171]
  v_mul_f32 v236, v128, v128
  v_mul_f32 v237, v129, v129
  v_mul_f32 v238, v130, v130
  v_mfma_f32_16x16x32_bf16 v[172:175], a[128:131], a[12:15], v[172:175]
  ds_read_b64_tr_b16 a[128:129], v226 offset:160
  s_waitcnt lgkmcnt(13)
  v_mfma_f32_16x16x32_bf16 v[176:179], a[132:135], a[0:3], v[176:179]
  ds_read_b64_tr_b16 a[130:131], v226 offset:3744
  v_mul_f32 v239, v131, v131
  v_mfma_f32_16x16x32_bf16 v[180:183], a[132:135], a[4:7], v[180:183]
  v_fma_f32 v236, v236, v244, v246
  v_fma_f32 v237, v237, v244, v246
  v_mfma_f32_16x16x32_bf16 v[184:187], a[132:135], a[8:11], v[184:187]
  v_fma_f32 v238, v238, v244, v246
  v_fma_f32 v239, v239, v244, v246
  v_mfma_f32_16x16x32_bf16 v[188:191], a[132:135], a[12:15], v[188:191]
  ds_read_b64_tr_b16 a[132:133], v226 offset:7328
  s_waitcnt lgkmcnt(13)
  v_mfma_f32_16x16x32_bf16 v[160:163], a[136:139], a[16:19], v[160:163]
  ds_read_b64_tr_b16 a[134:135], v226 offset:10912
  v_mul_f32 v236, v236, v128
  v_mfma_f32_16x16x32_bf16 v[164:167], a[136:139], a[20:23], v[164:167]
  v_mul_f32 v237, v237, v129
  v_mul_f32 v238, v238, v130
  v_mul_f32 v239, v239, v131
  v_mfma_f32_16x16x32_bf16 v[168:171], a[136:139], a[24:27], v[168:171]
  v_exp_f32 v236, v236
  v_mfma_f32_16x16x32_bf16 v[172:175], a[136:139], a[28:31], v[172:175]
  ds_read_b64_tr_b16 a[136:137], v226 offset:14496
  s_waitcnt lgkmcnt(13)
  v_mfma_f32_16x16x32_bf16 v[176:179], a[140:143], a[16:19], v[176:179]
  ds_read_b64_tr_b16 a[138:139], v226 offset:18080
  v_mul_f32 v144, v128, v144
  v_mfma_f32_16x16x32_bf16 v[180:183], a[140:143], a[20:23], v[180:183]
  v_exp_f32 v237, v237
  v_mfma_f32_16x16x32_bf16 v[184:187], a[140:143], a[24:27], v[184:187]
  v_mul_f32 v145, v129, v145
  v_exp_f32 v238, v238
  v_mfma_f32_16x16x32_bf16 v[188:191], a[140:143], a[28:31], v[188:191]
  ds_read_b64_tr_b16 a[140:141], v226 offset:21664
  s_waitcnt lgkmcnt(13)
  v_mfma_f32_16x16x32_bf16 v[160:163], a[144:147], a[32:35], v[160:163]
  ds_read_b64_tr_b16 a[142:143], v226 offset:25248
  v_mfma_f32_16x16x32_bf16 v[164:167], a[144:147], a[36:39], v[164:167]
  v_mul_f32 v146, v130, v146
  v_exp_f32 v239, v239
  v_mfma_f32_16x16x32_bf16 v[168:171], a[144:147], a[40:43], v[168:171]
  v_mul_f32 v147, v131, v147
  v_add_f32 v236, 1.0, v236
  v_mfma_f32_16x16x32_bf16 v[172:175], a[144:147], a[44:47], v[172:175]
  ds_read_b64_tr_b16 a[144:145], v227 offset:160
  s_waitcnt lgkmcnt(13)
  v_mfma_f32_16x16x32_bf16 v[176:179], a[148:151], a[32:35], v[176:179]
  ds_read_b64_tr_b16 a[146:147], v227 offset:3744
  v_add_f32 v237, 1.0, v237
  v_mfma_f32_16x16x32_bf16 v[180:183], a[148:151], a[36:39], v[180:183]
  v_add_f32 v238, 1.0, v238
  v_add_f32 v239, 1.0, v239
  v_mfma_f32_16x16x32_bf16 v[184:187], a[148:151], a[40:43], v[184:187]
  v_rcp_f32 v236, v236
  v_rcp_f32 v237, v237
  v_mfma_f32_16x16x32_bf16 v[188:191], a[148:151], a[44:47], v[188:191]
  ds_read_b64_tr_b16 a[148:149], v227 offset:7328
  s_waitcnt lgkmcnt(13)
  v_mfma_f32_16x16x32_bf16 v[160:163], a[152:155], a[48:51], v[160:163]
  ds_read_b64_tr_b16 a[150:151], v227 offset:10912
  v_mfma_f32_16x16x32_bf16 v[164:167], a[152:155], a[52:55], v[164:167]
  v_rcp_f32 v238, v238
  v_mfma_f32_16x16x32_bf16 v[168:171], a[152:155], a[56:59], v[168:171]
  v_rcp_f32 v239, v239
  v_mfma_f32_16x16x32_bf16 v[172:175], a[152:155], a[60:63], v[172:175]
  ds_read_b64_tr_b16 a[152:153], v227 offset:14496
  s_waitcnt lgkmcnt(13)
  v_mfma_f32_16x16x32_bf16 v[176:179], a[156:159], a[48:51], v[176:179]
  ds_read_b64_tr_b16 a[154:155], v227 offset:18080
  v_mul_f32 v144, v144, v236
  v_mfma_f32_16x16x32_bf16 v[180:183], a[156:159], a[52:55], v[180:183]
  v_mul_f32 v145, v145, v237
  v_mul_f32 v146, v146, v238
  v_mfma_f32_16x16x32_bf16 v[184:187], a[156:159], a[56:59], v[184:187]
  v_mul_f32 v147, v147, v239
  v_cvt_pk_bf16_f32 v128, v144, v145
  v_cvt_pk_bf16_f32 v129, v146, v147
  v_mfma_f32_16x16x32_bf16 v[188:191], a[156:159], a[60:63], v[188:191]
  ds_read_b64_tr_b16 a[156:157], v227 offset:21664
  s_waitcnt lgkmcnt(13)
  v_mfma_f32_16x16x32_bf16 v[160:163], a[128:131], a[64:67], v[160:163]
  ds_read_b64_tr_b16 a[158:159], v227 offset:25248
  v_mul_f32 v240, v132, v132
  v_mfma_f32_16x16x32_bf16 v[164:167], a[128:131], a[68:71], v[164:167]
  v_mul_f32 v241, v133, v133
  v_mul_f32 v242, v134, v134
  v_mfma_f32_16x16x32_bf16 v[168:171], a[128:131], a[72:75], v[168:171]
  v_mul_f32 v243, v135, v135
  v_fma_f32 v240, v240, v244, v246
  v_mfma_f32_16x16x32_bf16 v[172:175], a[128:131], a[76:79], v[172:175]
  ds_read_b64_tr_b16 a[128:129], v225 offset:192
  s_waitcnt lgkmcnt(13)
  v_mfma_f32_16x16x32_bf16 v[176:179], a[132:135], a[64:67], v[176:179]
  ds_read_b64_tr_b16 a[130:131], v225 offset:3776
  v_fma_f32 v241, v241, v244, v246
  v_mfma_f32_16x16x32_bf16 v[180:183], a[132:135], a[68:71], v[180:183]
  v_fma_f32 v242, v242, v244, v246
  v_fma_f32 v243, v243, v244, v246
  v_mul_f32 v240, v240, v132
  v_mfma_f32_16x16x32_bf16 v[184:187], a[132:135], a[72:75], v[184:187]
  v_mul_f32 v241, v241, v133
  v_mul_f32 v242, v242, v134
  v_mfma_f32_16x16x32_bf16 v[188:191], a[132:135], a[76:79], v[188:191]
  ds_read_b64_tr_b16 a[132:133], v225 offset:7360
  s_waitcnt lgkmcnt(13)
  v_mfma_f32_16x16x32_bf16 v[160:163], a[136:139], a[80:83], v[160:163]
  ds_read_b64_tr_b16 a[134:135], v225 offset:10944
  v_mul_f32 v243, v243, v135
  v_mfma_f32_16x16x32_bf16 v[164:167], a[136:139], a[84:87], v[164:167]
  v_exp_f32 v240, v240
  v_mfma_f32_16x16x32_bf16 v[168:171], a[136:139], a[88:91], v[168:171]
  v_mul_f32 v148, v132, v148
  v_exp_f32 v241, v241
  v_mfma_f32_16x16x32_bf16 v[172:175], a[136:139], a[92:95], v[172:175]
  ds_read_b64_tr_b16 a[136:137], v225 offset:14528
  s_waitcnt lgkmcnt(13)
  v_mfma_f32_16x16x32_bf16 v[176:179], a[140:143], a[80:83], v[176:179]
  ds_read_b64_tr_b16 a[138:139], v225 offset:18112
  v_mfma_f32_16x16x32_bf16 v[180:183], a[140:143], a[84:87], v[180:183]
  v_mul_f32 v149, v133, v149
  v_exp_f32 v242, v242
  v_mfma_f32_16x16x32_bf16 v[184:187], a[140:143], a[88:91], v[184:187]
  v_mul_f32 v150, v134, v150
  v_exp_f32 v243, v243
  v_mfma_f32_16x16x32_bf16 v[188:191], a[140:143], a[92:95], v[188:191]
  ds_read_b64_tr_b16 a[140:141], v225 offset:21696
  s_waitcnt lgkmcnt(13)
  v_mfma_f32_16x16x32_bf16 v[160:163], a[144:147], a[96:99], v[160:163]
  ds_read_b64_tr_b16 a[142:143], v225 offset:25280
  v_mfma_f32_16x16x32_bf16 v[164:167], a[144:147], a[100:103], v[164:167]
  v_mul_f32 v151, v135, v151
  v_add_f32 v240, 1.0, v240
  v_mfma_f32_16x16x32_bf16 v[168:171], a[144:147], a[104:107], v[168:171]
  v_add_f32 v241, 1.0, v241
  v_add_f32 v242, 1.0, v242
  v_mfma_f32_16x16x32_bf16 v[172:175], a[144:147], a[108:111], v[172:175]
  ds_read_b64_tr_b16 a[144:145], v225 offset:28864
  s_waitcnt lgkmcnt(13)
  v_mfma_f32_16x16x32_bf16 v[176:179], a[148:151], a[96:99], v[176:179]
  ds_read_b64_tr_b16 a[146:147], v225 offset:32448
  v_add_f32 v243, 1.0, v243
  v_rcp_f32 v240, v240
  v_mfma_f32_16x16x32_bf16 v[180:183], a[148:151], a[100:103], v[180:183]
  v_rcp_f32 v241, v241
  v_mfma_f32_16x16x32_bf16 v[184:187], a[148:151], a[104:107], v[184:187]
  v_rcp_f32 v242, v242
  v_mfma_f32_16x16x32_bf16 v[188:191], a[148:151], a[108:111], v[188:191]
  ds_read_b64_tr_b16 a[148:149], v225 offset:36032
  s_waitcnt lgkmcnt(13)
  v_mfma_f32_16x16x32_bf16 v[160:163], a[152:155], a[160:163], v[160:163]
  ds_read_b64_tr_b16 a[150:151], v225 offset:39616
  v_mfma_f32_16x16x32_bf16 v[164:167], a[152:155], a[164:167], v[164:167]
  v_rcp_f32 v243, v243
  v_mfma_f32_16x16x32_bf16 v[168:171], a[152:155], a[168:171], v[168:171]
  v_mul_f32 v148, v148, v240
  v_mul_f32 v149, v149, v241
  v_mul_f32 v150, v150, v242
  v_mfma_f32_16x16x32_bf16 v[172:175], a[152:155], a[172:175], v[172:175]
  ds_read_b64_tr_b16 a[152:153], v225 offset:43200
  s_waitcnt lgkmcnt(13)
  v_mfma_f32_16x16x32_bf16 v[176:179], a[156:159], a[160:163], v[176:179]
  ds_read_b64_tr_b16 a[154:155], v225 offset:46784
  v_mul_f32 v151, v151, v243
  v_mfma_f32_16x16x32_bf16 v[180:183], a[156:159], a[164:167], v[180:183]
  v_cvt_pk_bf16_f32 v132, v148, v149
  v_cvt_pk_bf16_f32 v133, v150, v151
  v_mfma_f32_16x16x32_bf16 v[184:187], a[156:159], a[168:171], v[184:187]
  v_pk_mul_f32 v[236:237], v[136:137], v[136:137]
  v_pk_mul_f32 v[240:241], v[140:141], v[140:141]
  v_pk_mul_f32 v[238:239], v[138:139], v[138:139]
  v_pk_mul_f32 v[242:243], v[142:143], v[142:143]
  v_pk_fma_f32 v[236:237], v[236:237], v[244:245], v[246:247]
  v_pk_fma_f32 v[240:241], v[240:241], v[244:245], v[246:247]
  v_pk_fma_f32 v[238:239], v[238:239], v[244:245], v[246:247]
  v_pk_fma_f32 v[242:243], v[242:243], v[244:245], v[246:247]
  v_pk_mul_f32 v[236:237], v[236:237], v[136:137]
  v_pk_mul_f32 v[240:241], v[240:241], v[140:141]
  v_pk_mul_f32 v[238:239], v[238:239], v[138:139]
  v_pk_mul_f32 v[242:243], v[242:243], v[142:143]
  v_exp_f32 v236, v236
  v_exp_f32 v240, v240
  v_exp_f32 v237, v237
  v_exp_f32 v241, v241
  v_exp_f32 v238, v238
  v_exp_f32 v242, v242
  v_exp_f32 v239, v239
  v_exp_f32 v243, v243
  v_pk_mul_f32 v[152:153], v[136:137], v[152:153]
  v_pk_mul_f32 v[156:157], v[140:141], v[156:157]
  v_pk_mul_f32 v[154:155], v[138:139], v[154:155]
  v_pk_mul_f32 v[158:159], v[142:143], v[158:159]
  v_pk_add_f32 v[236:237], v[236:237], 1.0 op_sel_hi:[1,0]
  v_pk_add_f32 v[240:241], v[240:241], 1.0 op_sel_hi:[1,0]
  v_pk_add_f32 v[238:239], v[238:239], 1.0 op_sel_hi:[1,0]
  v_pk_add_f32 v[242:243], v[242:243], 1.0 op_sel_hi:[1,0]
  v_rcp_f32 v236, v236
  v_rcp_f32 v240, v240
  v_rcp_f32 v237, v237
  v_rcp_f32 v241, v241
  v_rcp_f32 v238, v238
  v_rcp_f32 v242, v242
  v_rcp_f32 v239, v239
  v_rcp_f32 v243, v243
  v_pk_mul_f32 v[152:153], v[152:153], v[236:237]
  v_pk_mul_f32 v[156:157], v[156:157], v[240:241]
  v_pk_mul_f32 v[154:155], v[154:155], v[238:239]
  v_pk_mul_f32 v[158:159], v[158:159], v[242:243]
  v_cvt_pk_bf16_f32 v136, v152, v153
  v_cvt_pk_bf16_f32 v140, v156, v157
  v_cvt_pk_bf16_f32 v137, v154, v155
  v_cvt_pk_bf16_f32 v141, v158, v159
  v_mfma_f32_16x16x32_bf16 v[188:191], a[156:159], a[172:175], v[188:191]
  ds_read_b64_tr_b16 a[156:157], v225 offset:50368
  s_waitcnt lgkmcnt(13)
  v_mfma_f32_16x16x32_bf16 v[192:195], a[128:131], a[0:3], v[192:195]
  ds_read_b64_tr_b16 a[158:159], v225 offset:53952
  v_mfma_f32_16x16x32_bf16 v[196:199], a[128:131], a[4:7], v[196:199]
  v_mfma_f32_16x16x32_bf16 v[200:203], a[128:131], a[8:11], v[200:203]
  v_mul_f32 v236, v160, v160
  v_mul_f32 v237, v161, v161
  v_mul_f32 v238, v162, v162
  v_mfma_f32_16x16x32_bf16 v[204:207], a[128:131], a[12:15], v[204:207]
  ds_read_b64_tr_b16 a[128:129], v226 offset:192
  s_waitcnt lgkmcnt(13)
  v_mfma_f32_16x16x32_bf16 v[208:211], a[132:135], a[0:3], v[208:211]
  ds_read_b64_tr_b16 a[130:131], v226 offset:3776
  v_mul_f32 v239, v163, v163
  v_mfma_f32_16x16x32_bf16 v[212:215], a[132:135], a[4:7], v[212:215]
  v_fma_f32 v236, v236, v244, v246
  v_fma_f32 v237, v237, v244, v246
  v_mfma_f32_16x16x32_bf16 v[216:219], a[132:135], a[8:11], v[216:219]
  v_fma_f32 v238, v238, v244, v246
  v_fma_f32 v239, v239, v244, v246
  v_mfma_f32_16x16x32_bf16 v[220:223], a[132:135], a[12:15], v[220:223]
  ds_read_b64_tr_b16 a[132:133], v226 offset:7360
  s_waitcnt lgkmcnt(13)
  v_mfma_f32_16x16x32_bf16 v[192:195], a[136:139], a[16:19], v[192:195]
  ds_read_b64_tr_b16 a[134:135], v226 offset:10944
  v_mul_f32 v236, v236, v160
  v_mfma_f32_16x16x32_bf16 v[196:199], a[136:139], a[20:23], v[196:199]
  v_mul_f32 v237, v237, v161
  v_mul_f32 v238, v238, v162
  v_mul_f32 v239, v239, v163
  v_mfma_f32_16x16x32_bf16 v[200:203], a[136:139], a[24:27], v[200:203]
  v_exp_f32 v236, v236
  v_mfma_f32_16x16x32_bf16 v[204:207], a[136:139], a[28:31], v[204:207]
  ds_read_b64_tr_b16 a[136:137], v226 offset:14528
  s_waitcnt lgkmcnt(13)
  v_mfma_f32_16x16x32_bf16 v[208:211], a[140:143], a[16:19], v[208:211]
  ds_read_b64_tr_b16 a[138:139], v226 offset:18112
  v_mul_f32 v176, v160, v176
  v_mfma_f32_16x16x32_bf16 v[212:215], a[140:143], a[20:23], v[212:215]
  v_exp_f32 v237, v237
  v_mfma_f32_16x16x32_bf16 v[216:219], a[140:143], a[24:27], v[216:219]
  v_mul_f32 v177, v161, v177
  v_exp_f32 v238, v238
  v_mfma_f32_16x16x32_bf16 v[220:223], a[140:143], a[28:31], v[220:223]
  ds_read_b64_tr_b16 a[140:141], v226 offset:21696
  s_waitcnt lgkmcnt(13)
  v_mfma_f32_16x16x32_bf16 v[192:195], a[144:147], a[32:35], v[192:195]
  ds_read_b64_tr_b16 a[142:143], v226 offset:25280
  v_mfma_f32_16x16x32_bf16 v[196:199], a[144:147], a[36:39], v[196:199]
  v_mul_f32 v178, v162, v178
  v_exp_f32 v239, v239
  v_mfma_f32_16x16x32_bf16 v[200:203], a[144:147], a[40:43], v[200:203]
  v_mul_f32 v179, v163, v179
  v_add_f32 v236, 1.0, v236
  v_mfma_f32_16x16x32_bf16 v[204:207], a[144:147], a[44:47], v[204:207]
  ds_read_b64_tr_b16 a[144:145], v227 offset:192
  s_waitcnt lgkmcnt(13)
  v_mfma_f32_16x16x32_bf16 v[208:211], a[148:151], a[32:35], v[208:211]
  ds_read_b64_tr_b16 a[146:147], v227 offset:3776
  v_add_f32 v237, 1.0, v237
  v_mfma_f32_16x16x32_bf16 v[212:215], a[148:151], a[36:39], v[212:215]
  v_add_f32 v238, 1.0, v238
  v_add_f32 v239, 1.0, v239
  v_mfma_f32_16x16x32_bf16 v[216:219], a[148:151], a[40:43], v[216:219]
  v_rcp_f32 v236, v236
  v_rcp_f32 v237, v237
  v_mfma_f32_16x16x32_bf16 v[220:223], a[148:151], a[44:47], v[220:223]
  ds_read_b64_tr_b16 a[148:149], v227 offset:7360
  s_waitcnt lgkmcnt(13)
  v_mfma_f32_16x16x32_bf16 v[192:195], a[152:155], a[48:51], v[192:195]
  ds_read_b64_tr_b16 a[150:151], v227 offset:10944
  v_mfma_f32_16x16x32_bf16 v[196:199], a[152:155], a[52:55], v[196:199]
  v_rcp_f32 v238, v238
  v_mfma_f32_16x16x32_bf16 v[200:203], a[152:155], a[56:59], v[200:203]
  v_rcp_f32 v239, v239
  v_mfma_f32_16x16x32_bf16 v[204:207], a[152:155], a[60:63], v[204:207]
  ds_read_b64_tr_b16 a[152:153], v227 offset:14528
  s_waitcnt lgkmcnt(13)
  v_mfma_f32_16x16x32_bf16 v[208:211], a[156:159], a[48:51], v[208:211]
  ds_read_b64_tr_b16 a[154:155], v227 offset:18112
  v_mul_f32 v176, v176, v236
  v_mfma_f32_16x16x32_bf16 v[212:215], a[156:159], a[52:55], v[212:215]
  v_mul_f32 v177, v177, v237
  v_mul_f32 v178, v178, v238
  v_mfma_f32_16x16x32_bf16 v[216:219], a[156:159], a[56:59], v[216:219]
  v_mul_f32 v179, v179, v239
  v_cvt_pk_bf16_f32 v130, v176, v177
  v_cvt_pk_bf16_f32 v131, v178, v179
  v_mfma_f32_16x16x32_bf16 v[220:223], a[156:159], a[60:63], v[220:223]
  ds_read_b64_tr_b16 a[156:157], v227 offset:21696
  s_waitcnt lgkmcnt(13)
  v_mfma_f32_16x16x32_bf16 v[192:195], a[128:131], a[64:67], v[192:195]
  ds_read_b64_tr_b16 a[158:159], v227 offset:25280
  buffer_store_dwordx4 v[128:131], v224, s[16:19], s25 offen offset:0 sc1
  v_mfma_f32_16x16x32_bf16 v[196:199], a[128:131], a[68:71], v[196:199]
  v_mul_f32 v240, v164, v164
  v_mul_f32 v241, v165, v165
  v_mfma_f32_16x16x32_bf16 v[200:203], a[128:131], a[72:75], v[200:203]
  v_mul_f32 v242, v166, v166
  v_mul_f32 v243, v167, v167
  v_mfma_f32_16x16x32_bf16 v[204:207], a[128:131], a[76:79], v[204:207]
  s_waitcnt lgkmcnt(12)
  v_mfma_f32_16x16x32_bf16 v[208:211], a[132:135], a[64:67], v[208:211]
  v_fma_f32 v240, v240, v244, v246
  v_mfma_f32_16x16x32_bf16 v[212:215], a[132:135], a[68:71], v[212:215]
  v_fma_f32 v241, v241, v244, v246
  v_fma_f32 v242, v242, v244, v246
  v_fma_f32 v243, v243, v244, v246
  v_mfma_f32_16x16x32_bf16 v[216:219], a[132:135], a[72:75], v[216:219]
  v_mul_f32 v240, v240, v164
  v_mul_f32 v241, v241, v165
  v_mfma_f32_16x16x32_bf16 v[220:223], a[132:135], a[76:79], v[220:223]
  s_waitcnt lgkmcnt(10)
  v_mfma_f32_16x16x32_bf16 v[192:195], a[136:139], a[80:83], v[192:195]
  v_mul_f32 v242, v242, v166
  v_mfma_f32_16x16x32_bf16 v[196:199], a[136:139], a[84:87], v[196:199]
  v_mul_f32 v243, v243, v167
  v_exp_f32 v240, v240
  v_mfma_f32_16x16x32_bf16 v[200:203], a[136:139], a[88:91], v[200:203]
  v_mul_f32 v180, v164, v180
  v_mfma_f32_16x16x32_bf16 v[204:207], a[136:139], a[92:95], v[204:207]
  s_waitcnt lgkmcnt(8)
  v_mfma_f32_16x16x32_bf16 v[208:211], a[140:143], a[80:83], v[208:211]
  v_exp_f32 v241, v241
  v_mfma_f32_16x16x32_bf16 v[212:215], a[140:143], a[84:87], v[212:215]
  v_mul_f32 v181, v165, v181
  v_exp_f32 v242, v242
  v_mfma_f32_16x16x32_bf16 v[216:219], a[140:143], a[88:91], v[216:219]
  v_mul_f32 v182, v166, v182
  v_mfma_f32_16x16x32_bf16 v[220:223], a[140:143], a[92:95], v[220:223]
  s_waitcnt lgkmcnt(6)
  v_mfma_f32_16x16x32_bf16 v[192:195], a[144:147], a[96:99], v[192:195]
  v_exp_f32 v243, v243
  v_mfma_f32_16x16x32_bf16 v[196:199], a[144:147], a[100:103], v[196:199]
  v_mul_f32 v183, v167, v183
  v_mfma_f32_16x16x32_bf16 v[200:203], a[144:147], a[104:107], v[200:203]
  v_add_f32 v240, 1.0, v240
  v_add_f32 v241, 1.0, v241
  v_mfma_f32_16x16x32_bf16 v[204:207], a[144:147], a[108:111], v[204:207]
  s_waitcnt lgkmcnt(4)
  v_mfma_f32_16x16x32_bf16 v[208:211], a[148:151], a[96:99], v[208:211]
  v_add_f32 v242, 1.0, v242
  v_add_f32 v243, 1.0, v243
  v_mfma_f32_16x16x32_bf16 v[212:215], a[148:151], a[100:103], v[212:215]
  v_rcp_f32 v240, v240
  v_mfma_f32_16x16x32_bf16 v[216:219], a[148:151], a[104:107], v[216:219]
  v_rcp_f32 v241, v241
  v_mfma_f32_16x16x32_bf16 v[220:223], a[148:151], a[108:111], v[220:223]
  s_waitcnt lgkmcnt(2)
  v_mfma_f32_16x16x32_bf16 v[192:195], a[152:155], a[160:163], v[192:195]
  v_rcp_f32 v242, v242
  v_mfma_f32_16x16x32_bf16 v[196:199], a[152:155], a[164:167], v[196:199]
  v_rcp_f32 v243, v243
  v_mfma_f32_16x16x32_bf16 v[200:203], a[152:155], a[168:171], v[200:203]
  v_mul_f32 v180, v180, v240
  v_mul_f32 v181, v181, v241
  v_mfma_f32_16x16x32_bf16 v[204:207], a[152:155], a[172:175], v[204:207]
  s_waitcnt lgkmcnt(0)
  v_mfma_f32_16x16x32_bf16 v[208:211], a[156:159], a[160:163], v[208:211]
  v_mul_f32 v182, v182, v242
  v_mfma_f32_16x16x32_bf16 v[212:215], a[156:159], a[164:167], v[212:215]
  v_mul_f32 v183, v183, v243
  v_cvt_pk_bf16_f32 v134, v180, v181
  v_cvt_pk_bf16_f32 v135, v182, v183
  buffer_store_dwordx4 v[132:135], v224, s[16:19], s25 offen offset:1024 sc1
  v_mfma_f32_16x16x32_bf16 v[216:219], a[156:159], a[168:171], v[216:219]
  v_pk_mul_f32 v[236:237], v[168:169], v[168:169]
  v_pk_mul_f32 v[240:241], v[172:173], v[172:173]
  v_pk_mul_f32 v[238:239], v[170:171], v[170:171]
  v_pk_mul_f32 v[242:243], v[174:175], v[174:175]
  v_pk_fma_f32 v[236:237], v[236:237], v[244:245], v[246:247]
  v_pk_fma_f32 v[240:241], v[240:241], v[244:245], v[246:247]
  v_pk_fma_f32 v[238:239], v[238:239], v[244:245], v[246:247]
  v_pk_fma_f32 v[242:243], v[242:243], v[244:245], v[246:247]
  v_pk_mul_f32 v[236:237], v[236:237], v[168:169]
  v_pk_mul_f32 v[240:241], v[240:241], v[172:173]
  v_pk_mul_f32 v[238:239], v[238:239], v[170:171]
  v_pk_mul_f32 v[242:243], v[242:243], v[174:175]
  v_exp_f32 v236, v236
  v_exp_f32 v240, v240
  v_exp_f32 v237, v237
  v_exp_f32 v241, v241
  v_exp_f32 v238, v238
  v_exp_f32 v242, v242
  v_exp_f32 v239, v239
  v_exp_f32 v243, v243
  v_pk_mul_f32 v[184:185], v[168:169], v[184:185]
  v_pk_mul_f32 v[188:189], v[172:173], v[188:189]
  v_pk_mul_f32 v[186:187], v[170:171], v[186:187]
  v_pk_mul_f32 v[190:191], v[174:175], v[190:191]
  v_pk_add_f32 v[236:237], v[236:237], 1.0 op_sel_hi:[1,0]
  v_pk_add_f32 v[240:241], v[240:241], 1.0 op_sel_hi:[1,0]
  v_pk_add_f32 v[238:239], v[238:239], 1.0 op_sel_hi:[1,0]
  v_pk_add_f32 v[242:243], v[242:243], 1.0 op_sel_hi:[1,0]
  v_rcp_f32 v236, v236
  v_rcp_f32 v240, v240
  v_rcp_f32 v237, v237
  v_rcp_f32 v241, v241
  v_rcp_f32 v238, v238
  v_rcp_f32 v242, v242
  v_rcp_f32 v239, v239
  v_rcp_f32 v243, v243
  v_pk_mul_f32 v[184:185], v[184:185], v[236:237]
  v_pk_mul_f32 v[188:189], v[188:189], v[240:241]
  v_pk_mul_f32 v[186:187], v[186:187], v[238:239]
  v_pk_mul_f32 v[190:191], v[190:191], v[242:243]
  v_cvt_pk_bf16_f32 v138, v184, v185
  v_cvt_pk_bf16_f32 v142, v188, v189
  v_cvt_pk_bf16_f32 v139, v186, v187
  v_cvt_pk_bf16_f32 v143, v190, v191
  buffer_store_dwordx4 v[136:139], v224, s[16:19], s25 offen offset:2048 sc1
  buffer_store_dwordx4 v[140:143], v224, s[16:19], s25 offen offset:3072 sc1
  s_add_u32 s25, s25, 4096
  v_mfma_f32_16x16x32_bf16 v[220:223], a[156:159], a[172:175], v[220:223]
  v_pk_mul_f32 v[236:237], v[192:193], v[192:193]
  v_pk_mul_f32 v[240:241], v[196:197], v[196:197]
  v_pk_mul_f32 v[238:239], v[194:195], v[194:195]
  v_pk_mul_f32 v[242:243], v[198:199], v[198:199]
  v_pk_fma_f32 v[236:237], v[236:237], v[244:245], v[246:247]
  v_pk_fma_f32 v[240:241], v[240:241], v[244:245], v[246:247]
  v_pk_fma_f32 v[238:239], v[238:239], v[244:245], v[246:247]
  v_pk_fma_f32 v[242:243], v[242:243], v[244:245], v[246:247]
  v_pk_mul_f32 v[236:237], v[236:237], v[192:193]
  v_pk_mul_f32 v[240:241], v[240:241], v[196:197]
  v_pk_mul_f32 v[238:239], v[238:239], v[194:195]
  v_pk_mul_f32 v[242:243], v[242:243], v[198:199]
  v_exp_f32 v236, v236
  v_exp_f32 v240, v240
  v_exp_f32 v237, v237
  v_exp_f32 v241, v241
  v_exp_f32 v238, v238
  v_exp_f32 v242, v242
  v_exp_f32 v239, v239
  v_exp_f32 v243, v243
  v_pk_mul_f32 v[208:209], v[192:193], v[208:209]
  v_pk_mul_f32 v[212:213], v[196:197], v[212:213]
  v_pk_mul_f32 v[210:211], v[194:195], v[210:211]
  v_pk_mul_f32 v[214:215], v[198:199], v[214:215]
  v_pk_add_f32 v[236:237], v[236:237], 1.0 op_sel_hi:[1,0]
  v_pk_add_f32 v[240:241], v[240:241], 1.0 op_sel_hi:[1,0]
  v_pk_add_f32 v[238:239], v[238:239], 1.0 op_sel_hi:[1,0]
  v_pk_add_f32 v[242:243], v[242:243], 1.0 op_sel_hi:[1,0]
  v_rcp_f32 v236, v236
  v_rcp_f32 v240, v240
  v_rcp_f32 v237, v237
  v_rcp_f32 v241, v241
  v_rcp_f32 v238, v238
  v_rcp_f32 v242, v242
  v_rcp_f32 v239, v239
  v_rcp_f32 v243, v243
  v_pk_mul_f32 v[208:209], v[208:209], v[236:237]
  v_pk_mul_f32 v[212:213], v[212:213], v[240:241]
  v_pk_mul_f32 v[210:211], v[210:211], v[238:239]
  v_pk_mul_f32 v[214:215], v[214:215], v[242:243]
  v_cvt_pk_bf16_f32 v192, v208, v209
  v_cvt_pk_bf16_f32 v196, v212, v213
  v_cvt_pk_bf16_f32 v193, v210, v211
  v_cvt_pk_bf16_f32 v197, v214, v215
  buffer_store_dwordx2 v[192:193], v224, s[16:19], s26 offen offset:0 sc1
  buffer_store_dwordx2 v[196:197], v224, s[16:19], s26 offen offset:1024 sc1
  v_pk_mul_f32 v[236:237], v[200:201], v[200:201]
  v_pk_mul_f32 v[240:241], v[204:205], v[204:205]
  v_pk_mul_f32 v[238:239], v[202:203], v[202:203]
  v_pk_mul_f32 v[242:243], v[206:207], v[206:207]
  v_pk_fma_f32 v[236:237], v[236:237], v[244:245], v[246:247]
  v_pk_fma_f32 v[240:241], v[240:241], v[244:245], v[246:247]
  v_pk_fma_f32 v[238:239], v[238:239], v[244:245], v[246:247]
  v_pk_fma_f32 v[242:243], v[242:243], v[244:245], v[246:247]
  v_pk_mul_f32 v[236:237], v[236:237], v[200:201]
  v_pk_mul_f32 v[240:241], v[240:241], v[204:205]
  v_pk_mul_f32 v[238:239], v[238:239], v[202:203]
  v_pk_mul_f32 v[242:243], v[242:243], v[206:207]
  v_exp_f32 v236, v236
  v_exp_f32 v240, v240
  v_exp_f32 v237, v237
  v_exp_f32 v241, v241
  v_exp_f32 v238, v238
  v_exp_f32 v242, v242
  v_exp_f32 v239, v239
  v_exp_f32 v243, v243
  v_pk_mul_f32 v[216:217], v[200:201], v[216:217]
  v_pk_mul_f32 v[220:221], v[204:205], v[220:221]
  v_pk_mul_f32 v[218:219], v[202:203], v[218:219]
  v_pk_mul_f32 v[222:223], v[206:207], v[222:223]
  v_pk_add_f32 v[236:237], v[236:237], 1.0 op_sel_hi:[1,0]
  v_pk_add_f32 v[240:241], v[240:241], 1.0 op_sel_hi:[1,0]
  v_pk_add_f32 v[238:239], v[238:239], 1.0 op_sel_hi:[1,0]
  v_pk_add_f32 v[242:243], v[242:243], 1.0 op_sel_hi:[1,0]
  v_rcp_f32 v236, v236
  v_rcp_f32 v240, v240
  v_rcp_f32 v237, v237
  v_rcp_f32 v241, v241
  v_rcp_f32 v238, v238
  v_rcp_f32 v242, v242
  v_rcp_f32 v239, v239
  v_rcp_f32 v243, v243
  v_pk_mul_f32 v[216:217], v[216:217], v[236:237]
  v_pk_mul_f32 v[220:221], v[220:221], v[240:241]
  v_pk_mul_f32 v[218:219], v[218:219], v[238:239]
  v_pk_mul_f32 v[222:223], v[222:223], v[242:243]
  v_cvt_pk_bf16_f32 v200, v216, v217
  v_cvt_pk_bf16_f32 v204, v220, v221
  v_cvt_pk_bf16_f32 v201, v218, v219
  v_cvt_pk_bf16_f32 v205, v222, v223
  buffer_store_dwordx2 v[200:201], v224, s[16:19], s26 offen offset:2048 sc1
  buffer_store_dwordx2 v[204:205], v224, s[16:19], s26 offen offset:3072 sc1
  s_lshl_b32 s36, s54, 5
  s_add_u32 s36, s36, s55
  s_sub_u32 s53, s53, 3670016
  v_mbcnt_lo_u32_b32 v100, -1, 0
  v_mbcnt_hi_u32_b32 v100, -1, v100
  s_and_b32 s33, s2, 1
  s_bfe_u32 s34, s2, 0x20001
  s_lshl_b32 s34, s34, 2
  s_lshr_b32 s35, s2, 6
  s_add_u32 s34, s34, s35
  s_bfe_u32 s35, s2, 0x30003
  v_lshlrev_b32 v64, 4, v100
  v_lshrrev_b32 v102, 4, v100
  v_bfe_u32 v103, v100, 1, 3
  v_and_b32 v104, 1, v100
  v_xor_b32 v105, v103, v102
  v_lshl_add_u32 v105, v105, 1, v104
  v_lshlrev_b32 v105, 4, v105
  v_lshl_add_u32 v124, v102, 11, v105
  v_add_u32 v102, 4, v102
  v_xor_b32 v105, v103, v102
  v_lshl_add_u32 v105, v105, 1, v104
  v_lshlrev_b32 v105, 4, v105
  v_lshl_add_u32 v125, v102, 11, v105
  v_add_u32 v126, 14336, v124
  v_add_u32 v127, 13312, v125
  v_subrev_u32 v125, 1024, v125
  s_lshl_b32 s25, s96, 15
  s_lshl_b32 s37, s35, 8
  s_add_u32 s25, s25, s37
  s_lshl_b32 s24, s96, 12
  s_and_b32 s26, s96, 1
  s_lshl_b32 s26, s26, 11
  s_mul_i32 s39, s33, 3670016
  s_lshr_b32 s37, s96, 1
  s_lshl_b32 s38, s34, 1
  s_add_u32 s37, s37, s38
  s_mul_i32 s37, s37, 458752
  s_mul_i32 s38, s33, 229376
  s_add_u32 s37, s37, s38
  s_add_u32 s37, s37, 67108864
  s_add_u32 s8, s88, s39
  s_addc_u32 s9, s89, 0
  s_mov_b32 s10, 3670016
  s_mov_b32 s11, 0x00020000
  s_add_u32 s12, s92, s37
  s_addc_u32 s13, s93, 0
  s_mov_b32 s14, 229376
  s_mov_b32 s15, 0x00020000
  v_lshrrev_b32 v102, 2, v100
  v_and_b32 v103, 7, v102
  s_lshl_b32 s37, s33, 2
  v_xor_b32 v103, s37, v103
  v_and_b32 v104, 3, v100
  v_lshlrev_b32 v104, 3, v104
  v_lshl_add_u32 v104, v102, 8, v104
  v_xor_b32 v105, 0, v103
  v_lshl_add_u32 v68, v105, 5, v104
  v_add_u32 v76, 0x10000, v68
  v_xor_b32 v105, 1, v103
  v_lshl_add_u32 v69, v105, 5, v104
  v_add_u32 v77, 0x10000, v69
  v_xor_b32 v105, 2, v103
  v_lshl_add_u32 v70, v105, 5, v104
  v_add_u32 v78, 0x10000, v70
  v_xor_b32 v105, 3, v103
  v_lshl_add_u32 v71, v105, 5, v104
  v_add_u32 v79, 0x10000, v71
  v_xor_b32 v105, 4, v103
  v_lshl_add_u32 v72, v105, 5, v104
  v_add_u32 v80, 0x10000, v72
  v_xor_b32 v105, 5, v103
  v_lshl_add_u32 v73, v105, 5, v104
  v_add_u32 v81, 0x10000, v73
  v_xor_b32 v105, 6, v103
  v_lshl_add_u32 v74, v105, 5, v104
  v_add_u32 v82, 0x10000, v74
  v_xor_b32 v105, 7, v103
  v_lshl_add_u32 v75, v105, 5, v104
  v_add_u32 v83, 0x10000, v75
  v_and_b32 v102, 15, v100
  v_bfe_u32 v103, v100, 4, 1
  v_lshrrev_b32 v104, 5, v100
  v_lshl_add_u32 v103, v103, 1, v104
  v_lshlrev_b32 v84, 8, v103
  v_lshl_add_u32 v84, v102, 4, v84
  v_lshrrev_b32 v104, 1, v102
  v_and_b32 v105, 1, v102
  v_lshlrev_b32 v104, 17, v104
  v_lshl_add_u32 v104, v105, 21, v104
  v_lshl_add_u32 v85, v103, 4, v104
  s_waitcnt vmcnt(0)
  s_barrier
  s_add_u32 s76, s92, 0x7000000
  s_addc_u32 s77, s93, 0
  s_mov_b32 s78, 0x28000
  s_mov_b32 s79, 0x00020000
  s_cmp_lg_u32 s96, 0
  s_cbranch_scc1 fa_kernel_pub13
  s_lshl_b32 s3, s36, 7
  s_add_u32 s3, s3, 32768
  v_mov_b32 v106, 1
  v_mov_b32 v107, 0
  s_mov_b64 exec, 1
  buffer_store_dword v106, v107, s[76:79], s3 offen sc1
  s_mov_b64 exec, -1
fa_kernel_pub13:
  s_add_u32 m0, s24, 0
  s_add_u32 s29, s25, 0
  buffer_load_dwordx4 v124, s[8:11], s29 offen offset:0 lds
  buffer_load_dwordx4 v125, s[8:11], s29 offen offset:1024 lds
  buffer_load_dwordx4 v126, s[8:11], s29 offen offset:2048 lds
  buffer_load_dwordx4 v127, s[8:11], s29 offen offset:3072 lds
  s_add_u32 m0, s24, 16384
  s_add_u32 s29, s25, 131072
  buffer_load_dwordx4 v124, s[8:11], s29 offen offset:0 lds
  buffer_load_dwordx4 v125, s[8:11], s29 offen offset:1024 lds
  buffer_load_dwordx4 v126, s[8:11], s29 offen offset:2048 lds
  buffer_load_dwordx4 v127, s[8:11], s29 offen offset:3072 lds
  s_add_u32 m0, s24, 32768
  s_add_u32 s29, s25, 262144
  buffer_load_dwordx4 v124, s[8:11], s29 offen offset:0 lds
  buffer_load_dwordx4 v125, s[8:11], s29 offen offset:1024 lds
  buffer_load_dwordx4 v126, s[8:11], s29 offen offset:2048 lds
  buffer_load_dwordx4 v127, s[8:11], s29 offen offset:3072 lds
  v_mov_b32 v0, 0
  v_mov_b32 v1, 0
  v_mov_b32 v2, 0
  v_mov_b32 v3, 0
  v_mov_b32 v4, 0
  v_mov_b32 v5, 0
  v_mov_b32 v6, 0
  v_mov_b32 v7, 0
  v_mov_b32 v8, 0
  v_mov_b32 v9, 0
  v_mov_b32 v10, 0
  v_mov_b32 v11, 0
  v_mov_b32 v12, 0
  v_mov_b32 v13, 0
  v_mov_b32 v14, 0
  v_mov_b32 v15, 0
  v_mov_b32 v16, 0
  v_mov_b32 v17, 0
  v_mov_b32 v18, 0
  v_mov_b32 v19, 0
  v_mov_b32 v20, 0
  v_mov_b32 v21, 0
  v_mov_b32 v22, 0
  v_mov_b32 v23, 0
  v_mov_b32 v24, 0
  v_mov_b32 v25, 0
  v_mov_b32 v26, 0
  v_mov_b32 v27, 0
  v_mov_b32 v28, 0
  v_mov_b32 v29, 0
  v_mov_b32 v30, 0
  v_mov_b32 v31, 0
  v_mov_b32 v32, 0
  v_mov_b32 v33, 0
  v_mov_b32 v34, 0
  v_mov_b32 v35, 0
  v_mov_b32 v36, 0
  v_mov_b32 v37, 0
  v_mov_b32 v38, 0
  v_mov_b32 v39, 0
  v_mov_b32 v40, 0
  v_mov_b32 v41, 0
  v_mov_b32 v42, 0
  v_mov_b32 v43, 0
  v_mov_b32 v44, 0
  v_mov_b32 v45, 0
  v_mov_b32 v46, 0
  v_mov_b32 v47, 0
  v_mov_b32 v48, 0
  v_mov_b32 v49, 0
  v_mov_b32 v50, 0
  v_mov_b32 v51, 0
  v_mov_b32 v52, 0
  v_mov_b32 v53, 0
  v_mov_b32 v54, 0
  v_mov_b32 v55, 0
  v_mov_b32 v56, 0
  v_mov_b32 v57, 0
  v_mov_b32 v58, 0
  v_mov_b32 v59, 0
  v_mov_b32 v60, 0
  v_mov_b32 v61, 0
  v_mov_b32 v62, 0
  v_mov_b32 v63, 0
  s_lshr_b32 s36, s34, 1
  s_lshl_b32 s36, s36, 5
  s_cmp_lg_u32 s96, 0
  s_cbranch_scc1 fa_kernel_pe16
  v_mbcnt_lo_u32_b32 v107, -1, 0
  v_lshlrev_b32 v107, 7, v107
  s_lshl_b32 s3, s36, 7
  s_add_u32 s3, s3, 32768
  s_mov_b64 exec, 0xffffffff
  s_mov_b32 s80, 0x40000
fa_kernel_pl14:
  buffer_load_dword v106, v107, s[76:79], s3 offen sc1
  s_waitcnt vmcnt(0)
  v_cmp_gt_u32 vcc, 1, v106
  s_cbranch_vccz fa_kernel_pd15
  s_sub_u32 s80, s80, 1
  s_cmp_lg_u32 s80, 0
  s_cbranch_scc1 fa_kernel_pl14
fa_kernel_pd15:
  s_mov_b64 exec, -1
fa_kernel_pe16:
  s_add_u32 m0, s24, 49152
  s_add_u32 s29, s25, 393216
  buffer_load_dwordx4 v124, s[8:11], s29 offen offset:0 lds
  buffer_load_dwordx4 v125, s[8:11], s29 offen offset:1024 lds
  buffer_load_dwordx4 v126, s[8:11], s29 offen offset:2048 lds
  buffer_load_dwordx4 v127, s[8:11], s29 offen offset:3072 lds
  s_add_u32 m0, s24, 65536
  s_add_u32 s29, s25, 524288
  buffer_load_dwordx4 v124, s[8:11], s29 offen offset:0 lds
  buffer_load_dwordx4 v125, s[8:11], s29 offen offset:1024 lds
  buffer_load_dwordx4 v126, s[8:11], s29 offen offset:2048 lds
  buffer_load_dwordx4 v127, s[8:11], s29 offen offset:3072 lds
  s_add_u32 m0, s24, 81920
  s_add_u32 s29, s25, 655360
  buffer_load_dwordx4 v124, s[8:11], s29 offen offset:0 lds
  buffer_load_dwordx4 v125, s[8:11], s29 offen offset:1024 lds
  buffer_load_dwordx4 v126, s[8:11], s29 offen offset:2048 lds
  buffer_load_dwordx4 v127, s[8:11], s29 offen offset:3072 lds
  s_add_u32 m0, s24, 98304
  s_add_u32 s29, s25, 786432
  buffer_load_dwordx4 v124, s[8:11], s29 offen offset:0 lds
  buffer_load_dwordx4 v125, s[8:11], s29 offen offset:1024 lds
  buffer_load_dwordx4 v126, s[8:11], s29 offen offset:2048 lds
  buffer_load_dwordx4 v127, s[8:11], s29 offen offset:3072 lds
  s_barrier
  s_add_u32 s30, s26, 0
  buffer_load_dwordx4 a[0:3], v64, s[12:15], s30 offen offset:0 sc1
  buffer_load_dwordx4 a[4:7], v64, s[12:15], s30 offen offset:1024 sc1
  s_add_u32 s30, s26, 4096
  buffer_load_dwordx4 a[8:11], v64, s[12:15], s30 offen offset:0 sc1
  buffer_load_dwordx4 a[12:15], v64, s[12:15], s30 offen offset:1024 sc1
  s_add_u32 s30, s26, 8192
  buffer_load_dwordx4 a[16:19], v64, s[12:15], s30 offen offset:0 sc1
  buffer_load_dwordx4 a[20:23], v64, s[12:15], s30 offen offset:1024 sc1
  s_add_u32 s30, s26, 12288
  buffer_load_dwordx4 a[24:27], v64, s[12:15], s30 offen offset:0 sc1
  buffer_load_dwordx4 a[28:31], v64, s[12:15], s30 offen offset:1024 sc1
  s_add_u32 s30, s26, 16384
  buffer_load_dwordx4 a[32:35], v64, s[12:15], s30 offen offset:0 sc1
  buffer_load_dwordx4 a[36:39], v64, s[12:15], s30 offen offset:1024 sc1
  s_add_u32 s16, s92, 0x400000
  s_addc_u32 s17, s93, 0
  s_mov_b32 s18, 0x400000
  s_mov_b32 s19, 0x00020000
  s_xor_b32 s37, s97, 1
  s_and_b32 s37, s37, s33
  s_cmp_eq_u32 s37, 0
  s_cselect_b32 s18, s18, 0
  s_lshr_b32 s36, s34, 1
  s_lshl_b32 s36, s36, 19
  s_and_b32 s37, s34, 1
  s_lshl_b32 s37, s37, 13
  s_add_u32 s36, s36, s37
  s_lshl_b32 s37, s96, 11
  s_add_u32 s36, s36, s37
  s_lshl_b32 s37, s35, 16
  s_add_u32 s36, s36, s37
  s_lshl_b32 s37, s33, 15
  s_add_u32 s40, s36, s37
  s_add_u32 s41, s40, 16384
  s_xor_b32 s42, s40, 0x8000
  s_add_u32 s43, s42, 16384
  s_lshl_b32 s36, s34, 2
  s_add_u32 s36, s36, s96
  s_lshl_b32 s36, s36, 11
  s_lshl_b32 s37, s35, 8
  s_add_u32 s36, s36, s37
  s_lshl_b32 s37, s33, 7
  s_add_u32 s44, s36, s37
  s_add_u32 s45, s44, 0x100000
  s_xor_b32 s46, s44, 0x80
  s_xor_b32 s47, s45, 0x80
  s_mov_b32 s27, 3
  s_waitcnt vmcnt(34)
  s_barrier
  ds_read_b64_tr_b16 a[112:113], v68 offset:0
  ds_read_b64_tr_b16 a[114:115], v68 offset:4096
  ds_read_b64_tr_b16 a[116:117], v69 offset:0
  ds_read_b64_tr_b16 a[118:119], v69 offset:4096
  ds_read_b64_tr_b16 a[120:121], v70 offset:0
  ds_read_b64_tr_b16 a[122:123], v70 offset:4096
  ds_read_b64_tr_b16 a[124:125], v71 offset:0
  ds_read_b64_tr_b16 a[126:127], v71 offset:4096
  ds_read_b64_tr_b16 a[128:129], v72 offset:0
  ds_read_b64_tr_b16 a[130:131], v72 offset:4096
  s_waitcnt vmcnt(8) lgkmcnt(6)
  v_mfma_f32_16x16x32_bf16 v[0:3], a[112:115], a[0:3], v[0:3]
  ds_read_b64_tr_b16 a[132:133], v73 offset:0
  v_mfma_f32_16x16x32_bf16 v[4:7], a[112:115], a[4:7], v[4:7]
  s_add_u32 s30, s26, 20480
  ds_read_b64_tr_b16 a[134:135], v73 offset:4096
  ds_read_b64_tr_b16 a[136:137], v74 offset:0
  v_mfma_f32_16x16x32_bf16 v[8:11], a[116:119], a[0:3], v[8:11]
  buffer_load_dwordx4 a[40:43], v64, s[12:15], s30 offen offset:0 sc1
  ds_read_b64_tr_b16 a[138:139], v74 offset:4096
  v_mfma_f32_16x16x32_bf16 v[12:15], a[116:119], a[4:7], v[12:15]
  ds_read_b64_tr_b16 a[140:141], v75 offset:0
  s_waitcnt lgkmcnt(7)
  v_mfma_f32_16x16x32_bf16 v[16:19], a[120:123], a[0:3], v[16:19]
  ds_read_b64_tr_b16 a[142:143], v75 offset:4096
  v_mfma_f32_16x16x32_bf16 v[20:23], a[120:123], a[4:7], v[20:23]
  ds_read_b64_tr_b16 a[112:113], v68 offset:8192
  v_mfma_f32_16x16x32_bf16 v[24:27], a[124:127], a[0:3], v[24:27]
  ds_read_b64_tr_b16 a[114:115], v68 offset:12288
  v_mfma_f32_16x16x32_bf16 v[28:31], a[124:127], a[4:7], v[28:31]
  ds_read_b64_tr_b16 a[116:117], v69 offset:8192
  s_waitcnt lgkmcnt(7)
  v_mfma_f32_16x16x32_bf16 v[32:35], a[128:131], a[0:3], v[32:35]
  ds_read_b64_tr_b16 a[118:119], v69 offset:12288
  v_mfma_f32_16x16x32_bf16 v[36:39], a[128:131], a[4:7], v[36:39]
  ds_read_b64_tr_b16 a[120:121], v70 offset:8192
  v_mfma_f32_16x16x32_bf16 v[40:43], a[132:135], a[0:3], v[40:43]
  buffer_load_dwordx4 a[44:47], v64, s[12:15], s30 offen offset:1024 sc1
  ds_read_b64_tr_b16 a[122:123], v70 offset:12288
  v_mfma_f32_16x16x32_bf16 v[44:47], a[132:135], a[4:7], v[44:47]
  ds_read_b64_tr_b16 a[124:125], v71 offset:8192
  s_waitcnt lgkmcnt(7)
  v_mfma_f32_16x16x32_bf16 v[48:51], a[136:139], a[0:3], v[48:51]
  ds_read_b64_tr_b16 a[126:127], v71 offset:12288
  v_mfma_f32_16x16x32_bf16 v[52:55], a[136:139], a[4:7], v[52:55]
  ds_read_b64_tr_b16 a[128:129], v72 offset:8192
  v_mfma_f32_16x16x32_bf16 v[56:59], a[140:143], a[0:3], v[56:59]
  ds_read_b64_tr_b16 a[130:131], v72 offset:12288
  v_mfma_f32_16x16x32_bf16 v[60:63], a[140:143], a[4:7], v[60:63]
  ds_read_b64_tr_b16 a[132:133], v73 offset:8192
  s_waitcnt vmcnt(8) lgkmcnt(7)
  v_mfma_f32_16x16x32_bf16 v[0:3], a[112:115], a[8:11], v[0:3]
  ds_read_b64_tr_b16 a[134:135], v73 offset:12288
  v_mfma_f32_16x16x32_bf16 v[4:7], a[112:115], a[12:15], v[4:7]
  s_add_u32 s30, s26, 24576
  ds_read_b64_tr_b16 a[136:137], v74 offset:8192
  v_mfma_f32_16x16x32_bf16 v[8:11], a[116:119], a[8:11], v[8:11]
  buffer_load_dwordx4 a[48:51], v64, s[12:15], s30 offen offset:0 sc1
  ds_read_b64_tr_b16 a[138:139], v74 offset:12288
  v_mfma_f32_16x16x32_bf16 v[12:15], a[116:119], a[12:15], v[12:15]
  ds_read_b64_tr_b16 a[140:141], v75 offset:8192
  s_waitcnt lgkmcnt(7)
  v_mfma_f32_16x16x32_bf16 v[16:19], a[120:123], a[8:11], v[16:19]
  ds_read_b64_tr_b16 a[142:143], v75 offset:12288
  v_mfma_f32_16x16x32_bf16 v[20:23], a[120:123], a[12:15], v[20:23]
.p2align 6
fa_kernel_g2loop:
  s_waitcnt lgkmcnt(0)
  s_barrier
  s_add_u32 m0, s24, 0
  s_add_u32 s29, s25, 917504
  ds_read_b64_tr_b16 a[112:113], v68 offset:16384
  v_mfma_f32_16x16x32_bf16 v[24:27], a[124:127], a[8:11], v[24:27]
  buffer_load_dwordx4 v124, s[8:11], s29 offen offset:0 lds
  ds_read_b64_tr_b16 a[114:115], v68 offset:20480
  v_mfma_f32_16x16x32_bf16 v[28:31], a[124:127], a[12:15], v[28:31]
  ds_read_b64_tr_b16 a[116:117], v69 offset:16384
  v_mfma_f32_16x16x32_bf16 v[32:35], a[128:131], a[8:11], v[32:35]
  ds_read_b64_tr_b16 a[118:119], v69 offset:20480
  v_mfma_f32_16x16x32_bf16 v[36:39], a[128:131], a[12:15], v[36:39]
  ds_read_b64_tr_b16 a[120:121], v70 offset:16384
  v_mfma_f32_16x16x32_bf16 v[40:43], a[132:135], a[8:11], v[40:43]
  buffer_load_dwordx4 a[52:55], v64, s[12:15], s30 offen offset:1024 sc1
  ds_read_b64_tr_b16 a[122:123], v70 offset:20480
  v_mfma_f32_16x16x32_bf16 v[44:47], a[132:135], a[12:15], v[44:47]
  ds_read_b64_tr_b16 a[124:125], v71 offset:16384
  v_mfma_f32_16x16x32_bf16 v[48:51], a[136:139], a[8:11], v[48:51]
  ds_read_b64_tr_b16 a[126:127], v71 offset:20480
  v_mfma_f32_16x16x32_bf16 v[52:55], a[136:139], a[12:15], v[52:55]
  ds_read_b64_tr_b16 a[128:129], v72 offset:16384
  v_mfma_f32_16x16x32_bf16 v[56:59], a[140:143], a[8:11], v[56:59]
  buffer_load_dwordx4 v125, s[8:11], s29 offen offset:1024 lds
  ds_read_b64_tr_b16 a[130:131], v72 offset:20480
  v_mfma_f32_16x16x32_bf16 v[60:63], a[140:143], a[12:15], v[60:63]
  ds_read_b64_tr_b16 a[132:133], v73 offset:16384
  s_waitcnt vmcnt(10) lgkmcnt(7)
  v_mfma_f32_16x16x32_bf16 v[0:3], a[112:115], a[16:19], v[0:3]
  ds_read_b64_tr_b16 a[134:135], v73 offset:20480
  v_mfma_f32_16x16x32_bf16 v[4:7], a[112:115], a[20:23], v[4:7]
  s_add_u32 s30, s26, 28672
  ds_read_b64_tr_b16 a[136:137], v74 offset:16384
  v_mfma_f32_16x16x32_bf16 v[8:11], a[116:119], a[16:19], v[8:11]
  buffer_load_dwordx4 a[56:59], v64, s[12:15], s30 offen offset:0 sc1
  ds_read_b64_tr_b16 a[138:139], v74 offset:20480
  v_mfma_f32_16x16x32_bf16 v[12:15], a[116:119], a[20:23], v[12:15]
  ds_read_b64_tr_b16 a[140:141], v75 offset:16384
  s_waitcnt lgkmcnt(7)
  v_mfma_f32_16x16x32_bf16 v[16:19], a[120:123], a[16:19], v[16:19]
  ds_read_b64_tr_b16 a[142:143], v75 offset:20480
  v_mfma_f32_16x16x32_bf16 v[20:23], a[120:123], a[20:23], v[20:23]
  ds_read_b64_tr_b16 a[112:113], v68 offset:24576
  v_mfma_f32_16x16x32_bf16 v[24:27], a[124:127], a[16:19], v[24:27]
  buffer_load_dwordx4 v126, s[8:11], s29 offen offset:2048 lds
  ds_read_b64_tr_b16 a[114:115], v68 offset:28672
  v_mfma_f32_16x16x32_bf16 v[28:31], a[124:127], a[20:23], v[28:31]
  ds_read_b64_tr_b16 a[116:117], v69 offset:24576
  s_waitcnt lgkmcnt(7)
  v_mfma_f32_16x16x32_bf16 v[32:35], a[128:131], a[16:19], v[32:35]
  ds_read_b64_tr_b16 a[118:119], v69 offset:28672
  v_mfma_f32_16x16x32_bf16 v[36:39], a[128:131], a[20:23], v[36:39]
  ds_read_b64_tr_b16 a[120:121], v70 offset:24576
  v_mfma_f32_16x16x32_bf16 v[40:43], a[132:135], a[16:19], v[40:43]
  buffer_load_dwordx4 a[60:63], v64, s[12:15], s30 offen offset:1024 sc1
  ds_read_b64_tr_b16 a[122:123], v70 offset:28672
  v_mfma_f32_16x16x32_bf16 v[44:47], a[132:135], a[20:23], v[44:47]
  ds_read_b64_tr_b16 a[124:125], v71 offset:24576
  s_waitcnt lgkmcnt(7)
  v_mfma_f32_16x16x32_bf16 v[48:51], a[136:139], a[16:19], v[48:51]
  ds_read_b64_tr_b16 a[126:127], v71 offset:28672
  v_mfma_f32_16x16x32_bf16 v[52:55], a[136:139], a[20:23], v[52:55]
  ds_read_b64_tr_b16 a[128:129], v72 offset:24576
  v_mfma_f32_16x16x32_bf16 v[56:59], a[140:143], a[16:19], v[56:59]
  buffer_load_dwordx4 v127, s[8:11], s29 offen offset:3072 lds
  ds_read_b64_tr_b16 a[130:131], v72 offset:28672
  v_mfma_f32_16x16x32_bf16 v[60:63], a[140:143], a[20:23], v[60:63]
  ds_read_b64_tr_b16 a[132:133], v73 offset:24576
  s_waitcnt vmcnt(12) lgkmcnt(7)
  v_mfma_f32_16x16x32_bf16 v[0:3], a[112:115], a[24:27], v[0:3]
  ds_read_b64_tr_b16 a[134:135], v73 offset:28672
  v_mfma_f32_16x16x32_bf16 v[4:7], a[112:115], a[28:31], v[4:7]
  s_add_u32 s30, s26, 32768
  ds_read_b64_tr_b16 a[136:137], v74 offset:24576
  v_mfma_f32_16x16x32_bf16 v[8:11], a[116:119], a[24:27], v[8:11]
  buffer_load_dwordx4 a[64:67], v64, s[12:15], s30 offen offset:0 sc1
  ds_read_b64_tr_b16 a[138:139], v74 offset:28672
  v_mfma_f32_16x16x32_bf16 v[12:15], a[116:119], a[28:31], v[12:15]
  ds_read_b64_tr_b16 a[140:141], v75 offset:24576
  s_waitcnt lgkmcnt(7)
  v_mfma_f32_16x16x32_bf16 v[16:19], a[120:123], a[24:27], v[16:19]
  ds_read_b64_tr_b16 a[142:143], v75 offset:28672
  v_mfma_f32_16x16x32_bf16 v[20:23], a[120:123], a[28:31], v[20:23]
  s_waitcnt lgkmcnt(0)
  s_barrier
  s_add_u32 m0, s24, 16384
  s_add_u32 s29, s25, 1048576
  ds_read_b64_tr_b16 a[112:113], v68 offset:32768
  v_mfma_f32_16x16x32_bf16 v[24:27], a[124:127], a[24:27], v[24:27]
  buffer_load_dwordx4 v124, s[8:11], s29 offen offset:0 lds
  ds_read_b64_tr_b16 a[114:115], v68 offset:36864
  v_mfma_f32_16x16x32_bf16 v[28:31], a[124:127], a[28:31], v[28:31]
  ds_read_b64_tr_b16 a[116:117], v69 offset:32768
  v_mfma_f32_16x16x32_bf16 v[32:35], a[128:131], a[24:27], v[32:35]
  ds_read_b64_tr_b16 a[118:119], v69 offset:36864
  v_mfma_f32_16x16x32_bf16 v[36:39], a[128:131], a[28:31], v[36:39]
  ds_read_b64_tr_b16 a[120:121], v70 offset:32768
  v_mfma_f32_16x16x32_bf16 v[40:43], a[132:135], a[24:27], v[40:43]
  buffer_load_dwordx4 a[68:71], v64, s[12:15], s30 offen offset:1024 sc1
  ds_read_b64_tr_b16 a[122:123], v70 offset:36864
  v_mfma_f32_16x16x32_bf16 v[44:47], a[132:135], a[28:31], v[44:47]
  ds_read_b64_tr_b16 a[124:125], v71 offset:32768
  v_mfma_f32_16x16x32_bf16 v[48:51], a[136:139], a[24:27], v[48:51]
  ds_read_b64_tr_b16 a[126:127], v71 offset:36864
  v_mfma_f32_16x16x32_bf16 v[52:55], a[136:139], a[28:31], v[52:55]
  ds_read_b64_tr_b16 a[128:129], v72 offset:32768
  v_mfma_f32_16x16x32_bf16 v[56:59], a[140:143], a[24:27], v[56:59]
  buffer_load_dwordx4 v125, s[8:11], s29 offen offset:1024 lds
  ds_read_b64_tr_b16 a[130:131], v72 offset:36864
  v_mfma_f32_16x16x32_bf16 v[60:63], a[140:143], a[28:31], v[60:63]
  ds_read_b64_tr_b16 a[132:133], v73 offset:32768
  s_waitcnt vmcnt(14) lgkmcnt(7)
  v_mfma_f32_16x16x32_bf16 v[0:3], a[112:115], a[32:35], v[0:3]
  ds_read_b64_tr_b16 a[134:135], v73 offset:36864
  v_mfma_f32_16x16x32_bf16 v[4:7], a[112:115], a[36:39], v[4:7]
  s_add_u32 s30, s26, 36864
  ds_read_b64_tr_b16 a[136:137], v74 offset:32768
  v_mfma_f32_16x16x32_bf16 v[8:11], a[116:119], a[32:35], v[8:11]
  buffer_load_dwordx4 a[72:75], v64, s[12:15], s30 offen offset:0 sc1
  ds_read_b64_tr_b16 a[138:139], v74 offset:36864
  v_mfma_f32_16x16x32_bf16 v[12:15], a[116:119], a[36:39], v[12:15]
  ds_read_b64_tr_b16 a[140:141], v75 offset:32768
  s_waitcnt lgkmcnt(7)
  v_mfma_f32_16x16x32_bf16 v[16:19], a[120:123], a[32:35], v[16:19]
  ds_read_b64_tr_b16 a[142:143], v75 offset:36864
  v_mfma_f32_16x16x32_bf16 v[20:23], a[120:123], a[36:39], v[20:23]
  ds_read_b64_tr_b16 a[112:113], v68 offset:40960
  v_mfma_f32_16x16x32_bf16 v[24:27], a[124:127], a[32:35], v[24:27]
  buffer_load_dwordx4 v126, s[8:11], s29 offen offset:2048 lds
  ds_read_b64_tr_b16 a[114:115], v68 offset:45056
  v_mfma_f32_16x16x32_bf16 v[28:31], a[124:127], a[36:39], v[28:31]
  ds_read_b64_tr_b16 a[116:117], v69 offset:40960
  s_waitcnt lgkmcnt(7)
  v_mfma_f32_16x16x32_bf16 v[32:35], a[128:131], a[32:35], v[32:35]
  ds_read_b64_tr_b16 a[118:119], v69 offset:45056
  v_mfma_f32_16x16x32_bf16 v[36:39], a[128:131], a[36:39], v[36:39]
  ds_read_b64_tr_b16 a[120:121], v70 offset:40960
  v_mfma_f32_16x16x32_bf16 v[40:43], a[132:135], a[32:35], v[40:43]
  buffer_load_dwordx4 a[76:79], v64, s[12:15], s30 offen offset:1024 sc1
  ds_read_b64_tr_b16 a[122:123], v70 offset:45056
  v_mfma_f32_16x16x32_bf16 v[44:47], a[132:135], a[36:39], v[44:47]
  ds_read_b64_tr_b16 a[124:125], v71 offset:40960
  s_waitcnt lgkmcnt(7)
  v_mfma_f32_16x16x32_bf16 v[48:51], a[136:139], a[32:35], v[48:51]
  ds_read_b64_tr_b16 a[126:127], v71 offset:45056
  v_mfma_f32_16x16x32_bf16 v[52:55], a[136:139], a[36:39], v[52:55]
  ds_read_b64_tr_b16 a[128:129], v72 offset:40960
  v_mfma_f32_16x16x32_bf16 v[56:59], a[140:143], a[32:35], v[56:59]
  buffer_load_dwordx4 v127, s[8:11], s29 offen offset:3072 lds
  ds_read_b64_tr_b16 a[130:131], v72 offset:45056
  v_mfma_f32_16x16x32_bf16 v[60:63], a[140:143], a[36:39], v[60:63]
  ds_read_b64_tr_b16 a[132:133], v73 offset:40960
  s_waitcnt vmcnt(16) lgkmcnt(7)
  v_mfma_f32_16x16x32_bf16 v[0:3], a[112:115], a[40:43], v[0:3]
  ds_read_b64_tr_b16 a[134:135], v73 offset:45056
  v_mfma_f32_16x16x32_bf16 v[4:7], a[112:115], a[44:47], v[4:7]
  s_add_u32 s30, s26, 40960
  ds_read_b64_tr_b16 a[136:137], v74 offset:40960
  v_mfma_f32_16x16x32_bf16 v[8:11], a[116:119], a[40:43], v[8:11]
  buffer_load_dwordx4 a[80:83], v64, s[12:15], s30 offen offset:0 sc1
  ds_read_b64_tr_b16 a[138:139], v74 offset:45056
  v_mfma_f32_16x16x32_bf16 v[12:15], a[116:119], a[44:47], v[12:15]
  ds_read_b64_tr_b16 a[140:141], v75 offset:40960
  s_waitcnt lgkmcnt(7)
  v_mfma_f32_16x16x32_bf16 v[16:19], a[120:123], a[40:43], v[16:19]
  ds_read_b64_tr_b16 a[142:143], v75 offset:45056
  v_mfma_f32_16x16x32_bf16 v[20:23], a[120:123], a[44:47], v[20:23]
  s_waitcnt lgkmcnt(0)
  s_barrier
  s_add_u32 m0, s24, 32768
  s_add_u32 s29, s25, 1179648
  ds_read_b64_tr_b16 a[112:113], v68 offset:49152
  v_mfma_f32_16x16x32_bf16 v[24:27], a[124:127], a[40:43], v[24:27]
  buffer_load_dwordx4 v124, s[8:11], s29 offen offset:0 lds
  ds_read_b64_tr_b16 a[114:115], v68 offset:53248
  v_mfma_f32_16x16x32_bf16 v[28:31], a[124:127], a[44:47], v[28:31]
  ds_read_b64_tr_b16 a[116:117], v69 offset:49152
  v_mfma_f32_16x16x32_bf16 v[32:35], a[128:131], a[40:43], v[32:35]
  ds_read_b64_tr_b16 a[118:119], v69 offset:53248
  v_mfma_f32_16x16x32_bf16 v[36:39], a[128:131], a[44:47], v[36:39]
  ds_read_b64_tr_b16 a[120:121], v70 offset:49152
  v_mfma_f32_16x16x32_bf16 v[40:43], a[132:135], a[40:43], v[40:43]
  buffer_load_dwordx4 a[84:87], v64, s[12:15], s30 offen offset:1024 sc1
  ds_read_b64_tr_b16 a[122:123], v70 offset:53248
  v_mfma_f32_16x16x32_bf16 v[44:47], a[132:135], a[44:47], v[44:47]
  ds_read_b64_tr_b16 a[124:125], v71 offset:49152
  v_mfma_f32_16x16x32_bf16 v[48:51], a[136:139], a[40:43], v[48:51]
  ds_read_b64_tr_b16 a[126:127], v71 offset:53248
  v_mfma_f32_16x16x32_bf16 v[52:55], a[136:139], a[44:47], v[52:55]
  ds_read_b64_tr_b16 a[128:129], v72 offset:49152
  v_mfma_f32_16x16x32_bf16 v[56:59], a[140:143], a[40:43], v[56:59]
  buffer_load_dwordx4 v125, s[8:11], s29 offen offset:1024 lds
  ds_read_b64_tr_b16 a[130:131], v72 offset:53248
  v_mfma_f32_16x16x32_bf16 v[60:63], a[140:143], a[44:47], v[60:63]
  ds_read_b64_tr_b16 a[132:133], v73 offset:49152
  s_waitcnt vmcnt(17) lgkmcnt(7)
  v_mfma_f32_16x16x32_bf16 v[0:3], a[112:115], a[48:51], v[0:3]
  ds_read_b64_tr_b16 a[134:135], v73 offset:53248
  v_mfma_f32_16x16x32_bf16 v[4:7], a[112:115], a[52:55], v[4:7]
  s_add_u32 s30, s26, 45056
  ds_read_b64_tr_b16 a[136:137], v74 offset:49152
  v_mfma_f32_16x16x32_bf16 v[8:11], a[116:119], a[48:51], v[8:11]
  buffer_load_dwordx4 a[88:91], v64, s[12:15], s30 offen offset:0 sc1
  ds_read_b64_tr_b16 a[138:139], v74 offset:53248
  v_mfma_f32_16x16x32_bf16 v[12:15], a[116:119], a[52:55], v[12:15]
  ds_read_b64_tr_b16 a[140:141], v75 offset:49152
  s_waitcnt lgkmcnt(7)
  v_mfma_f32_16x16x32_bf16 v[16:19], a[120:123], a[48:51], v[16:19]
  ds_read_b64_tr_b16 a[142:143], v75 offset:53248
  v_mfma_f32_16x16x32_bf16 v[20:23], a[120:123], a[52:55], v[20:23]
  ds_read_b64_tr_b16 a[112:113], v68 offset:57344
  v_mfma_f32_16x16x32_bf16 v[24:27], a[124:127], a[48:51], v[24:27]
  buffer_load_dwordx4 v126, s[8:11], s29 offen offset:2048 lds
  ds_read_b64_tr_b16 a[114:115], v68 offset:61440
  v_mfma_f32_16x16x32_bf16 v[28:31], a[124:127], a[52:55], v[28:31]
  ds_read_b64_tr_b16 a[116:117], v69 offset:57344
  s_waitcnt lgkmcnt(7)
  v_mfma_f32_16x16x32_bf16 v[32:35], a[128:131], a[48:51], v[32:35]
  ds_read_b64_tr_b16 a[118:119], v69 offset:61440
  v_mfma_f32_16x16x32_bf16 v[36:39], a[128:131], a[52:55], v[36:39]
  ds_read_b64_tr_b16 a[120:121], v70 offset:57344
  v_mfma_f32_16x16x32_bf16 v[40:43], a[132:135], a[48:51], v[40:43]
  buffer_load_dwordx4 a[92:95], v64, s[12:15], s30 offen offset:1024 sc1
  ds_read_b64_tr_b16 a[122:123], v70 offset:61440
  v_mfma_f32_16x16x32_bf16 v[44:47], a[132:135], a[52:55], v[44:47]
  ds_read_b64_tr_b16 a[124:125], v71 offset:57344
  s_waitcnt lgkmcnt(7)
  v_mfma_f32_16x16x32_bf16 v[48:51], a[136:139], a[48:51], v[48:51]
  ds_read_b64_tr_b16 a[126:127], v71 offset:61440
  v_mfma_f32_16x16x32_bf16 v[52:55], a[136:139], a[52:55], v[52:55]
  ds_read_b64_tr_b16 a[128:129], v72 offset:57344
  v_mfma_f32_16x16x32_bf16 v[56:59], a[140:143], a[48:51], v[56:59]
  buffer_load_dwordx4 v127, s[8:11], s29 offen offset:3072 lds
  ds_read_b64_tr_b16 a[130:131], v72 offset:61440
  v_mfma_f32_16x16x32_bf16 v[60:63], a[140:143], a[52:55], v[60:63]
  ds_read_b64_tr_b16 a[132:133], v73 offset:57344
  s_waitcnt vmcnt(17) lgkmcnt(7)
  v_mfma_f32_16x16x32_bf16 v[0:3], a[112:115], a[56:59], v[0:3]
  ds_read_b64_tr_b16 a[134:135], v73 offset:61440
  v_mfma_f32_16x16x32_bf16 v[4:7], a[112:115], a[60:63], v[4:7]
  s_add_u32 s30, s26, 49152
  ds_read_b64_tr_b16 a[136:137], v74 offset:57344
  v_mfma_f32_16x16x32_bf16 v[8:11], a[116:119], a[56:59], v[8:11]
  buffer_load_dwordx4 a[96:99], v64, s[12:15], s30 offen offset:0 sc1
  ds_read_b64_tr_b16 a[138:139], v74 offset:61440
  v_mfma_f32_16x16x32_bf16 v[12:15], a[116:119], a[60:63], v[12:15]
  ds_read_b64_tr_b16 a[140:141], v75 offset:57344
  s_waitcnt lgkmcnt(7)
  v_mfma_f32_16x16x32_bf16 v[16:19], a[120:123], a[56:59], v[16:19]
  ds_read_b64_tr_b16 a[142:143], v75 offset:61440
  v_mfma_f32_16x16x32_bf16 v[20:23], a[120:123], a[60:63], v[20:23]
  s_waitcnt lgkmcnt(0)
  s_barrier
  s_add_u32 m0, s24, 49152
  s_add_u32 s29, s25, 1310720
  ds_read_b64_tr_b16 a[112:113], v76 offset:0
  v_mfma_f32_16x16x32_bf16 v[24:27], a[124:127], a[56:59], v[24:27]
  buffer_load_dwordx4 v124, s[8:11], s29 offen offset:0 lds
  ds_read_b64_tr_b16 a[114:115], v76 offset:4096
  v_mfma_f32_16x16x32_bf16 v[28:31], a[124:127], a[60:63], v[28:31]
  ds_read_b64_tr_b16 a[116:117], v77 offset:0
  v_mfma_f32_16x16x32_bf16 v[32:35], a[128:131], a[56:59], v[32:35]
  ds_read_b64_tr_b16 a[118:119], v77 offset:4096
  v_mfma_f32_16x16x32_bf16 v[36:39], a[128:131], a[60:63], v[36:39]
  ds_read_b64_tr_b16 a[120:121], v78 offset:0
  v_mfma_f32_16x16x32_bf16 v[40:43], a[132:135], a[56:59], v[40:43]
  buffer_load_dwordx4 a[100:103], v64, s[12:15], s30 offen offset:1024 sc1
  ds_read_b64_tr_b16 a[122:123], v78 offset:4096
  v_mfma_f32_16x16x32_bf16 v[44:47], a[132:135], a[60:63], v[44:47]
  ds_read_b64_tr_b16 a[124:125], v79 offset:0
  v_mfma_f32_16x16x32_bf16 v[48:51], a[136:139], a[56:59], v[48:51]
  ds_read_b64_tr_b16 a[126:127], v79 offset:4096
  v_mfma_f32_16x16x32_bf16 v[52:55], a[136:139], a[60:63], v[52:55]
  ds_read_b64_tr_b16 a[128:129], v80 offset:0
  v_mfma_f32_16x16x32_bf16 v[56:59], a[140:143], a[56:59], v[56:59]
  buffer_load_dwordx4 v125, s[8:11], s29 offen offset:1024 lds
  ds_read_b64_tr_b16 a[130:131], v80 offset:4096
  v_mfma_f32_16x16x32_bf16 v[60:63], a[140:143], a[60:63], v[60:63]
  ds_read_b64_tr_b16 a[132:133], v81 offset:0
  s_waitcnt vmcnt(17) lgkmcnt(7)
  v_mfma_f32_16x16x32_bf16 v[0:3], a[112:115], a[64:67], v[0:3]
  ds_read_b64_tr_b16 a[134:135], v81 offset:4096
  v_mfma_f32_16x16x32_bf16 v[4:7], a[112:115], a[68:71], v[4:7]
  s_add_u32 s30, s26, 53248
  ds_read_b64_tr_b16 a[136:137], v82 offset:0
  v_mfma_f32_16x16x32_bf16 v[8:11], a[116:119], a[64:67], v[8:11]
  buffer_load_dwordx4 a[104:107], v64, s[12:15], s30 offen offset:0 sc1
  ds_read_b64_tr_b16 a[138:139], v82 offset:4096
  v_mfma_f32_16x16x32_bf16 v[12:15], a[116:119], a[68:71], v[12:15]
  ds_read_b64_tr_b16 a[140:141], v83 offset:0
  s_waitcnt lgkmcnt(7)
  v_mfma_f32_16x16x32_bf16 v[16:19], a[120:123], a[64:67], v[16:19]
  ds_read_b64_tr_b16 a[142:143], v83 offset:4096
  v_mfma_f32_16x16x32_bf16 v[20:23], a[120:123], a[68:71], v[20:23]
  ds_read_b64_tr_b16 a[112:113], v76 offset:8192
  v_mfma_f32_16x16x32_bf16 v[24:27], a[124:127], a[64:67], v[24:27]
  buffer_load_dwordx4 v126, s[8:11], s29 offen offset:2048 lds
  ds_read_b64_tr_b16 a[114:115], v76 offset:12288
  v_mfma_f32_16x16x32_bf16 v[28:31], a[124:127], a[68:71], v[28:31]
  ds_read_b64_tr_b16 a[116:117], v77 offset:8192
  s_waitcnt lgkmcnt(7)
  v_mfma_f32_16x16x32_bf16 v[32:35], a[128:131], a[64:67], v[32:35]
  ds_read_b64_tr_b16 a[118:119], v77 offset:12288
  v_mfma_f32_16x16x32_bf16 v[36:39], a[128:131], a[68:71], v[36:39]
  ds_read_b64_tr_b16 a[120:121], v78 offset:8192
  v_mfma_f32_16x16x32_bf16 v[40:43], a[132:135], a[64:67], v[40:43]
  buffer_load_dwordx4 a[108:111], v64, s[12:15], s30 offen offset:1024 sc1
  ds_read_b64_tr_b16 a[122:123], v78 offset:12288
  v_mfma_f32_16x16x32_bf16 v[44:47], a[132:135], a[68:71], v[44:47]
  ds_read_b64_tr_b16 a[124:125], v79 offset:8192
  s_waitcnt lgkmcnt(7)
  v_mfma_f32_16x16x32_bf16 v[48:51], a[136:139], a[64:67], v[48:51]
  ds_read_b64_tr_b16 a[126:127], v79 offset:12288
  v_mfma_f32_16x16x32_bf16 v[52:55], a[136:139], a[68:71], v[52:55]
  ds_read_b64_tr_b16 a[128:129], v80 offset:8192
  v_mfma_f32_16x16x32_bf16 v[56:59], a[140:143], a[64:67], v[56:59]
  buffer_load_dwordx4 v127, s[8:11], s29 offen offset:3072 lds
  ds_read_b64_tr_b16 a[130:131], v80 offset:12288
  v_mfma_f32_16x16x32_bf16 v[60:63], a[140:143], a[68:71], v[60:63]
  ds_read_b64_tr_b16 a[132:133], v81 offset:8192
  s_waitcnt vmcnt(17) lgkmcnt(7)
  v_mfma_f32_16x16x32_bf16 v[0:3], a[112:115], a[72:75], v[0:3]
  ds_read_b64_tr_b16 a[134:135], v81 offset:12288
  v_mfma_f32_16x16x32_bf16 v[4:7], a[112:115], a[76:79], v[4:7]
  s_add_u32 s30, s26, 57344
  ds_read_b64_tr_b16 a[136:137], v82 offset:8192
  v_mfma_f32_16x16x32_bf16 v[8:11], a[116:119], a[72:75], v[8:11]
  buffer_load_dwordx4 a[0:3], v64, s[12:15], s30 offen offset:0 sc1
  ds_read_b64_tr_b16 a[138:139], v82 offset:12288
  v_mfma_f32_16x16x32_bf16 v[12:15], a[116:119], a[76:79], v[12:15]
  ds_read_b64_tr_b16 a[140:141], v83 offset:8192
  s_waitcnt lgkmcnt(7)
  v_mfma_f32_16x16x32_bf16 v[16:19], a[120:123], a[72:75], v[16:19]
  ds_read_b64_tr_b16 a[142:143], v83 offset:12288
  v_mfma_f32_16x16x32_bf16 v[20:23], a[120:123], a[76:79], v[20:23]
  s_waitcnt lgkmcnt(0)
  s_barrier
  s_add_u32 m0, s24, 65536
  s_add_u32 s29, s25, 1441792
  ds_read_b64_tr_b16 a[112:113], v76 offset:16384
  v_mfma_f32_16x16x32_bf16 v[24:27], a[124:127], a[72:75], v[24:27]
  buffer_load_dwordx4 v124, s[8:11], s29 offen offset:0 lds
  ds_read_b64_tr_b16 a[114:115], v76 offset:20480
  v_mfma_f32_16x16x32_bf16 v[28:31], a[124:127], a[76:79], v[28:31]
  ds_read_b64_tr_b16 a[116:117], v77 offset:16384
  v_mfma_f32_16x16x32_bf16 v[32:35], a[128:131], a[72:75], v[32:35]
  ds_read_b64_tr_b16 a[118:119], v77 offset:20480
  v_mfma_f32_16x16x32_bf16 v[36:39], a[128:131], a[76:79], v[36:39]
  ds_read_b64_tr_b16 a[120:121], v78 offset:16384
  v_mfma_f32_16x16x32_bf16 v[40:43], a[132:135], a[72:75], v[40:43]
  buffer_load_dwordx4 a[4:7], v64, s[12:15], s30 offen offset:1024 sc1
  ds_read_b64_tr_b16 a[122:123], v78 offset:20480
  v_mfma_f32_16x16x32_bf16 v[44:47], a[132:135], a[76:79], v[44:47]
  ds_read_b64_tr_b16 a[124:125], v79 offset:16384
  v_mfma_f32_16x16x32_bf16 v[48:51], a[136:139], a[72:75], v[48:51]
  ds_read_b64_tr_b16 a[126:127], v79 offset:20480
  v_mfma_f32_16x16x32_bf16 v[52:55], a[136:139], a[76:79], v[52:55]
  ds_read_b64_tr_b16 a[128:129], v80 offset:16384
  v_mfma_f32_16x16x32_bf16 v[56:59], a[140:143], a[72:75], v[56:59]
  buffer_load_dwordx4 v125, s[8:11], s29 offen offset:1024 lds
  ds_read_b64_tr_b16 a[130:131], v80 offset:20480
  v_mfma_f32_16x16x32_bf16 v[60:63], a[140:143], a[76:79], v[60:63]
  ds_read_b64_tr_b16 a[132:133], v81 offset:16384
  s_waitcnt vmcnt(17) lgkmcnt(7)
  v_mfma_f32_16x16x32_bf16 v[0:3], a[112:115], a[80:83], v[0:3]
  ds_read_b64_tr_b16 a[134:135], v81 offset:20480
  v_mfma_f32_16x16x32_bf16 v[4:7], a[112:115], a[84:87], v[4:7]
  s_add_u32 s30, s26, 61440
  ds_read_b64_tr_b16 a[136:137], v82 offset:16384
  v_mfma_f32_16x16x32_bf16 v[8:11], a[116:119], a[80:83], v[8:11]
  buffer_load_dwordx4 a[8:11], v64, s[12:15], s30 offen offset:0 sc1
  ds_read_b64_tr_b16 a[138:139], v82 offset:20480
  v_mfma_f32_16x16x32_bf16 v[12:15], a[116:119], a[84:87], v[12:15]
  ds_read_b64_tr_b16 a[140:141], v83 offset:16384
  s_waitcnt lgkmcnt(7)
  v_mfma_f32_16x16x32_bf16 v[16:19], a[120:123], a[80:83], v[16:19]
  ds_read_b64_tr_b16 a[142:143], v83 offset:20480
  v_mfma_f32_16x16x32_bf16 v[20:23], a[120:123], a[84:87], v[20:23]
  ds_read_b64_tr_b16 a[112:113], v76 offset:24576
  v_mfma_f32_16x16x32_bf16 v[24:27], a[124:127], a[80:83], v[24:27]
  buffer_load_dwordx4 v126, s[8:11], s29 offen offset:2048 lds
  ds_read_b64_tr_b16 a[114:115], v76 offset:28672
  v_mfma_f32_16x16x32_bf16 v[28:31], a[124:127], a[84:87], v[28:31]
  ds_read_b64_tr_b16 a[116:117], v77 offset:24576
  s_waitcnt lgkmcnt(7)
  v_mfma_f32_16x16x32_bf16 v[32:35], a[128:131], a[80:83], v[32:35]
  ds_read_b64_tr_b16 a[118:119], v77 offset:28672
  v_mfma_f32_16x16x32_bf16 v[36:39], a[128:131], a[84:87], v[36:39]
  ds_read_b64_tr_b16 a[120:121], v78 offset:24576
  v_mfma_f32_16x16x32_bf16 v[40:43], a[132:135], a[80:83], v[40:43]
  buffer_load_dwordx4 a[12:15], v64, s[12:15], s30 offen offset:1024 sc1
  ds_read_b64_tr_b16 a[122:123], v78 offset:28672
  v_mfma_f32_16x16x32_bf16 v[44:47], a[132:135], a[84:87], v[44:47]
  ds_read_b64_tr_b16 a[124:125], v79 offset:24576
  s_waitcnt lgkmcnt(7)
  v_mfma_f32_16x16x32_bf16 v[48:51], a[136:139], a[80:83], v[48:51]
  ds_read_b64_tr_b16 a[126:127], v79 offset:28672
  v_mfma_f32_16x16x32_bf16 v[52:55], a[136:139], a[84:87], v[52:55]
  ds_read_b64_tr_b16 a[128:129], v80 offset:24576
  v_mfma_f32_16x16x32_bf16 v[56:59], a[140:143], a[80:83], v[56:59]
  buffer_load_dwordx4 v127, s[8:11], s29 offen offset:3072 lds
  ds_read_b64_tr_b16 a[130:131], v80 offset:28672
  v_mfma_f32_16x16x32_bf16 v[60:63], a[140:143], a[84:87], v[60:63]
  ds_read_b64_tr_b16 a[132:133], v81 offset:24576
  s_waitcnt vmcnt(17) lgkmcnt(7)
  v_mfma_f32_16x16x32_bf16 v[0:3], a[112:115], a[88:91], v[0:3]
  ds_read_b64_tr_b16 a[134:135], v81 offset:28672
  v_mfma_f32_16x16x32_bf16 v[4:7], a[112:115], a[92:95], v[4:7]
  s_add_u32 s30, s26, 65536
  ds_read_b64_tr_b16 a[136:137], v82 offset:24576
  v_mfma_f32_16x16x32_bf16 v[8:11], a[116:119], a[88:91], v[8:11]
  buffer_load_dwordx4 a[16:19], v64, s[12:15], s30 offen offset:0 sc1
  ds_read_b64_tr_b16 a[138:139], v82 offset:28672
  v_mfma_f32_16x16x32_bf16 v[12:15], a[116:119], a[92:95], v[12:15]
  ds_read_b64_tr_b16 a[140:141], v83 offset:24576
  s_waitcnt lgkmcnt(7)
  v_mfma_f32_16x16x32_bf16 v[16:19], a[120:123], a[88:91], v[16:19]
  ds_read_b64_tr_b16 a[142:143], v83 offset:28672
  v_mfma_f32_16x16x32_bf16 v[20:23], a[120:123], a[92:95], v[20:23]
  s_waitcnt lgkmcnt(0)
  s_barrier
  s_add_u32 m0, s24, 81920
  s_add_u32 s29, s25, 1572864
  ds_read_b64_tr_b16 a[112:113], v76 offset:32768
  v_mfma_f32_16x16x32_bf16 v[24:27], a[124:127], a[88:91], v[24:27]
  buffer_load_dwordx4 v124, s[8:11], s29 offen offset:0 lds
  ds_read_b64_tr_b16 a[114:115], v76 offset:36864
  v_mfma_f32_16x16x32_bf16 v[28:31], a[124:127], a[92:95], v[28:31]
  ds_read_b64_tr_b16 a[116:117], v77 offset:32768
  v_mfma_f32_16x16x32_bf16 v[32:35], a[128:131], a[88:91], v[32:35]
  ds_read_b64_tr_b16 a[118:119], v77 offset:36864
  v_mfma_f32_16x16x32_bf16 v[36:39], a[128:131], a[92:95], v[36:39]
  ds_read_b64_tr_b16 a[120:121], v78 offset:32768
  v_mfma_f32_16x16x32_bf16 v[40:43], a[132:135], a[88:91], v[40:43]
  buffer_load_dwordx4 a[20:23], v64, s[12:15], s30 offen offset:1024 sc1
  ds_read_b64_tr_b16 a[122:123], v78 offset:36864
  v_mfma_f32_16x16x32_bf16 v[44:47], a[132:135], a[92:95], v[44:47]
  ds_read_b64_tr_b16 a[124:125], v79 offset:32768
  v_mfma_f32_16x16x32_bf16 v[48:51], a[136:139], a[88:91], v[48:51]
  ds_read_b64_tr_b16 a[126:127], v79 offset:36864
  v_mfma_f32_16x16x32_bf16 v[52:55], a[136:139], a[92:95], v[52:55]
  ds_read_b64_tr_b16 a[128:129], v80 offset:32768
  v_mfma_f32_16x16x32_bf16 v[56:59], a[140:143], a[88:91], v[56:59]
  buffer_load_dwordx4 v125, s[8:11], s29 offen offset:1024 lds
  ds_read_b64_tr_b16 a[130:131], v80 offset:36864
  v_mfma_f32_16x16x32_bf16 v[60:63], a[140:143], a[92:95], v[60:63]
  ds_read_b64_tr_b16 a[132:133], v81 offset:32768
  s_waitcnt vmcnt(17) lgkmcnt(7)
  v_mfma_f32_16x16x32_bf16 v[0:3], a[112:115], a[96:99], v[0:3]
  ds_read_b64_tr_b16 a[134:135], v81 offset:36864
  v_mfma_f32_16x16x32_bf16 v[4:7], a[112:115], a[100:103], v[4:7]
  s_add_u32 s30, s26, 69632
  ds_read_b64_tr_b16 a[136:137], v82 offset:32768
  v_mfma_f32_16x16x32_bf16 v[8:11], a[116:119], a[96:99], v[8:11]
  buffer_load_dwordx4 a[24:27], v64, s[12:15], s30 offen offset:0 sc1
  ds_read_b64_tr_b16 a[138:139], v82 offset:36864
  v_mfma_f32_16x16x32_bf16 v[12:15], a[116:119], a[100:103], v[12:15]
  ds_read_b64_tr_b16 a[140:141], v83 offset:32768
  s_waitcnt lgkmcnt(7)
  v_mfma_f32_16x16x32_bf16 v[16:19], a[120:123], a[96:99], v[16:19]
  ds_read_b64_tr_b16 a[142:143], v83 offset:36864
  v_mfma_f32_16x16x32_bf16 v[20:23], a[120:123], a[100:103], v[20:23]
  ds_read_b64_tr_b16 a[112:113], v76 offset:40960
  v_mfma_f32_16x16x32_bf16 v[24:27], a[124:127], a[96:99], v[24:27]
  buffer_load_dwordx4 v126, s[8:11], s29 offen offset:2048 lds
  ds_read_b64_tr_b16 a[114:115], v76 offset:45056
  v_mfma_f32_16x16x32_bf16 v[28:31], a[124:127], a[100:103], v[28:31]
  ds_read_b64_tr_b16 a[116:117], v77 offset:40960
  s_waitcnt lgkmcnt(7)
  v_mfma_f32_16x16x32_bf16 v[32:35], a[128:131], a[96:99], v[32:35]
  ds_read_b64_tr_b16 a[118:119], v77 offset:45056
  v_mfma_f32_16x16x32_bf16 v[36:39], a[128:131], a[100:103], v[36:39]
  ds_read_b64_tr_b16 a[120:121], v78 offset:40960
  v_mfma_f32_16x16x32_bf16 v[40:43], a[132:135], a[96:99], v[40:43]
  buffer_load_dwordx4 a[28:31], v64, s[12:15], s30 offen offset:1024 sc1
  ds_read_b64_tr_b16 a[122:123], v78 offset:45056
  v_mfma_f32_16x16x32_bf16 v[44:47], a[132:135], a[100:103], v[44:47]
  ds_read_b64_tr_b16 a[124:125], v79 offset:40960
  s_waitcnt lgkmcnt(7)
  v_mfma_f32_16x16x32_bf16 v[48:51], a[136:139], a[96:99], v[48:51]
  ds_read_b64_tr_b16 a[126:127], v79 offset:45056
  v_mfma_f32_16x16x32_bf16 v[52:55], a[136:139], a[100:103], v[52:55]
  ds_read_b64_tr_b16 a[128:129], v80 offset:40960
  v_mfma_f32_16x16x32_bf16 v[56:59], a[140:143], a[96:99], v[56:59]
  buffer_load_dwordx4 v127, s[8:11], s29 offen offset:3072 lds
  ds_read_b64_tr_b16 a[130:131], v80 offset:45056
  v_mfma_f32_16x16x32_bf16 v[60:63], a[140:143], a[100:103], v[60:63]
  ds_read_b64_tr_b16 a[132:133], v81 offset:40960
  s_waitcnt vmcnt(17) lgkmcnt(7)
  v_mfma_f32_16x16x32_bf16 v[0:3], a[112:115], a[104:107], v[0:3]
  ds_read_b64_tr_b16 a[134:135], v81 offset:45056
  v_mfma_f32_16x16x32_bf16 v[4:7], a[112:115], a[108:111], v[4:7]
  s_add_u32 s30, s26, 73728
  ds_read_b64_tr_b16 a[136:137], v82 offset:40960
  v_mfma_f32_16x16x32_bf16 v[8:11], a[116:119], a[104:107], v[8:11]
  buffer_load_dwordx4 a[32:35], v64, s[12:15], s30 offen offset:0 sc1
  ds_read_b64_tr_b16 a[138:139], v82 offset:45056
  v_mfma_f32_16x16x32_bf16 v[12:15], a[116:119], a[108:111], v[12:15]
  ds_read_b64_tr_b16 a[140:141], v83 offset:40960
  s_waitcnt lgkmcnt(7)
  v_mfma_f32_16x16x32_bf16 v[16:19], a[120:123], a[104:107], v[16:19]
  ds_read_b64_tr_b16 a[142:143], v83 offset:45056
  v_mfma_f32_16x16x32_bf16 v[20:23], a[120:123], a[108:111], v[20:23]
  s_waitcnt lgkmcnt(0)
  s_barrier
  s_add_u32 m0, s24, 98304
  s_add_u32 s29, s25, 1703936
  ds_read_b64_tr_b16 a[112:113], v68 offset:0
  v_mfma_f32_16x16x32_bf16 v[24:27], a[124:127], a[104:107], v[24:27]
  buffer_load_dwordx4 v124, s[8:11], s29 offen offset:0 lds
  ds_read_b64_tr_b16 a[114:115], v68 offset:4096
  v_mfma_f32_16x16x32_bf16 v[28:31], a[124:127], a[108:111], v[28:31]
  ds_read_b64_tr_b16 a[116:117], v69 offset:0
  v_mfma_f32_16x16x32_bf16 v[32:35], a[128:131], a[104:107], v[32:35]
  ds_read_b64_tr_b16 a[118:119], v69 offset:4096
  v_mfma_f32_16x16x32_bf16 v[36:39], a[128:131], a[108:111], v[36:39]
  ds_read_b64_tr_b16 a[120:121], v70 offset:0
  v_mfma_f32_16x16x32_bf16 v[40:43], a[132:135], a[104:107], v[40:43]
  buffer_load_dwordx4 a[36:39], v64, s[12:15], s30 offen offset:1024 sc1
  ds_read_b64_tr_b16 a[122:123], v70 offset:4096
  v_mfma_f32_16x16x32_bf16 v[44:47], a[132:135], a[108:111], v[44:47]
  ds_read_b64_tr_b16 a[124:125], v71 offset:0
  v_mfma_f32_16x16x32_bf16 v[48:51], a[136:139], a[104:107], v[48:51]
  ds_read_b64_tr_b16 a[126:127], v71 offset:4096
  v_mfma_f32_16x16x32_bf16 v[52:55], a[136:139], a[108:111], v[52:55]
  ds_read_b64_tr_b16 a[128:129], v72 offset:0
  v_mfma_f32_16x16x32_bf16 v[56:59], a[140:143], a[104:107], v[56:59]
  buffer_load_dwordx4 v125, s[8:11], s29 offen offset:1024 lds
  ds_read_b64_tr_b16 a[130:131], v72 offset:4096
  v_mfma_f32_16x16x32_bf16 v[60:63], a[140:143], a[108:111], v[60:63]
  ds_read_b64_tr_b16 a[132:133], v73 offset:0
  s_waitcnt vmcnt(17) lgkmcnt(7)
  v_mfma_f32_16x16x32_bf16 v[0:3], a[112:115], a[0:3], v[0:3]
  ds_read_b64_tr_b16 a[134:135], v73 offset:4096
  v_mfma_f32_16x16x32_bf16 v[4:7], a[112:115], a[4:7], v[4:7]
  s_add_u32 s30, s26, 77824
  ds_read_b64_tr_b16 a[136:137], v74 offset:0
  v_mfma_f32_16x16x32_bf16 v[8:11], a[116:119], a[0:3], v[8:11]
  buffer_load_dwordx4 a[40:43], v64, s[12:15], s30 offen offset:0 sc1
  ds_read_b64_tr_b16 a[138:139], v74 offset:4096
  v_mfma_f32_16x16x32_bf16 v[12:15], a[116:119], a[4:7], v[12:15]
  ds_read_b64_tr_b16 a[140:141], v75 offset:0
  s_waitcnt lgkmcnt(7)
  v_mfma_f32_16x16x32_bf16 v[16:19], a[120:123], a[0:3], v[16:19]
  ds_read_b64_tr_b16 a[142:143], v75 offset:4096
  v_mfma_f32_16x16x32_bf16 v[20:23], a[120:123], a[4:7], v[20:23]
  ds_read_b64_tr_b16 a[112:113], v68 offset:8192
  v_mfma_f32_16x16x32_bf16 v[24:27], a[124:127], a[0:3], v[24:27]
  buffer_load_dwordx4 v126, s[8:11], s29 offen offset:2048 lds
  ds_read_b64_tr_b16 a[114:115], v68 offset:12288
  v_mfma_f32_16x16x32_bf16 v[28:31], a[124:127], a[4:7], v[28:31]
  ds_read_b64_tr_b16 a[116:117], v69 offset:8192
  s_waitcnt lgkmcnt(7)
  v_mfma_f32_16x16x32_bf16 v[32:35], a[128:131], a[0:3], v[32:35]
  ds_read_b64_tr_b16 a[118:119], v69 offset:12288
  v_mfma_f32_16x16x32_bf16 v[36:39], a[128:131], a[4:7], v[36:39]
  ds_read_b64_tr_b16 a[120:121], v70 offset:8192
  v_mfma_f32_16x16x32_bf16 v[40:43], a[132:135], a[0:3], v[40:43]
  buffer_load_dwordx4 a[44:47], v64, s[12:15], s30 offen offset:1024 sc1
  ds_read_b64_tr_b16 a[122:123], v70 offset:12288
  v_mfma_f32_16x16x32_bf16 v[44:47], a[132:135], a[4:7], v[44:47]
  ds_read_b64_tr_b16 a[124:125], v71 offset:8192
  s_waitcnt lgkmcnt(7)
  v_mfma_f32_16x16x32_bf16 v[48:51], a[136:139], a[0:3], v[48:51]
  ds_read_b64_tr_b16 a[126:127], v71 offset:12288
  v_mfma_f32_16x16x32_bf16 v[52:55], a[136:139], a[4:7], v[52:55]
  ds_read_b64_tr_b16 a[128:129], v72 offset:8192
  v_mfma_f32_16x16x32_bf16 v[56:59], a[140:143], a[0:3], v[56:59]
  buffer_load_dwordx4 v127, s[8:11], s29 offen offset:3072 lds
  ds_read_b64_tr_b16 a[130:131], v72 offset:12288
  v_mfma_f32_16x16x32_bf16 v[60:63], a[140:143], a[4:7], v[60:63]
  ds_read_b64_tr_b16 a[132:133], v73 offset:8192
  s_waitcnt vmcnt(17) lgkmcnt(7)
  v_mfma_f32_16x16x32_bf16 v[0:3], a[112:115], a[8:11], v[0:3]
  ds_read_b64_tr_b16 a[134:135], v73 offset:12288
  v_mfma_f32_16x16x32_bf16 v[4:7], a[112:115], a[12:15], v[4:7]
  s_add_u32 s30, s26, 81920
  ds_read_b64_tr_b16 a[136:137], v74 offset:8192
  v_mfma_f32_16x16x32_bf16 v[8:11], a[116:119], a[8:11], v[8:11]
  buffer_load_dwordx4 a[48:51], v64, s[12:15], s30 offen offset:0 sc1
  ds_read_b64_tr_b16 a[138:139], v74 offset:12288
  v_mfma_f32_16x16x32_bf16 v[12:15], a[116:119], a[12:15], v[12:15]
  ds_read_b64_tr_b16 a[140:141], v75 offset:8192
  s_waitcnt lgkmcnt(7)
  v_mfma_f32_16x16x32_bf16 v[16:19], a[120:123], a[8:11], v[16:19]
  ds_read_b64_tr_b16 a[142:143], v75 offset:12288
  v_mfma_f32_16x16x32_bf16 v[20:23], a[120:123], a[12:15], v[20:23]
  s_add_u32 s25, s25, 917504
  s_add_u32 s26, s26, 57344
  s_sub_u32 s27, s27, 1
  s_cmp_lg_u32 s27, 0
  s_cbranch_scc1 fa_kernel_g2loop
  s_waitcnt lgkmcnt(0)
  s_barrier
  ds_read_b64_tr_b16 a[112:113], v68 offset:16384
  v_mfma_f32_16x16x32_bf16 v[24:27], a[124:127], a[8:11], v[24:27]
  ds_read_b64_tr_b16 a[114:115], v68 offset:20480
  v_mfma_f32_16x16x32_bf16 v[28:31], a[124:127], a[12:15], v[28:31]
  ds_read_b64_tr_b16 a[116:117], v69 offset:16384
  v_mfma_f32_16x16x32_bf16 v[32:35], a[128:131], a[8:11], v[32:35]
  ds_read_b64_tr_b16 a[118:119], v69 offset:20480
  v_mfma_f32_16x16x32_bf16 v[36:39], a[128:131], a[12:15], v[36:39]
  ds_read_b64_tr_b16 a[120:121], v70 offset:16384
  v_mfma_f32_16x16x32_bf16 v[40:43], a[132:135], a[8:11], v[40:43]
  buffer_load_dwordx4 a[52:55], v64, s[12:15], s30 offen offset:1024 sc1
  ds_read_b64_tr_b16 a[122:123], v70 offset:20480
  v_mfma_f32_16x16x32_bf16 v[44:47], a[132:135], a[12:15], v[44:47]
  ds_read_b64_tr_b16 a[124:125], v71 offset:16384
  v_mfma_f32_16x16x32_bf16 v[48:51], a[136:139], a[8:11], v[48:51]
  ds_read_b64_tr_b16 a[126:127], v71 offset:20480
  v_mfma_f32_16x16x32_bf16 v[52:55], a[136:139], a[12:15], v[52:55]
  ds_read_b64_tr_b16 a[128:129], v72 offset:16384
  v_mfma_f32_16x16x32_bf16 v[56:59], a[140:143], a[8:11], v[56:59]
  ds_read_b64_tr_b16 a[130:131], v72 offset:20480
  v_mfma_f32_16x16x32_bf16 v[60:63], a[140:143], a[12:15], v[60:63]
  ds_read_b64_tr_b16 a[132:133], v73 offset:16384
  s_waitcnt vmcnt(15) lgkmcnt(7)
  v_mfma_f32_16x16x32_bf16 v[0:3], a[112:115], a[16:19], v[0:3]
  ds_read_b64_tr_b16 a[134:135], v73 offset:20480
  v_mfma_f32_16x16x32_bf16 v[4:7], a[112:115], a[20:23], v[4:7]
  s_add_u32 s30, s26, 28672
  ds_read_b64_tr_b16 a[136:137], v74 offset:16384
  v_mfma_f32_16x16x32_bf16 v[8:11], a[116:119], a[16:19], v[8:11]
  buffer_load_dwordx4 a[56:59], v64, s[12:15], s30 offen offset:0 sc1
  ds_read_b64_tr_b16 a[138:139], v74 offset:20480
  v_mfma_f32_16x16x32_bf16 v[12:15], a[116:119], a[20:23], v[12:15]
  ds_read_b64_tr_b16 a[140:141], v75 offset:16384
  s_waitcnt lgkmcnt(7)
  v_mfma_f32_16x16x32_bf16 v[16:19], a[120:123], a[16:19], v[16:19]
  ds_read_b64_tr_b16 a[142:143], v75 offset:20480
  v_mfma_f32_16x16x32_bf16 v[20:23], a[120:123], a[20:23], v[20:23]
  ds_read_b64_tr_b16 a[112:113], v68 offset:24576
  v_mfma_f32_16x16x32_bf16 v[24:27], a[124:127], a[16:19], v[24:27]
  ds_read_b64_tr_b16 a[114:115], v68 offset:28672
  v_mfma_f32_16x16x32_bf16 v[28:31], a[124:127], a[20:23], v[28:31]
  ds_read_b64_tr_b16 a[116:117], v69 offset:24576
  s_waitcnt lgkmcnt(7)
  v_mfma_f32_16x16x32_bf16 v[32:35], a[128:131], a[16:19], v[32:35]
  ds_read_b64_tr_b16 a[118:119], v69 offset:28672
  v_mfma_f32_16x16x32_bf16 v[36:39], a[128:131], a[20:23], v[36:39]
  ds_read_b64_tr_b16 a[120:121], v70 offset:24576
  v_mfma_f32_16x16x32_bf16 v[40:43], a[132:135], a[16:19], v[40:43]
  buffer_load_dwordx4 a[60:63], v64, s[12:15], s30 offen offset:1024 sc1
  ds_read_b64_tr_b16 a[122:123], v70 offset:28672
  v_mfma_f32_16x16x32_bf16 v[44:47], a[132:135], a[20:23], v[44:47]
  ds_read_b64_tr_b16 a[124:125], v71 offset:24576
  s_waitcnt lgkmcnt(7)
  v_mfma_f32_16x16x32_bf16 v[48:51], a[136:139], a[16:19], v[48:51]
  ds_read_b64_tr_b16 a[126:127], v71 offset:28672
  v_mfma_f32_16x16x32_bf16 v[52:55], a[136:139], a[20:23], v[52:55]
  ds_read_b64_tr_b16 a[128:129], v72 offset:24576
  v_mfma_f32_16x16x32_bf16 v[56:59], a[140:143], a[16:19], v[56:59]
  ds_read_b64_tr_b16 a[130:131], v72 offset:28672
  v_mfma_f32_16x16x32_bf16 v[60:63], a[140:143], a[20:23], v[60:63]
  ds_read_b64_tr_b16 a[132:133], v73 offset:24576
  s_waitcnt vmcnt(13) lgkmcnt(7)
  v_mfma_f32_16x16x32_bf16 v[0:3], a[112:115], a[24:27], v[0:3]
  ds_read_b64_tr_b16 a[134:135], v73 offset:28672
  v_mfma_f32_16x16x32_bf16 v[4:7], a[112:115], a[28:31], v[4:7]
  s_add_u32 s30, s26, 32768
  ds_read_b64_tr_b16 a[136:137], v74 offset:24576
  v_mfma_f32_16x16x32_bf16 v[8:11], a[116:119], a[24:27], v[8:11]
  buffer_load_dwordx4 a[64:67], v64, s[12:15], s30 offen offset:0 sc1
  ds_read_b64_tr_b16 a[138:139], v74 offset:28672
  v_mfma_f32_16x16x32_bf16 v[12:15], a[116:119], a[28:31], v[12:15]
  ds_read_b64_tr_b16 a[140:141], v75 offset:24576
  s_waitcnt lgkmcnt(7)
  v_mfma_f32_16x16x32_bf16 v[16:19], a[120:123], a[24:27], v[16:19]
  ds_read_b64_tr_b16 a[142:143], v75 offset:28672
  v_mfma_f32_16x16x32_bf16 v[20:23], a[120:123], a[28:31], v[20:23]
  s_waitcnt lgkmcnt(0)
  s_barrier
  ds_read_b64_tr_b16 a[112:113], v68 offset:32768
  v_mfma_f32_16x16x32_bf16 v[24:27], a[124:127], a[24:27], v[24:27]
  ds_read_b64_tr_b16 a[114:115], v68 offset:36864
  v_mfma_f32_16x16x32_bf16 v[28:31], a[124:127], a[28:31], v[28:31]
  ds_read_b64_tr_b16 a[116:117], v69 offset:32768
  v_mfma_f32_16x16x32_bf16 v[32:35], a[128:131], a[24:27], v[32:35]
  ds_read_b64_tr_b16 a[118:119], v69 offset:36864
  v_mfma_f32_16x16x32_bf16 v[36:39], a[128:131], a[28:31], v[36:39]
  ds_read_b64_tr_b16 a[120:121], v70 offset:32768
  v_mfma_f32_16x16x32_bf16 v[40:43], a[132:135], a[24:27], v[40:43]
  buffer_load_dwordx4 a[68:71], v64, s[12:15], s30 offen offset:1024 sc1
  ds_read_b64_tr_b16 a[122:123], v70 offset:36864
  v_mfma_f32_16x16x32_bf16 v[44:47], a[132:135], a[28:31], v[44:47]
  ds_read_b64_tr_b16 a[124:125], v71 offset:32768
  v_mfma_f32_16x16x32_bf16 v[48:51], a[136:139], a[24:27], v[48:51]
  ds_read_b64_tr_b16 a[126:127], v71 offset:36864
  v_mfma_f32_16x16x32_bf16 v[52:55], a[136:139], a[28:31], v[52:55]
  ds_read_b64_tr_b16 a[128:129], v72 offset:32768
  v_mfma_f32_16x16x32_bf16 v[56:59], a[140:143], a[24:27], v[56:59]
  ds_read_b64_tr_b16 a[130:131], v72 offset:36864
  v_mfma_f32_16x16x32_bf16 v[60:63], a[140:143], a[28:31], v[60:63]
  ds_read_b64_tr_b16 a[132:133], v73 offset:32768
  s_waitcnt vmcnt(11) lgkmcnt(7)
  v_mfma_f32_16x16x32_bf16 v[0:3], a[112:115], a[32:35], v[0:3]
  ds_read_b64_tr_b16 a[134:135], v73 offset:36864
  v_mfma_f32_16x16x32_bf16 v[4:7], a[112:115], a[36:39], v[4:7]
  s_add_u32 s30, s26, 36864
  ds_read_b64_tr_b16 a[136:137], v74 offset:32768
  v_mfma_f32_16x16x32_bf16 v[8:11], a[116:119], a[32:35], v[8:11]
  buffer_load_dwordx4 a[72:75], v64, s[12:15], s30 offen offset:0 sc1
  ds_read_b64_tr_b16 a[138:139], v74 offset:36864
  v_mfma_f32_16x16x32_bf16 v[12:15], a[116:119], a[36:39], v[12:15]
  ds_read_b64_tr_b16 a[140:141], v75 offset:32768
  s_waitcnt lgkmcnt(7)
  v_mfma_f32_16x16x32_bf16 v[16:19], a[120:123], a[32:35], v[16:19]
  ds_read_b64_tr_b16 a[142:143], v75 offset:36864
  v_mfma_f32_16x16x32_bf16 v[20:23], a[120:123], a[36:39], v[20:23]
  ds_read_b64_tr_b16 a[112:113], v68 offset:40960
  v_mfma_f32_16x16x32_bf16 v[24:27], a[124:127], a[32:35], v[24:27]
  ds_read_b64_tr_b16 a[114:115], v68 offset:45056
  v_mfma_f32_16x16x32_bf16 v[28:31], a[124:127], a[36:39], v[28:31]
  ds_read_b64_tr_b16 a[116:117], v69 offset:40960
  s_waitcnt lgkmcnt(7)
  v_mfma_f32_16x16x32_bf16 v[32:35], a[128:131], a[32:35], v[32:35]
  ds_read_b64_tr_b16 a[118:119], v69 offset:45056
  v_mfma_f32_16x16x32_bf16 v[36:39], a[128:131], a[36:39], v[36:39]
  ds_read_b64_tr_b16 a[120:121], v70 offset:40960
  v_mfma_f32_16x16x32_bf16 v[40:43], a[132:135], a[32:35], v[40:43]
  buffer_load_dwordx4 a[76:79], v64, s[12:15], s30 offen offset:1024 sc1
  ds_read_b64_tr_b16 a[122:123], v70 offset:45056
  v_mfma_f32_16x16x32_bf16 v[44:47], a[132:135], a[36:39], v[44:47]
  ds_read_b64_tr_b16 a[124:125], v71 offset:40960
  s_waitcnt lgkmcnt(7)
  v_mfma_f32_16x16x32_bf16 v[48:51], a[136:139], a[32:35], v[48:51]
  ds_read_b64_tr_b16 a[126:127], v71 offset:45056
  v_mfma_f32_16x16x32_bf16 v[52:55], a[136:139], a[36:39], v[52:55]
  ds_read_b64_tr_b16 a[128:129], v72 offset:40960
  v_mfma_f32_16x16x32_bf16 v[56:59], a[140:143], a[32:35], v[56:59]
  ds_read_b64_tr_b16 a[130:131], v72 offset:45056
  v_mfma_f32_16x16x32_bf16 v[60:63], a[140:143], a[36:39], v[60:63]
  ds_read_b64_tr_b16 a[132:133], v73 offset:40960
  s_waitcnt vmcnt(9) lgkmcnt(7)
  v_mfma_f32_16x16x32_bf16 v[0:3], a[112:115], a[40:43], v[0:3]
  ds_read_b64_tr_b16 a[134:135], v73 offset:45056
  v_mfma_f32_16x16x32_bf16 v[4:7], a[112:115], a[44:47], v[4:7]
  s_add_u32 s30, s26, 40960
  ds_read_b64_tr_b16 a[136:137], v74 offset:40960
  v_mfma_f32_16x16x32_bf16 v[8:11], a[116:119], a[40:43], v[8:11]
  buffer_load_dwordx4 a[80:83], v64, s[12:15], s30 offen offset:0 sc1
  ds_read_b64_tr_b16 a[138:139], v74 offset:45056
  v_mfma_f32_16x16x32_bf16 v[12:15], a[116:119], a[44:47], v[12:15]
  ds_read_b64_tr_b16 a[140:141], v75 offset:40960
  s_waitcnt lgkmcnt(7)
  v_mfma_f32_16x16x32_bf16 v[16:19], a[120:123], a[40:43], v[16:19]
  ds_read_b64_tr_b16 a[142:143], v75 offset:45056
  v_mfma_f32_16x16x32_bf16 v[20:23], a[120:123], a[44:47], v[20:23]
  s_waitcnt lgkmcnt(0)
  s_barrier
  ds_read_b64_tr_b16 a[112:113], v68 offset:49152
  v_mfma_f32_16x16x32_bf16 v[24:27], a[124:127], a[40:43], v[24:27]
  ds_read_b64_tr_b16 a[114:115], v68 offset:53248
  v_mfma_f32_16x16x32_bf16 v[28:31], a[124:127], a[44:47], v[28:31]
  ds_read_b64_tr_b16 a[116:117], v69 offset:49152
  v_mfma_f32_16x16x32_bf16 v[32:35], a[128:131], a[40:43], v[32:35]
  ds_read_b64_tr_b16 a[118:119], v69 offset:53248
  v_mfma_f32_16x16x32_bf16 v[36:39], a[128:131], a[44:47], v[36:39]
  ds_read_b64_tr_b16 a[120:121], v70 offset:49152
  v_mfma_f32_16x16x32_bf16 v[40:43], a[132:135], a[40:43], v[40:43]
  buffer_load_dwordx4 a[84:87], v64, s[12:15], s30 offen offset:1024 sc1
  ds_read_b64_tr_b16 a[122:123], v70 offset:53248
  v_mfma_f32_16x16x32_bf16 v[44:47], a[132:135], a[44:47], v[44:47]
  ds_read_b64_tr_b16 a[124:125], v71 offset:49152
  v_mfma_f32_16x16x32_bf16 v[48:51], a[136:139], a[40:43], v[48:51]
  ds_read_b64_tr_b16 a[126:127], v71 offset:53248
  v_mfma_f32_16x16x32_bf16 v[52:55], a[136:139], a[44:47], v[52:55]
  ds_read_b64_tr_b16 a[128:129], v72 offset:49152
  v_mfma_f32_16x16x32_bf16 v[56:59], a[140:143], a[40:43], v[56:59]
  ds_read_b64_tr_b16 a[130:131], v72 offset:53248
  v_mfma_f32_16x16x32_bf16 v[60:63], a[140:143], a[44:47], v[60:63]
  ds_read_b64_tr_b16 a[132:133], v73 offset:49152
  s_waitcnt vmcnt(8) lgkmcnt(7)
  v_mfma_f32_16x16x32_bf16 v[0:3], a[112:115], a[48:51], v[0:3]
  ds_read_b64_tr_b16 a[134:135], v73 offset:53248
  v_mfma_f32_16x16x32_bf16 v[4:7], a[112:115], a[52:55], v[4:7]
  s_add_u32 s30, s26, 45056
  ds_read_b64_tr_b16 a[136:137], v74 offset:49152
  v_mfma_f32_16x16x32_bf16 v[8:11], a[116:119], a[48:51], v[8:11]
  buffer_load_dwordx4 a[88:91], v64, s[12:15], s30 offen offset:0 sc1
  ds_read_b64_tr_b16 a[138:139], v74 offset:53248
  v_mfma_f32_16x16x32_bf16 v[12:15], a[116:119], a[52:55], v[12:15]
  ds_read_b64_tr_b16 a[140:141], v75 offset:49152
  s_waitcnt lgkmcnt(7)
  v_mfma_f32_16x16x32_bf16 v[16:19], a[120:123], a[48:51], v[16:19]
  ds_read_b64_tr_b16 a[142:143], v75 offset:53248
  v_mfma_f32_16x16x32_bf16 v[20:23], a[120:123], a[52:55], v[20:23]
  ds_read_b64_tr_b16 a[112:113], v68 offset:57344
  v_mfma_f32_16x16x32_bf16 v[24:27], a[124:127], a[48:51], v[24:27]
  ds_read_b64_tr_b16 a[114:115], v68 offset:61440
  v_mfma_f32_16x16x32_bf16 v[28:31], a[124:127], a[52:55], v[28:31]
  ds_read_b64_tr_b16 a[116:117], v69 offset:57344
  s_waitcnt lgkmcnt(7)
  v_mfma_f32_16x16x32_bf16 v[32:35], a[128:131], a[48:51], v[32:35]
  ds_read_b64_tr_b16 a[118:119], v69 offset:61440
  v_mfma_f32_16x16x32_bf16 v[36:39], a[128:131], a[52:55], v[36:39]
  ds_read_b64_tr_b16 a[120:121], v70 offset:57344
  v_mfma_f32_16x16x32_bf16 v[40:43], a[132:135], a[48:51], v[40:43]
  buffer_load_dwordx4 a[92:95], v64, s[12:15], s30 offen offset:1024 sc1
  ds_read_b64_tr_b16 a[122:123], v70 offset:61440
  v_mfma_f32_16x16x32_bf16 v[44:47], a[132:135], a[52:55], v[44:47]
  ds_read_b64_tr_b16 a[124:125], v71 offset:57344
  s_waitcnt lgkmcnt(7)
  v_mfma_f32_16x16x32_bf16 v[48:51], a[136:139], a[48:51], v[48:51]
  ds_read_b64_tr_b16 a[126:127], v71 offset:61440
  v_mfma_f32_16x16x32_bf16 v[52:55], a[136:139], a[52:55], v[52:55]
  ds_read_b64_tr_b16 a[128:129], v72 offset:57344
  v_mfma_f32_16x16x32_bf16 v[56:59], a[140:143], a[48:51], v[56:59]
  ds_read_b64_tr_b16 a[130:131], v72 offset:61440
  v_mfma_f32_16x16x32_bf16 v[60:63], a[140:143], a[52:55], v[60:63]
  ds_read_b64_tr_b16 a[132:133], v73 offset:57344
  s_waitcnt vmcnt(8) lgkmcnt(7)
  v_mfma_f32_16x16x32_bf16 v[0:3], a[112:115], a[56:59], v[0:3]
  ds_read_b64_tr_b16 a[134:135], v73 offset:61440
  v_mfma_f32_16x16x32_bf16 v[4:7], a[112:115], a[60:63], v[4:7]
  s_add_u32 s30, s26, 49152
  ds_read_b64_tr_b16 a[136:137], v74 offset:57344
  v_mfma_f32_16x16x32_bf16 v[8:11], a[116:119], a[56:59], v[8:11]
  buffer_load_dwordx4 a[96:99], v64, s[12:15], s30 offen offset:0 sc1
  ds_read_b64_tr_b16 a[138:139], v74 offset:61440
  v_mfma_f32_16x16x32_bf16 v[12:15], a[116:119], a[60:63], v[12:15]
  ds_read_b64_tr_b16 a[140:141], v75 offset:57344
  s_waitcnt lgkmcnt(7)
  v_mfma_f32_16x16x32_bf16 v[16:19], a[120:123], a[56:59], v[16:19]
  ds_read_b64_tr_b16 a[142:143], v75 offset:61440
  v_mfma_f32_16x16x32_bf16 v[20:23], a[120:123], a[60:63], v[20:23]
  s_waitcnt lgkmcnt(0)
  s_barrier
  ds_read_b64_tr_b16 a[112:113], v76 offset:0
  v_mfma_f32_16x16x32_bf16 v[24:27], a[124:127], a[56:59], v[24:27]
  ds_read_b64_tr_b16 a[114:115], v76 offset:4096
  v_mfma_f32_16x16x32_bf16 v[28:31], a[124:127], a[60:63], v[28:31]
  ds_read_b64_tr_b16 a[116:117], v77 offset:0
  v_mfma_f32_16x16x32_bf16 v[32:35], a[128:131], a[56:59], v[32:35]
  ds_read_b64_tr_b16 a[118:119], v77 offset:4096
  v_mfma_f32_16x16x32_bf16 v[36:39], a[128:131], a[60:63], v[36:39]
  ds_read_b64_tr_b16 a[120:121], v78 offset:0
  v_mfma_f32_16x16x32_bf16 v[40:43], a[132:135], a[56:59], v[40:43]
  buffer_load_dwordx4 a[100:103], v64, s[12:15], s30 offen offset:1024 sc1
  ds_read_b64_tr_b16 a[122:123], v78 offset:4096
  v_mfma_f32_16x16x32_bf16 v[44:47], a[132:135], a[60:63], v[44:47]
  ds_read_b64_tr_b16 a[124:125], v79 offset:0
  v_mfma_f32_16x16x32_bf16 v[48:51], a[136:139], a[56:59], v[48:51]
  ds_read_b64_tr_b16 a[126:127], v79 offset:4096
  v_mfma_f32_16x16x32_bf16 v[52:55], a[136:139], a[60:63], v[52:55]
  ds_read_b64_tr_b16 a[128:129], v80 offset:0
  v_mfma_f32_16x16x32_bf16 v[56:59], a[140:143], a[56:59], v[56:59]
  ds_read_b64_tr_b16 a[130:131], v80 offset:4096
  v_mfma_f32_16x16x32_bf16 v[60:63], a[140:143], a[60:63], v[60:63]
  ds_read_b64_tr_b16 a[132:133], v81 offset:0
  s_waitcnt vmcnt(8) lgkmcnt(7)
  v_mfma_f32_16x16x32_bf16 v[0:3], a[112:115], a[64:67], v[0:3]
  ds_read_b64_tr_b16 a[134:135], v81 offset:4096
  v_mfma_f32_16x16x32_bf16 v[4:7], a[112:115], a[68:71], v[4:7]
  s_add_u32 s30, s26, 53248
  ds_read_b64_tr_b16 a[136:137], v82 offset:0
  v_mfma_f32_16x16x32_bf16 v[8:11], a[116:119], a[64:67], v[8:11]
  buffer_load_dwordx4 a[104:107], v64, s[12:15], s30 offen offset:0 sc1
  ds_read_b64_tr_b16 a[138:139], v82 offset:4096
  v_mfma_f32_16x16x32_bf16 v[12:15], a[116:119], a[68:71], v[12:15]
  ds_read_b64_tr_b16 a[140:141], v83 offset:0
  s_waitcnt lgkmcnt(7)
  v_mfma_f32_16x16x32_bf16 v[16:19], a[120:123], a[64:67], v[16:19]
  ds_read_b64_tr_b16 a[142:143], v83 offset:4096
  v_mfma_f32_16x16x32_bf16 v[20:23], a[120:123], a[68:71], v[20:23]
  ds_read_b64_tr_b16 a[112:113], v76 offset:8192
  v_mfma_f32_16x16x32_bf16 v[24:27], a[124:127], a[64:67], v[24:27]
  ds_read_b64_tr_b16 a[114:115], v76 offset:12288
  v_mfma_f32_16x16x32_bf16 v[28:31], a[124:127], a[68:71], v[28:31]
  ds_read_b64_tr_b16 a[116:117], v77 offset:8192
  s_waitcnt lgkmcnt(7)
  v_mfma_f32_16x16x32_bf16 v[32:35], a[128:131], a[64:67], v[32:35]
  ds_read_b64_tr_b16 a[118:119], v77 offset:12288
  v_mfma_f32_16x16x32_bf16 v[36:39], a[128:131], a[68:71], v[36:39]
  ds_read_b64_tr_b16 a[120:121], v78 offset:8192
  v_mfma_f32_16x16x32_bf16 v[40:43], a[132:135], a[64:67], v[40:43]
  buffer_load_dwordx4 a[108:111], v64, s[12:15], s30 offen offset:1024 sc1
  ds_read_b64_tr_b16 a[122:123], v78 offset:12288
  v_mfma_f32_16x16x32_bf16 v[44:47], a[132:135], a[68:71], v[44:47]
  ds_read_b64_tr_b16 a[124:125], v79 offset:8192
  s_waitcnt lgkmcnt(7)
  v_mfma_f32_16x16x32_bf16 v[48:51], a[136:139], a[64:67], v[48:51]
  ds_read_b64_tr_b16 a[126:127], v79 offset:12288
  v_mfma_f32_16x16x32_bf16 v[52:55], a[136:139], a[68:71], v[52:55]
  ds_read_b64_tr_b16 a[128:129], v80 offset:8192
  v_mfma_f32_16x16x32_bf16 v[56:59], a[140:143], a[64:67], v[56:59]
  ds_read_b64_tr_b16 a[130:131], v80 offset:12288
  v_mfma_f32_16x16x32_bf16 v[60:63], a[140:143], a[68:71], v[60:63]
  ds_read_b64_tr_b16 a[132:133], v81 offset:8192
  s_waitcnt vmcnt(8) lgkmcnt(7)
  v_mfma_f32_16x16x32_bf16 v[0:3], a[112:115], a[72:75], v[0:3]
  ds_read_b64_tr_b16 a[134:135], v81 offset:12288
  v_mfma_f32_16x16x32_bf16 v[4:7], a[112:115], a[76:79], v[4:7]
  ds_read_b64_tr_b16 a[136:137], v82 offset:8192
  v_mfma_f32_16x16x32_bf16 v[8:11], a[116:119], a[72:75], v[8:11]
  ds_read_b64_tr_b16 a[138:139], v82 offset:12288
  v_mfma_f32_16x16x32_bf16 v[12:15], a[116:119], a[76:79], v[12:15]
  ds_read_b64_tr_b16 a[140:141], v83 offset:8192
  s_waitcnt lgkmcnt(7)
  v_mfma_f32_16x16x32_bf16 v[16:19], a[120:123], a[72:75], v[16:19]
  ds_read_b64_tr_b16 a[142:143], v83 offset:12288
  v_mfma_f32_16x16x32_bf16 v[20:23], a[120:123], a[76:79], v[20:23]
  s_waitcnt lgkmcnt(0)
  s_barrier
  ds_read_b64_tr_b16 a[112:113], v76 offset:16384
  v_mfma_f32_16x16x32_bf16 v[24:27], a[124:127], a[72:75], v[24:27]
  ds_read_b64_tr_b16 a[114:115], v76 offset:20480
  v_mfma_f32_16x16x32_bf16 v[28:31], a[124:127], a[76:79], v[28:31]
  ds_read_b64_tr_b16 a[116:117], v77 offset:16384
  v_mfma_f32_16x16x32_bf16 v[32:35], a[128:131], a[72:75], v[32:35]
  ds_read_b64_tr_b16 a[118:119], v77 offset:20480
  v_mfma_f32_16x16x32_bf16 v[36:39], a[128:131], a[76:79], v[36:39]
  ds_read_b64_tr_b16 a[120:121], v78 offset:16384
  v_mfma_f32_16x16x32_bf16 v[40:43], a[132:135], a[72:75], v[40:43]
  ds_read_b64_tr_b16 a[122:123], v78 offset:20480
  v_mfma_f32_16x16x32_bf16 v[44:47], a[132:135], a[76:79], v[44:47]
  ds_read_b64_tr_b16 a[124:125], v79 offset:16384
  v_mfma_f32_16x16x32_bf16 v[48:51], a[136:139], a[72:75], v[48:51]
  ds_read_b64_tr_b16 a[126:127], v79 offset:20480
  v_mfma_f32_16x16x32_bf16 v[52:55], a[136:139], a[76:79], v[52:55]
  ds_read_b64_tr_b16 a[128:129], v80 offset:16384
  v_mfma_f32_16x16x32_bf16 v[56:59], a[140:143], a[72:75], v[56:59]
  ds_read_b64_tr_b16 a[130:131], v80 offset:20480
  v_mfma_f32_16x16x32_bf16 v[60:63], a[140:143], a[76:79], v[60:63]
  ds_read_b64_tr_b16 a[132:133], v81 offset:16384
  s_waitcnt vmcnt(6) lgkmcnt(7)
  v_mfma_f32_16x16x32_bf16 v[0:3], a[112:115], a[80:83], v[0:3]
  ds_read_b64_tr_b16 a[134:135], v81 offset:20480
  buffer_load_dwordx4 v[88:91], v84, s[16:19], s40 offen offset:0 sc1
  v_mfma_f32_16x16x32_bf16 v[4:7], a[112:115], a[84:87], v[4:7]
  ds_read_b64_tr_b16 a[136:137], v82 offset:16384
  v_mfma_f32_16x16x32_bf16 v[8:11], a[116:119], a[80:83], v[8:11]
  ds_read_b64_tr_b16 a[138:139], v82 offset:20480
  v_mfma_f32_16x16x32_bf16 v[12:15], a[116:119], a[84:87], v[12:15]
  ds_read_b64_tr_b16 a[140:141], v83 offset:16384
  s_waitcnt lgkmcnt(7)
  v_mfma_f32_16x16x32_bf16 v[16:19], a[120:123], a[80:83], v[16:19]
  ds_read_b64_tr_b16 a[142:143], v83 offset:20480
  buffer_load_dwordx4 v[92:95], v84, s[16:19], s40 offen offset:1024 sc1
  v_mfma_f32_16x16x32_bf16 v[20:23], a[120:123], a[84:87], v[20:23]
  ds_read_b64_tr_b16 a[112:113], v76 offset:24576
  v_mfma_f32_16x16x32_bf16 v[24:27], a[124:127], a[80:83], v[24:27]
  ds_read_b64_tr_b16 a[114:115], v76 offset:28672
  v_mfma_f32_16x16x32_bf16 v[28:31], a[124:127], a[84:87], v[28:31]
  ds_read_b64_tr_b16 a[116:117], v77 offset:24576
  s_waitcnt lgkmcnt(7)
  v_mfma_f32_16x16x32_bf16 v[32:35], a[128:131], a[80:83], v[32:35]
  ds_read_b64_tr_b16 a[118:119], v77 offset:28672
  buffer_load_dwordx4 v[96:99], v84, s[16:19], s41 offen offset:0 sc1
  v_mfma_f32_16x16x32_bf16 v[36:39], a[128:131], a[84:87], v[36:39]
  ds_read_b64_tr_b16 a[120:121], v78 offset:24576
  v_mfma_f32_16x16x32_bf16 v[40:43], a[132:135], a[80:83], v[40:43]
  ds_read_b64_tr_b16 a[122:123], v78 offset:28672
  v_mfma_f32_16x16x32_bf16 v[44:47], a[132:135], a[84:87], v[44:47]
  ds_read_b64_tr_b16 a[124:125], v79 offset:24576
  s_waitcnt lgkmcnt(7)
  v_mfma_f32_16x16x32_bf16 v[48:51], a[136:139], a[80:83], v[48:51]
  ds_read_b64_tr_b16 a[126:127], v79 offset:28672
  buffer_load_dwordx4 v[100:103], v84, s[16:19], s41 offen offset:1024 sc1
  v_mfma_f32_16x16x32_bf16 v[52:55], a[136:139], a[84:87], v[52:55]
  ds_read_b64_tr_b16 a[128:129], v80 offset:24576
  v_mfma_f32_16x16x32_bf16 v[56:59], a[140:143], a[80:83], v[56:59]
  ds_read_b64_tr_b16 a[130:131], v80 offset:28672
  v_mfma_f32_16x16x32_bf16 v[60:63], a[140:143], a[84:87], v[60:63]
  ds_read_b64_tr_b16 a[132:133], v81 offset:24576
  s_waitcnt vmcnt(8) lgkmcnt(7)
  v_mfma_f32_16x16x32_bf16 v[0:3], a[112:115], a[88:91], v[0:3]
  ds_read_b64_tr_b16 a[134:135], v81 offset:28672
  buffer_load_dwordx4 v[104:107], v84, s[16:19], s42 offen offset:0 sc1
  v_mfma_f32_16x16x32_bf16 v[4:7], a[112:115], a[92:95], v[4:7]
  ds_read_b64_tr_b16 a[136:137], v82 offset:24576
  v_mfma_f32_16x16x32_bf16 v[8:11], a[116:119], a[88:91], v[8:11]
  ds_read_b64_tr_b16 a[138:139], v82 offset:28672
  v_mfma_f32_16x16x32_bf16 v[12:15], a[116:119], a[92:95], v[12:15]
  ds_read_b64_tr_b16 a[140:141], v83 offset:24576
  s_waitcnt lgkmcnt(7)
  v_mfma_f32_16x16x32_bf16 v[16:19], a[120:123], a[88:91], v[16:19]
  ds_read_b64_tr_b16 a[142:143], v83 offset:28672
  buffer_load_dwordx4 v[108:111], v84, s[16:19], s42 offen offset:1024 sc1
  v_mfma_f32_16x16x32_bf16 v[20:23], a[120:123], a[92:95], v[20:23]
  s_waitcnt lgkmcnt(0)
  s_barrier
  ds_read_b64_tr_b16 a[112:113], v76 offset:32768
  v_mfma_f32_16x16x32_bf16 v[24:27], a[124:127], a[88:91], v[24:27]
  ds_read_b64_tr_b16 a[114:115], v76 offset:36864
  v_mfma_f32_16x16x32_bf16 v[28:31], a[124:127], a[92:95], v[28:31]
  ds_read_b64_tr_b16 a[116:117], v77 offset:32768
  v_mfma_f32_16x16x32_bf16 v[32:35], a[128:131], a[88:91], v[32:35]
  ds_read_b64_tr_b16 a[118:119], v77 offset:36864
  buffer_load_dwordx4 v[112:115], v84, s[16:19], s43 offen offset:0 sc1
  v_mfma_f32_16x16x32_bf16 v[36:39], a[128:131], a[92:95], v[36:39]
  ds_read_b64_tr_b16 a[120:121], v78 offset:32768
  v_mfma_f32_16x16x32_bf16 v[40:43], a[132:135], a[88:91], v[40:43]
  ds_read_b64_tr_b16 a[122:123], v78 offset:36864
  v_mfma_f32_16x16x32_bf16 v[44:47], a[132:135], a[92:95], v[44:47]
  ds_read_b64_tr_b16 a[124:125], v79 offset:32768
  v_mfma_f32_16x16x32_bf16 v[48:51], a[136:139], a[88:91], v[48:51]
  ds_read_b64_tr_b16 a[126:127], v79 offset:36864
  buffer_load_dwordx4 v[116:119], v84, s[16:19], s43 offen offset:1024 sc1
  v_mfma_f32_16x16x32_bf16 v[52:55], a[136:139], a[92:95], v[52:55]
  ds_read_b64_tr_b16 a[128:129], v80 offset:32768
  v_mfma_f32_16x16x32_bf16 v[56:59], a[140:143], a[88:91], v[56:59]
  ds_read_b64_tr_b16 a[130:131], v80 offset:36864
  v_mfma_f32_16x16x32_bf16 v[60:63], a[140:143], a[92:95], v[60:63]
  ds_read_b64_tr_b16 a[132:133], v81 offset:32768
  s_waitcnt vmcnt(10) lgkmcnt(7)
  v_mfma_f32_16x16x32_bf16 v[0:3], a[112:115], a[96:99], v[0:3]
  ds_read_b64_tr_b16 a[134:135], v81 offset:36864
  v_mfma_f32_16x16x32_bf16 v[4:7], a[112:115], a[100:103], v[4:7]
  ds_read_b64_tr_b16 a[136:137], v82 offset:32768
  v_mfma_f32_16x16x32_bf16 v[8:11], a[116:119], a[96:99], v[8:11]
  ds_read_b64_tr_b16 a[138:139], v82 offset:36864
  v_mfma_f32_16x16x32_bf16 v[12:15], a[116:119], a[100:103], v[12:15]
  ds_read_b64_tr_b16 a[140:141], v83 offset:32768
  s_waitcnt lgkmcnt(7)
  v_mfma_f32_16x16x32_bf16 v[16:19], a[120:123], a[96:99], v[16:19]
  ds_read_b64_tr_b16 a[142:143], v83 offset:36864
  v_mfma_f32_16x16x32_bf16 v[20:23], a[120:123], a[100:103], v[20:23]
  ds_read_b64_tr_b16 a[112:113], v76 offset:40960
  v_mfma_f32_16x16x32_bf16 v[24:27], a[124:127], a[96:99], v[24:27]
  ds_read_b64_tr_b16 a[114:115], v76 offset:45056
  v_mfma_f32_16x16x32_bf16 v[28:31], a[124:127], a[100:103], v[28:31]
  ds_read_b64_tr_b16 a[116:117], v77 offset:40960
  s_waitcnt lgkmcnt(7)
  v_mfma_f32_16x16x32_bf16 v[32:35], a[128:131], a[96:99], v[32:35]
  ds_read_b64_tr_b16 a[118:119], v77 offset:45056
  v_mfma_f32_16x16x32_bf16 v[36:39], a[128:131], a[100:103], v[36:39]
  ds_read_b64_tr_b16 a[120:121], v78 offset:40960
  v_mfma_f32_16x16x32_bf16 v[40:43], a[132:135], a[96:99], v[40:43]
  ds_read_b64_tr_b16 a[122:123], v78 offset:45056
  v_mfma_f32_16x16x32_bf16 v[44:47], a[132:135], a[100:103], v[44:47]
  ds_read_b64_tr_b16 a[124:125], v79 offset:40960
  s_waitcnt lgkmcnt(7)
  v_mfma_f32_16x16x32_bf16 v[48:51], a[136:139], a[96:99], v[48:51]
  ds_read_b64_tr_b16 a[126:127], v79 offset:45056
  v_mfma_f32_16x16x32_bf16 v[52:55], a[136:139], a[100:103], v[52:55]
  ds_read_b64_tr_b16 a[128:129], v80 offset:40960
  v_mfma_f32_16x16x32_bf16 v[56:59], a[140:143], a[96:99], v[56:59]
  ds_read_b64_tr_b16 a[130:131], v80 offset:45056
  v_mfma_f32_16x16x32_bf16 v[60:63], a[140:143], a[100:103], v[60:63]
  ds_read_b64_tr_b16 a[132:133], v81 offset:40960
  s_waitcnt vmcnt(8) lgkmcnt(7)
  v_mfma_f32_16x16x32_bf16 v[0:3], a[112:115], a[104:107], v[0:3]
  ds_read_b64_tr_b16 a[134:135], v81 offset:45056
  v_mfma_f32_16x16x32_bf16 v[4:7], a[112:115], a[108:111], v[4:7]
  ds_read_b64_tr_b16 a[136:137], v82 offset:40960
  v_mfma_f32_16x16x32_bf16 v[8:11], a[116:119], a[104:107], v[8:11]
  ds_read_b64_tr_b16 a[138:139], v82 offset:45056
  v_mfma_f32_16x16x32_bf16 v[12:15], a[116:119], a[108:111], v[12:15]
  ds_read_b64_tr_b16 a[140:141], v83 offset:40960
  s_waitcnt lgkmcnt(7)
  v_mfma_f32_16x16x32_bf16 v[16:19], a[120:123], a[104:107], v[16:19]
  ds_read_b64_tr_b16 a[142:143], v83 offset:45056
  v_mfma_f32_16x16x32_bf16 v[20:23], a[120:123], a[108:111], v[20:23]
  v_mfma_f32_16x16x32_bf16 v[24:27], a[124:127], a[104:107], v[24:27]
  v_mfma_f32_16x16x32_bf16 v[28:31], a[124:127], a[108:111], v[28:31]
  s_waitcnt lgkmcnt(4)
  v_mfma_f32_16x16x32_bf16 v[32:35], a[128:131], a[104:107], v[32:35]
  v_mfma_f32_16x16x32_bf16 v[36:39], a[128:131], a[108:111], v[36:39]
  v_mfma_f32_16x16x32_bf16 v[40:43], a[132:135], a[104:107], v[40:43]
  v_mfma_f32_16x16x32_bf16 v[44:47], a[132:135], a[108:111], v[44:47]
  s_waitcnt lgkmcnt(0)
  v_mfma_f32_16x16x32_bf16 v[48:51], a[136:139], a[104:107], v[48:51]
  v_mfma_f32_16x16x32_bf16 v[52:55], a[136:139], a[108:111], v[52:55]
  v_mfma_f32_16x16x32_bf16 v[56:59], a[140:143], a[104:107], v[56:59]
  v_mfma_f32_16x16x32_bf16 v[60:63], a[140:143], a[108:111], v[60:63]
  s_cmp_lg_u32 s97, 0
  s_cbranch_scc1 fa_kernel_xch17
  s_lshl_b32 s37, s33, 22
  s_add_u32 s37, s37, 0xe000000
  s_add_u32 s20, s92, s37
  s_addc_u32 s21, s93, 0
  s_mov_b32 s22, 0x400000
  s_mov_b32 s23, 0x00020000
  s_nop 4
  v_permlane16_swap_b32 v0, v8
  v_permlane16_swap_b32 v1, v9
  v_permlane16_swap_b32 v2, v10
  v_permlane16_swap_b32 v3, v11
  s_waitcnt vmcnt(7)
  v_lshlrev_b32 v120, 16, v88
  v_and_b32 v121, 0xffff0000, v88
  v_pk_add_f32 v[0:1], v[0:1], v[120:121]
  v_cvt_pk_bf16_f32 v88, v0, v1
  v_lshlrev_b32 v120, 16, v89
  v_and_b32 v121, 0xffff0000, v89
  v_pk_add_f32 v[2:3], v[2:3], v[120:121]
  v_cvt_pk_bf16_f32 v89, v2, v3
  v_lshlrev_b32 v120, 16, v90
  v_and_b32 v121, 0xffff0000, v90
  v_pk_add_f32 v[8:9], v[8:9], v[120:121]
  v_cvt_pk_bf16_f32 v90, v8, v9
  v_lshlrev_b32 v120, 16, v91
  v_and_b32 v121, 0xffff0000, v91
  v_pk_add_f32 v[10:11], v[10:11], v[120:121]
  v_cvt_pk_bf16_f32 v91, v10, v11
  buffer_store_dwordx4 v[88:91], v85, s[20:23], s44 offen offset:0 sc1
  v_permlane16_swap_b32 v4, v12
  v_permlane16_swap_b32 v5, v13
  v_permlane16_swap_b32 v6, v14
  v_permlane16_swap_b32 v7, v15
  s_waitcnt vmcnt(7)
  v_lshlrev_b32 v120, 16, v92
  v_and_b32 v121, 0xffff0000, v92
  v_pk_add_f32 v[4:5], v[4:5], v[120:121]
  v_cvt_pk_bf16_f32 v92, v4, v5
  v_lshlrev_b32 v120, 16, v93
  v_and_b32 v121, 0xffff0000, v93
  v_pk_add_f32 v[6:7], v[6:7], v[120:121]
  v_cvt_pk_bf16_f32 v93, v6, v7
  v_lshlrev_b32 v120, 16, v94
  v_and_b32 v121, 0xffff0000, v94
  v_pk_add_f32 v[12:13], v[12:13], v[120:121]
  v_cvt_pk_bf16_f32 v94, v12, v13
  v_lshlrev_b32 v120, 16, v95
  v_and_b32 v121, 0xffff0000, v95
  v_pk_add_f32 v[14:15], v[14:15], v[120:121]
  v_cvt_pk_bf16_f32 v95, v14, v15
  buffer_store_dwordx4 v[92:95], v85, s[20:23], s45 offen offset:0 sc1
  v_permlane16_swap_b32 v16, v24
  v_permlane16_swap_b32 v17, v25
  v_permlane16_swap_b32 v18, v26
  v_permlane16_swap_b32 v19, v27
  s_waitcnt vmcnt(7)
  v_lshlrev_b32 v120, 16, v96
  v_and_b32 v121, 0xffff0000, v96
  v_pk_add_f32 v[16:17], v[16:17], v[120:121]
  v_cvt_pk_bf16_f32 v96, v16, v17
  v_lshlrev_b32 v120, 16, v97
  v_and_b32 v121, 0xffff0000, v97
  v_pk_add_f32 v[18:19], v[18:19], v[120:121]
  v_cvt_pk_bf16_f32 v97, v18, v19
  v_lshlrev_b32 v120, 16, v98
  v_and_b32 v121, 0xffff0000, v98
  v_pk_add_f32 v[24:25], v[24:25], v[120:121]
  v_cvt_pk_bf16_f32 v98, v24, v25
  v_lshlrev_b32 v120, 16, v99
  v_and_b32 v121, 0xffff0000, v99
  v_pk_add_f32 v[26:27], v[26:27], v[120:121]
  v_cvt_pk_bf16_f32 v99, v26, v27
  buffer_store_dwordx4 v[96:99], v85, s[20:23], s44 offen offset:64 sc1
  v_permlane16_swap_b32 v20, v28
  v_permlane16_swap_b32 v21, v29
  v_permlane16_swap_b32 v22, v30
  v_permlane16_swap_b32 v23, v31
  s_waitcnt vmcnt(7)
  v_lshlrev_b32 v120, 16, v100
  v_and_b32 v121, 0xffff0000, v100
  v_pk_add_f32 v[20:21], v[20:21], v[120:121]
  v_cvt_pk_bf16_f32 v100, v20, v21
  v_lshlrev_b32 v120, 16, v101
  v_and_b32 v121, 0xffff0000, v101
  v_pk_add_f32 v[22:23], v[22:23], v[120:121]
  v_cvt_pk_bf16_f32 v101, v22, v23
  v_lshlrev_b32 v120, 16, v102
  v_and_b32 v121, 0xffff0000, v102
  v_pk_add_f32 v[28:29], v[28:29], v[120:121]
  v_cvt_pk_bf16_f32 v102, v28, v29
  v_lshlrev_b32 v120, 16, v103
  v_and_b32 v121, 0xffff0000, v103
  v_pk_add_f32 v[30:31], v[30:31], v[120:121]
  v_cvt_pk_bf16_f32 v103, v30, v31
  buffer_store_dwordx4 v[100:103], v85, s[20:23], s45 offen offset:64 sc1
  v_permlane16_swap_b32 v32, v40
  v_permlane16_swap_b32 v33, v41
  v_permlane16_swap_b32 v34, v42
  v_permlane16_swap_b32 v35, v43
  s_waitcnt vmcnt(7)
  v_lshlrev_b32 v120, 16, v104
  v_and_b32 v121, 0xffff0000, v104
  v_pk_add_f32 v[32:33], v[32:33], v[120:121]
  v_cvt_pk_bf16_f32 v104, v32, v33
  v_lshlrev_b32 v120, 16, v105
  v_and_b32 v121, 0xffff0000, v105
  v_pk_add_f32 v[34:35], v[34:35], v[120:121]
  v_cvt_pk_bf16_f32 v105, v34, v35
  v_lshlrev_b32 v120, 16, v106
  v_and_b32 v121, 0xffff0000, v106
  v_pk_add_f32 v[40:41], v[40:41], v[120:121]
  v_cvt_pk_bf16_f32 v106, v40, v41
  v_lshlrev_b32 v120, 16, v107
  v_and_b32 v121, 0xffff0000, v107
  v_pk_add_f32 v[42:43], v[42:43], v[120:121]
  v_cvt_pk_bf16_f32 v107, v42, v43
  buffer_store_dwordx4 v[104:107], v85, s[20:23], s46 offen offset:0 sc1
  v_permlane16_swap_b32 v36, v44
  v_permlane16_swap_b32 v37, v45
  v_permlane16_swap_b32 v38, v46
  v_permlane16_swap_b32 v39, v47
  s_waitcnt vmcnt(7)
  v_lshlrev_b32 v120, 16, v108
  v_and_b32 v121, 0xffff0000, v108
  v_pk_add_f32 v[36:37], v[36:37], v[120:121]
  v_cvt_pk_bf16_f32 v108, v36, v37
  v_lshlrev_b32 v120, 16, v109
  v_and_b32 v121, 0xffff0000, v109
  v_pk_add_f32 v[38:39], v[38:39], v[120:121]
  v_cvt_pk_bf16_f32 v109, v38, v39
  v_lshlrev_b32 v120, 16, v110
  v_and_b32 v121, 0xffff0000, v110
  v_pk_add_f32 v[44:45], v[44:45], v[120:121]
  v_cvt_pk_bf16_f32 v110, v44, v45
  v_lshlrev_b32 v120, 16, v111
  v_and_b32 v121, 0xffff0000, v111
  v_pk_add_f32 v[46:47], v[46:47], v[120:121]
  v_cvt_pk_bf16_f32 v111, v46, v47
  buffer_store_dwordx4 v[108:111], v85, s[20:23], s47 offen offset:0 sc1
  v_permlane16_swap_b32 v48, v56
  v_permlane16_swap_b32 v49, v57
  v_permlane16_swap_b32 v50, v58
  v_permlane16_swap_b32 v51, v59
  s_waitcnt vmcnt(7)
  v_lshlrev_b32 v120, 16, v112
  v_and_b32 v121, 0xffff0000, v112
  v_pk_add_f32 v[48:49], v[48:49], v[120:121]
  v_cvt_pk_bf16_f32 v112, v48, v49
  v_lshlrev_b32 v120, 16, v113
  v_and_b32 v121, 0xffff0000, v113
  v_pk_add_f32 v[50:51], v[50:51], v[120:121]
  v_cvt_pk_bf16_f32 v113, v50, v51
  v_lshlrev_b32 v120, 16, v114
  v_and_b32 v121, 0xffff0000, v114
  v_pk_add_f32 v[56:57], v[56:57], v[120:121]
  v_cvt_pk_bf16_f32 v114, v56, v57
  v_lshlrev_b32 v120, 16, v115
  v_and_b32 v121, 0xffff0000, v115
  v_pk_add_f32 v[58:59], v[58:59], v[120:121]
  v_cvt_pk_bf16_f32 v115, v58, v59
  buffer_store_dwordx4 v[112:115], v85, s[20:23], s46 offen offset:64 sc1
  v_permlane16_swap_b32 v52, v60
  v_permlane16_swap_b32 v53, v61
  v_permlane16_swap_b32 v54, v62
  v_permlane16_swap_b32 v55, v63
  s_waitcnt vmcnt(7)
  v_lshlrev_b32 v120, 16, v116
  v_and_b32 v121, 0xffff0000, v116
  v_pk_add_f32 v[52:53], v[52:53], v[120:121]
  v_cvt_pk_bf16_f32 v116, v52, v53
  v_lshlrev_b32 v120, 16, v117
  v_and_b32 v121, 0xffff0000, v117
  v_pk_add_f32 v[54:55], v[54:55], v[120:121]
  v_cvt_pk_bf16_f32 v117, v54, v55
  v_lshlrev_b32 v120, 16, v118
  v_and_b32 v121, 0xffff0000, v118
  v_pk_add_f32 v[60:61], v[60:61], v[120:121]
  v_cvt_pk_bf16_f32 v118, v60, v61
  v_lshlrev_b32 v120, 16, v119
  v_and_b32 v121, 0xffff0000, v119
  v_pk_add_f32 v[62:63], v[62:63], v[120:121]
  v_cvt_pk_bf16_f32 v119, v62, v63
  buffer_store_dwordx4 v[116:119], v85, s[20:23], s47 offen offset:64 sc1
  s_lshl_b32 s36, s34, 4
  s_lshl_b32 s37, s35, 1
  s_add_u32 s36, s36, s37
  s_add_u32 s36, s36, s33
  s_waitcnt vmcnt(0)
  s_barrier
  s_add_u32 s76, s92, 0x7000000
  s_addc_u32 s77, s93, 0
  s_mov_b32 s78, 0x28000
  s_mov_b32 s79, 0x00020000
  s_cmp_lg_u32 s96, 0
  s_cbranch_scc1 fa_kernel_pub18
  s_lshl_b32 s3, s36, 7
  s_add_u32 s3, s3, 65536
  v_mov_b32 v130, 1
  v_mov_b32 v131, 0
  s_mov_b64 exec, 1
  buffer_store_dword v130, v131, s[76:79], s3 offen sc1
  s_mov_b64 exec, -1
fa_kernel_pub18:
  s_add_u32 s92, s92, 0x8000000
  s_addc_u32 s93, s93, 0
  s_mov_b32 s97, 1
fa_kernel_k1:
  v_mbcnt_lo_u32_b32 v1, -1, 0
  v_mbcnt_hi_u32_b32 v1, -1, v1
  s_lshl_b32 s3, s96, 6
  v_add_u32 v0, s3, v1
  v_and_b32 v2, 15, v1
  v_lshrrev_b32 v3, 4, v1
  s_mov_b32 s21, s96
  s_lshl_b32 s20, s54, 5
  s_add_u32 s20, s20, s55
  s_and_b32 s22, s20, 3
  s_lshl_b32 s22, s22, 2
  s_add_u32 s22, s22, s21
  s_lshl_b32 s22, s22, 6
  s_lshr_b32 s23, s20, 2
  s_add_u32 s22, s22, s23
  v_lshlrev_b32 v5, 9, v3
  v_lshl_add_u32 v5, v2, 2, v5
  s_lshl_b32 s24, s22, 11
  s_add_u32 s25, s24, 0x200000
  s_add_u32 s8, s92, 0x6000000
  s_addc_u32 s9, s93, 0
  s_mov_b32 s10, 0x800000
  s_mov_b32 s11, 0x00020000
  s_add_u32 s12, s92, 0x800000
  s_addc_u32 s13, s93, 0
  s_mov_b32 s14, 0x400000
  s_mov_b32 s15, 0x00020000
  v_lshrrev_b32 v16, 1, v0
  v_and_b32 v17, 1, v0
  v_lshrrev_b32 v6, 2, v0
  v_lshlrev_b32 v6, 14, v6
  v_and_b32 v18, 3, v0
  v_lshl_add_u32 v6, v18, 4, v6
  v_sub_u32 v18, 0x400, v16
  v_cmp_eq_u32 vcc, 1, v17
  s_nop 1
  v_cndmask_b32 v16, v16, v18, vcc
  v_mov_b32 v18, 1
  v_cndmask_b32 v17, v18, -1, vcc
  v_and_b32 v18, 31, v16
  v_bfe_u32 v19, v16, 5, 2
  v_lshlrev_b32 v19, 2, v19
  v_lshl_add_u32 v19, v18, 7, v19
  v_bfe_u32 v18, v16, 1, 3
  v_lshrrev_b32 v16, 7, v16
  v_xor_b32 v10, v16, v18
  v_and_b32 v10, 7, v10
  v_lshl_add_u32 v10, v10, 4, v19
  v_add_u32 v16, v16, v17
  v_xor_b32 v11, v16, v18
  v_and_b32 v11, 7, v11
  v_lshl_add_u32 v11, v11, 4, v19
  v_add_u32 v16, v16, v17
  v_xor_b32 v12, v16, v18
  v_and_b32 v12, 7, v12
  v_lshl_add_u32 v12, v12, 4, v19
  v_add_u32 v16, v16, v17
  v_xor_b32 v13, v16, v18
  v_and_b32 v13, 7, v13
  v_lshl_add_u32 v13, v13, 4, v19
  v_add_u32 v16, v16, v17
  v_xor_b32 v14, v16, v18
  v_and_b32 v14, 7, v14
  v_lshl_add_u32 v14, v14, 4, v19
  v_cmp_gt_u32 vcc, 2, v0
  s_nop 1
  v_cndmask_b32 v10, v10, v14, vcc
  v_lshrrev_b32 v16, 1, v2
  v_xor_b32 v16, v16, v3
  v_lshlrev_b32 v16, 4, v16
  v_lshl_add_u32 v8, v2, 7, v16
  s_lshl_b32 s23, s21, 12
  v_add_u32 v8, s23, v8
  v_xor_b32 v9, 64, v8
  v_cvt_f32_u32 v16, v2
  v_cvt_f32_u32 v17, v3
  v_mul_f32 v17, 0x41000000, v17
  v_add_u32 v8, 114688, v8
  v_add_u32 v9, 114688, v9
  v_add_u32 v10, 114688, v10
  v_add_u32 v11, 114688, v11
  v_add_u32 v12, 114688, v12
  v_add_u32 v13, 114688, v13
  v_add_f32 v18, 0x0, v16
  v_mul_f32 v18, 0x3d000000, v18
  v_mul_f32 v19, v17, v18
  v_mov_b32 v20, v19
  v_cos_f32 v21, v20
  v_sin_f32 v22, v20
  v_mul_f32 v20, 0x3d000000, v20
  v_cvt_pk_bf16_f32 v40, v21, v22
  v_cvt_pk_bf16_f32 v56, -v22, v21
  v_cos_f32 v72, v20
  v_sin_f32 v88, v20
  v_fmamk_f32 v20, v18, 0x40000000, v19
  v_cos_f32 v21, v20
  v_sin_f32 v22, v20
  v_mul_f32 v20, 0x3d000000, v20
  v_cvt_pk_bf16_f32 v41, v21, v22
  v_cvt_pk_bf16_f32 v57, -v22, v21
  v_cos_f32 v73, v20
  v_sin_f32 v89, v20
  v_fmamk_f32 v20, v18, 0x40800000, v19
  v_cos_f32 v21, v20
  v_sin_f32 v22, v20
  v_mul_f32 v20, 0x3d000000, v20
  v_cvt_pk_bf16_f32 v42, v21, v22
  v_cvt_pk_bf16_f32 v58, -v22, v21
  v_cos_f32 v74, v20
  v_sin_f32 v90, v20
  v_fmamk_f32 v20, v18, 0x40c00000, v19
  v_cos_f32 v21, v20
  v_sin_f32 v22, v20
  v_mul_f32 v20, 0x3d000000, v20
  v_cvt_pk_bf16_f32 v43, v21, v22
  v_cvt_pk_bf16_f32 v59, -v22, v21
  v_cos_f32 v75, v20
  v_sin_f32 v91, v20
  v_add_f32 v20, v18, v19
  v_cos_f32 v21, v20
  v_sin_f32 v22, v20
  v_mul_f32 v20, 0x3d000000, v20
  v_cvt_pk_bf16_f32 v48, v21, v22
  v_cvt_pk_bf16_f32 v64, -v22, v21
  v_cos_f32 v80, v20
  v_sin_f32 v96, v20
  v_fmamk_f32 v20, v18, 0x40400000, v19
  v_cos_f32 v21, v20
  v_sin_f32 v22, v20
  v_mul_f32 v20, 0x3d000000, v20
  v_cvt_pk_bf16_f32 v49, v21, v22
  v_cvt_pk_bf16_f32 v65, -v22, v21
  v_cos_f32 v81, v20
  v_sin_f32 v97, v20
  v_fmamk_f32 v20, v18, 0x40a00000, v19
  v_cos_f32 v21, v20
  v_sin_f32 v22, v20
  v_mul_f32 v20, 0x3d000000, v20
  v_cvt_pk_bf16_f32 v50, v21, v22
  v_cvt_pk_bf16_f32 v66, -v22, v21
  v_cos_f32 v82, v20
  v_sin_f32 v98, v20
  v_fmamk_f32 v20, v18, 0x40e00000, v19
  v_cos_f32 v21, v20
  v_sin_f32 v22, v20
  v_mul_f32 v20, 0x3d000000, v20
  v_cvt_pk_bf16_f32 v51, v21, v22
  v_cvt_pk_bf16_f32 v67, -v22, v21
  v_cos_f32 v83, v20
  v_sin_f32 v99, v20
  s_cmp_eq_u32 s97, 0
  s_cbranch_scc1 fa_kernel_w0
fa_kernel_pre:
  v_accvgpr_read_b32 v122, a244
  v_accvgpr_read_b32 v123, a245
  v_accvgpr_read_b32 v124, a246
  v_accvgpr_read_b32 v125, a247
  v_accvgpr_read_b32 v126, a248
  v_accvgpr_read_b32 v127, a249
  v_accvgpr_read_b32 v128, a250
  s_and_b32 s23, s96, 1
  s_add_u32 m0, s52, 0
  s_add_u32 s57, s53, 0
  buffer_load_dwordx4 v122, s[48:51], s57 offen lds
  v_cvt_f32_u32 v104, v2
  v_cvt_f32_u32 v105, v3
  v_mov_b32 v106, s23
  v_cvt_f32_u32 v106, v106
  v_mul_f32 v105, 4.0, v105
  v_fmamk_f32 v115, v106, 0x41800000, v104
  v_and_b32 v113, 1, v3
  v_lshlrev_b32 v112, 31, v113
  v_mul_f32 v107, 0x3d000000, v115
  v_xor_b32 v107, v112, v107
  v_lshrrev_b32 v113, 16, v112
  v_or_b32 v112, v112, v113
  v_and_b32 v113, 2, v3
  v_cvt_f32_u32 v113, v113
  v_add_f32 v113, v113, v113
  v_lshlrev_b32 v114, 31, v2
  v_xor_b32 v114, 0x3e000000, v114
  v_fma_f32 v108, v113, v107, v114
  v_mov_b32 v109, v108
  v_cos_f32 v110, v109
  v_sin_f32 v111, v109
  s_nop 0
  v_cvt_pk_bf16_f32 v120, -v111, v110
  v_cvt_pk_bf16_f32 v121, v110, v111
  v_xor_b32 v120, v112, v120
  v_accvgpr_write_b32 a0, v121
  v_accvgpr_write_b32 a16, v120
  v_add_f32 v109, v107, v108
  v_cos_f32 v110, v109
  s_add_u32 m0, s52, 1024
  s_add_u32 s57, s53, 0
  buffer_load_dwordx4 v123, s[48:51], s57 offen lds
  v_sin_f32 v111, v109
  s_nop 0
  v_cvt_pk_bf16_f32 v120, -v111, v110
  v_cvt_pk_bf16_f32 v121, v110, v111
  v_xor_b32 v120, v112, v120
  v_accvgpr_write_b32 a1, v121
  v_accvgpr_write_b32 a17, v120
  v_fmamk_f32 v109, v107, 0x40000000, v108
  v_cos_f32 v110, v109
  v_sin_f32 v111, v109
  s_nop 0
  v_cvt_pk_bf16_f32 v120, -v111, v110
  v_cvt_pk_bf16_f32 v121, v110, v111
  v_xor_b32 v120, v112, v120
  v_accvgpr_write_b32 a2, v121
  v_accvgpr_write_b32 a18, v120
  v_fmamk_f32 v109, v107, 0x40400000, v108
  v_cos_f32 v110, v109
  v_sin_f32 v111, v109
  s_nop 0
  v_cvt_pk_bf16_f32 v120, -v111, v110
  v_cvt_pk_bf16_f32 v121, v110, v111
  v_xor_b32 v120, v112, v120
  v_accvgpr_write_b32 a3, v121
  s_add_u32 m0, s52, 2048
  s_add_u32 s57, s53, 0
  buffer_load_dwordx4 v124, s[48:51], s57 offen lds
  v_accvgpr_write_b32 a19, v120
  v_fmamk_f32 v109, v107, 0x41000000, v108
  v_cos_f32 v110, v109
  v_sin_f32 v111, v109
  s_nop 0
  v_cvt_pk_bf16_f32 v120, -v111, v110
  v_cvt_pk_bf16_f32 v121, v110, v111
  v_xor_b32 v120, v112, v120
  v_accvgpr_write_b32 a4, v121
  v_accvgpr_write_b32 a20, v120
  v_fmamk_f32 v109, v107, 0x41100000, v108
  v_cos_f32 v110, v109
  v_sin_f32 v111, v109
  s_nop 0
  v_cvt_pk_bf16_f32 v120, -v111, v110
  v_cvt_pk_bf16_f32 v121, v110, v111
  v_xor_b32 v120, v112, v120
  v_accvgpr_write_b32 a5, v121
  v_accvgpr_write_b32 a21, v120
  v_fmamk_f32 v109, v107, 0x41200000, v108
  v_cos_f32 v110, v109
  v_sin_f32 v111, v109
  s_nop 0
  v_cvt_pk_bf16_f32 v120, -v111, v110
  s_add_u32 m0, s52, 3072
  s_add_u32 s57, s53, 0
  buffer_load_dwordx4 v125, s[48:51], s57 offen lds
  v_cvt_pk_bf16_f32 v121, v110, v111
  v_xor_b32 v120, v112, v120
  v_accvgpr_write_b32 a6, v121
  v_accvgpr_write_b32 a22, v120
  v_fmamk_f32 v109, v107, 0x41300000, v108
  v_cos_f32 v110, v109
  v_sin_f32 v111, v109
  s_nop 0
  v_cvt_pk_bf16_f32 v120, -v111, v110
  v_cvt_pk_bf16_f32 v121, v110, v111
  v_xor_b32 v120, v112, v120
  v_accvgpr_write_b32 a7, v121
  v_accvgpr_write_b32 a23, v120
  v_fmamk_f32 v109, v107, 0x3f000000, v108
  v_cos_f32 v110, v109
  v_sin_f32 v111, v109
  s_nop 0
  v_cvt_pk_bf16_f32 v120, -v111, v110
  v_cvt_pk_bf16_f32 v121, v110, v111
  v_xor_b32 v120, v112, v120
  v_accvgpr_write_b32 a8, v121
  v_accvgpr_write_b32 a24, v120
  v_fmamk_f32 v109, v107, 0x3fc00000, v108
  v_cos_f32 v110, v109
  v_sin_f32 v111, v109
  s_add_u32 m0, s52, 4096
  s_add_u32 s57, s53, 0
  buffer_load_dwordx4 v126, s[48:51], s57 offen lds
  s_nop 0
  v_cvt_pk_bf16_f32 v120, -v111, v110
  v_cvt_pk_bf16_f32 v121, v110, v111
  v_xor_b32 v120, v112, v120
  v_accvgpr_write_b32 a9, v121
  v_accvgpr_write_b32 a25, v120
  v_fmamk_f32 v109, v107, 0x40200000, v108
  v_cos_f32 v110, v109
  v_sin_f32 v111, v109
  s_nop 0
  v_cvt_pk_bf16_f32 v120, -v111, v110
  v_cvt_pk_bf16_f32 v121, v110, v111
  v_xor_b32 v120, v112, v120
  v_accvgpr_write_b32 a10, v121
  v_accvgpr_write_b32 a26, v120
  v_fmamk_f32 v109, v107, 0x40600000, v108
  v_cos_f32 v110, v109
  v_sin_f32 v111, v109
  s_nop 0
  v_cvt_pk_bf16_f32 v120, -v111, v110
  v_cvt_pk_bf16_f32 v121, v110, v111
  v_xor_b32 v120, v112, v120
  v_accvgpr_write_b32 a11, v121
  v_accvgpr_write_b32 a27, v120
  v_fmamk_f32 v109, v107, 0x41080000, v108
  v_cos_f32 v110, v109
  s_add_u32 m0, s52, 5120
  s_add_u32 s57, s53, 0
  buffer_load_dwordx4 v127, s[48:51], s57 offen lds
  v_sin_f32 v111, v109
  s_nop 0
  v_cvt_pk_bf16_f32 v120, -v111, v110
  v_cvt_pk_bf16_f32 v121, v110, v111
  v_xor_b32 v120, v112, v120
  v_accvgpr_write_b32 a12, v121
  v_accvgpr_write_b32 a28, v120
  v_fmamk_f32 v109, v107, 0x41180000, v108
  v_cos_f32 v110, v109
  v_sin_f32 v111, v109
  s_nop 0
  v_cvt_pk_bf16_f32 v120, -v111, v110
  v_cvt_pk_bf16_f32 v121, v110, v111
  v_xor_b32 v120, v112, v120
  v_accvgpr_write_b32 a13, v121
  v_accvgpr_write_b32 a29, v120
  v_fmamk_f32 v109, v107, 0x41280000, v108
  v_cos_f32 v110, v109
  v_sin_f32 v111, v109
  s_nop 0
  v_cvt_pk_bf16_f32 v120, -v111, v110
  v_cvt_pk_bf16_f32 v121, v110, v111
  v_xor_b32 v120, v112, v120
  v_accvgpr_write_b32 a14, v121
  s_add_u32 m0, s52, 6144
  s_add_u32 s57, s53, 0
  buffer_load_dwordx4 v128, s[48:51], s57 offen lds
  v_accvgpr_write_b32 a30, v120
  v_fmamk_f32 v109, v107, 0x41380000, v108
  v_cos_f32 v110, v109
  v_sin_f32 v111, v109
  s_nop 0
  v_cvt_pk_bf16_f32 v120, -v111, v110
  v_cvt_pk_bf16_f32 v121, v110, v111
  v_xor_b32 v120, v112, v120
  v_accvgpr_write_b32 a15, v121
  v_accvgpr_write_b32 a31, v120
  v_add_f32 v107, 0x0, v115
  v_mul_f32 v107, 0x3a000000, v107
  v_mul_f32 v108, v105, v107
  v_mov_b32 v109, v108
  v_cos_f32 v184, v109
  v_sin_f32 v200, v109
  v_add_f32 v109, v107, v108
  v_cos_f32 v185, v109
  v_sin_f32 v201, v109
  v_fmamk_f32 v109, v107, 0x40000000, v108
  v_cos_f32 v186, v109
  v_sin_f32 v202, v109
  s_add_u32 m0, s52, 28672
  s_add_u32 s57, s53, 458752
  buffer_load_dwordx4 v122, s[48:51], s57 offen lds
  v_fmamk_f32 v109, v107, 0x40400000, v108
  v_cos_f32 v187, v109
  v_sin_f32 v203, v109
  v_fmamk_f32 v109, v107, 0x41800000, v108
  v_cos_f32 v188, v109
  v_sin_f32 v204, v109
  v_fmamk_f32 v109, v107, 0x41880000, v108
  v_cos_f32 v189, v109
  v_sin_f32 v205, v109
  v_fmamk_f32 v109, v107, 0x41900000, v108
  v_cos_f32 v190, v109
  v_sin_f32 v206, v109
  v_fmamk_f32 v109, v107, 0x41980000, v108
  v_cos_f32 v191, v109
  v_sin_f32 v207, v109
  v_add_f32 v107, 0x42000000, v115
  v_mul_f32 v107, 0x3a000000, v107
  v_mul_f32 v108, v105, v107
  v_mov_b32 v109, v108
  v_cos_f32 v192, v109
  s_add_u32 m0, s52, 29696
  s_add_u32 s57, s53, 458752
  buffer_load_dwordx4 v123, s[48:51], s57 offen lds
  v_sin_f32 v208, v109
  v_add_f32 v109, v107, v108
  v_cos_f32 v193, v109
  v_sin_f32 v209, v109
  v_fmamk_f32 v109, v107, 0x40000000, v108
  v_cos_f32 v194, v109
  v_sin_f32 v210, v109
  v_fmamk_f32 v109, v107, 0x40400000, v108
  v_cos_f32 v195, v109
  v_sin_f32 v211, v109
  v_fmamk_f32 v109, v107, 0x41800000, v108
  v_cos_f32 v196, v109
  v_sin_f32 v212, v109
  v_fmamk_f32 v109, v107, 0x41880000, v108
  v_cos_f32 v197, v109
  v_sin_f32 v213, v109
  v_fmamk_f32 v109, v107, 0x41900000, v108
  v_cos_f32 v198, v109
  s_add_u32 m0, s52, 30720
  s_add_u32 s57, s53, 458752
  buffer_load_dwordx4 v124, s[48:51], s57 offen lds
  v_sin_f32 v214, v109
  v_fmamk_f32 v109, v107, 0x41980000, v108
  v_cos_f32 v199, v109
  v_sin_f32 v215, v109
  v_add_f32 v107, 0x0, v104
  v_mul_f32 v107, 0x3d000000, v107
  v_mul_f32 v108, v105, v107
  v_mov_b32 v109, v108
  v_cos_f32 v110, v109
  v_sin_f32 v111, v109
  s_nop 0
  v_cvt_pk_bf16_f32 v120, v110, v111
  v_cvt_pk_bf16_f32 v121, -v111, v110
  v_accvgpr_write_b32 a32, v120
  v_accvgpr_write_b32 a48, v121
  v_add_f32 v109, v107, v108
  v_cos_f32 v110, v109
  v_sin_f32 v111, v109
  s_nop 0
  v_cvt_pk_bf16_f32 v120, v110, v111
  v_cvt_pk_bf16_f32 v121, -v111, v110
  v_accvgpr_write_b32 a33, v120
  v_accvgpr_write_b32 a49, v121
  s_add_u32 m0, s52, 31744
  s_add_u32 s57, s53, 458752
  buffer_load_dwordx4 v125, s[48:51], s57 offen lds
  v_fmamk_f32 v109, v107, 0x40000000, v108
  v_cos_f32 v110, v109
  v_sin_f32 v111, v109
  s_nop 0
  v_cvt_pk_bf16_f32 v120, v110, v111
  v_cvt_pk_bf16_f32 v121, -v111, v110
  v_accvgpr_write_b32 a34, v120
  v_accvgpr_write_b32 a50, v121
  v_fmamk_f32 v109, v107, 0x40400000, v108
  v_cos_f32 v110, v109
  v_sin_f32 v111, v109
  s_nop 0
  v_cvt_pk_bf16_f32 v120, v110, v111
  v_cvt_pk_bf16_f32 v121, -v111, v110
  v_accvgpr_write_b32 a35, v120
  v_accvgpr_write_b32 a51, v121
  v_fmamk_f32 v109, v107, 0x41800000, v108
  v_cos_f32 v110, v109
  v_sin_f32 v111, v109
  s_nop 0
  v_cvt_pk_bf16_f32 v120, v110, v111
  v_cvt_pk_bf16_f32 v121, -v111, v110
  v_accvgpr_write_b32 a40, v120
  v_accvgpr_write_b32 a56, v121
  s_add_u32 m0, s52, 32768
  s_add_u32 s57, s53, 458752
  buffer_load_dwordx4 v126, s[48:51], s57 offen lds
  v_fmamk_f32 v109, v107, 0x41880000, v108
  v_cos_f32 v110, v109
  v_sin_f32 v111, v109
  s_nop 0
  v_cvt_pk_bf16_f32 v120, v110, v111
  v_cvt_pk_bf16_f32 v121, -v111, v110
  v_accvgpr_write_b32 a41, v120
  v_accvgpr_write_b32 a57, v121
  v_fmamk_f32 v109, v107, 0x41900000, v108
  v_cos_f32 v110, v109
  v_sin_f32 v111, v109
  s_nop 0
  v_cvt_pk_bf16_f32 v120, v110, v111
  v_cvt_pk_bf16_f32 v121, -v111, v110
  v_accvgpr_write_b32 a42, v120
  v_accvgpr_write_b32 a58, v121
  v_fmamk_f32 v109, v107, 0x41980000, v108
  v_cos_f32 v110, v109
  v_sin_f32 v111, v109
  s_nop 0
  v_cvt_pk_bf16_f32 v120, v110, v111
  v_cvt_pk_bf16_f32 v121, -v111, v110
  v_accvgpr_write_b32 a43, v120
  v_accvgpr_write_b32 a59, v121
  v_add_f32 v107, 0x41800000, v104
  s_add_u32 m0, s52, 33792
  s_add_u32 s57, s53, 458752
  buffer_load_dwordx4 v127, s[48:51], s57 offen lds
  v_mul_f32 v107, 0x3d000000, v107
  v_mul_f32 v108, v105, v107
  v_mov_b32 v109, v108
  v_cos_f32 v110, v109
  v_sin_f32 v111, v109
  s_nop 0
  v_cvt_pk_bf16_f32 v120, v110, v111
  v_cvt_pk_bf16_f32 v121, -v111, v110
  v_accvgpr_write_b32 a36, v120
  v_accvgpr_write_b32 a52, v121
  v_add_f32 v109, v107, v108
  v_cos_f32 v110, v109
  v_sin_f32 v111, v109
  s_nop 0
  v_cvt_pk_bf16_f32 v120, v110, v111
  v_cvt_pk_bf16_f32 v121, -v111, v110
  v_accvgpr_write_b32 a37, v120
  v_accvgpr_write_b32 a53, v121
  v_fmamk_f32 v109, v107, 0x40000000, v108
  v_cos_f32 v110, v109
  v_sin_f32 v111, v109
  s_nop 0
  v_cvt_pk_bf16_f32 v120, v110, v111
  v_cvt_pk_bf16_f32 v121, -v111, v110
  s_add_u32 m0, s52, 34816
  s_add_u32 s57, s53, 458752
  buffer_load_dwordx4 v128, s[48:51], s57 offen lds
  v_accvgpr_write_b32 a38, v120
  v_accvgpr_write_b32 a54, v121
  v_fmamk_f32 v109, v107, 0x40400000, v108
  v_cos_f32 v110, v109
  v_sin_f32 v111, v109
  s_nop 0
  v_cvt_pk_bf16_f32 v120, v110, v111
  v_cvt_pk_bf16_f32 v121, -v111, v110
  v_accvgpr_write_b32 a39, v120
  v_accvgpr_write_b32 a55, v121
  v_fmamk_f32 v109, v107, 0x41800000, v108
  v_cos_f32 v110, v109
  v_sin_f32 v111, v109
  s_nop 0
  v_cvt_pk_bf16_f32 v120, v110, v111
  v_cvt_pk_bf16_f32 v121, -v111, v110
  v_accvgpr_write_b32 a44, v120
  v_accvgpr_write_b32 a60, v121
  v_fmamk_f32 v109, v107, 0x41880000, v108
  v_cos_f32 v110, v109
  v_sin_f32 v111, v109
  s_nop 0
  v_cvt_pk_bf16_f32 v120, v110, v111
  v_cvt_pk_bf16_f32 v121, -v111, v110
  v_accvgpr_write_b32 a45, v120
  v_accvgpr_write_b32 a61, v121
  v_fmamk_f32 v109, v107, 0x41900000, v108
  v_cos_f32 v110, v109
  v_sin_f32 v111, v109
  s_nop 0
  v_cvt_pk_bf16_f32 v120, v110, v111
  v_cvt_pk_bf16_f32 v121, -v111, v110
  v_accvgpr_write_b32 a46, v120
  v_accvgpr_write_b32 a62, v121
  v_fmamk_f32 v109, v107, 0x41980000, v108
  v_cos_f32 v110, v109
  v_sin_f32 v111, v109
  s_nop 0
  v_cvt_pk_bf16_f32 v120, v110, v111
  v_cvt_pk_bf16_f32 v121, -v111, v110
  v_accvgpr_write_b32 a47, v120
  v_accvgpr_write_b32 a63, v121
  s_cmp_eq_u32 s97, 0
  s_cbranch_scc1 fa_kernel_k2x
  s_and_b32 s36, s20, 0xf0
  s_cmp_lg_u32 s96, 0
  s_cbranch_scc1 fa_kernel_pe21
  v_mbcnt_lo_u32_b32 v251, -1, 0
  v_lshlrev_b32 v251, 7, v251
  s_lshl_b32 s3, s36, 7
  s_add_u32 s3, s3, 65536
  s_mov_b64 exec, 0xffff
  s_mov_b32 s80, 0x40000
fa_kernel_pl19:
  buffer_load_dword v250, v251, s[76:79], s3 offen sc1
  s_waitcnt vmcnt(0)
  v_cmp_gt_u32 vcc, 1, v250
  s_cbranch_vccz fa_kernel_pd20
  s_sub_u32 s80, s80, 1
  s_cmp_lg_u32 s80, 0
  s_cbranch_scc1 fa_kernel_pl19
fa_kernel_pd20:
  s_mov_b64 exec, -1
fa_kernel_pe21:
  s_barrier
  buffer_load_dword v24, v5, s[8:11], s24 offen offset:0 sc1
  buffer_load_dword v25, v5, s[8:11], s24 offen offset:128 sc1
  buffer_load_dword v26, v5, s[8:11], s24 offen offset:256 sc1
  buffer_load_dword v27, v5, s[8:11], s24 offen offset:384 sc1
  buffer_load_dword v28, v5, s[8:11], s24 offen offset:64 sc1
  buffer_load_dword v29, v5, s[8:11], s24 offen offset:192 sc1
  buffer_load_dword v30, v5, s[8:11], s24 offen offset:320 sc1
  buffer_load_dword v31, v5, s[8:11], s24 offen offset:448 sc1
  s_add_u32 s24, s24, 0x400000
  buffer_load_dword v136, v5, s[8:11], s24 offen offset:0 sc1
  buffer_load_dword v137, v5, s[8:11], s24 offen offset:128 sc1
  buffer_load_dword v138, v5, s[8:11], s24 offen offset:256 sc1
  buffer_load_dword v139, v5, s[8:11], s24 offen offset:384 sc1
  buffer_load_dword v140, v5, s[8:11], s24 offen offset:64 sc1
  buffer_load_dword v141, v5, s[8:11], s24 offen offset:192 sc1
  buffer_load_dword v142, v5, s[8:11], s24 offen offset:320 sc1
  buffer_load_dword v143, v5, s[8:11], s24 offen offset:448 sc1
  buffer_load_dword v32, v5, s[8:11], s25 offen offset:0 sc1
  buffer_load_dword v33, v5, s[8:11], s25 offen offset:128 sc1
  buffer_load_dword v34, v5, s[8:11], s25 offen offset:256 sc1
  buffer_load_dword v35, v5, s[8:11], s25 offen offset:384 sc1
  buffer_load_dword v36, v5, s[8:11], s25 offen offset:64 sc1
  buffer_load_dword v37, v5, s[8:11], s25 offen offset:192 sc1
  buffer_load_dword v38, v5, s[8:11], s25 offen offset:320 sc1
  buffer_load_dword v39, v5, s[8:11], s25 offen offset:448 sc1
  s_add_u32 s25, s25, 0x400000
  buffer_load_dword v144, v5, s[8:11], s25 offen offset:0 sc1
  buffer_load_dword v145, v5, s[8:11], s25 offen offset:128 sc1
  buffer_load_dword v146, v5, s[8:11], s25 offen offset:256 sc1
  buffer_load_dword v147, v5, s[8:11], s25 offen offset:384 sc1
  buffer_load_dword v148, v5, s[8:11], s25 offen offset:64 sc1
  buffer_load_dword v149, v5, s[8:11], s25 offen offset:192 sc1
  buffer_load_dword v150, v5, s[8:11], s25 offen offset:320 sc1
  buffer_load_dword v151, v5, s[8:11], s25 offen offset:448 sc1
fa_kernel_k1c:
  v_add_f32 v18, 0x41800000, v16
  v_mul_f32 v18, 0x3d000000, v18
  v_mul_f32 v19, v17, v18
  v_mov_b32 v20, v19
  v_cos_f32 v21, v20
  v_sin_f32 v22, v20
  v_mul_f32 v20, 0x3d000000, v20
  v_cvt_pk_bf16_f32 v44, v21, v22
  v_cvt_pk_bf16_f32 v60, -v22, v21
  v_cos_f32 v76, v20
  v_sin_f32 v92, v20
  v_fmamk_f32 v20, v18, 0x40000000, v19
  v_cos_f32 v21, v20
  v_sin_f32 v22, v20
  v_mul_f32 v20, 0x3d000000, v20
  v_cvt_pk_bf16_f32 v45, v21, v22
  v_cvt_pk_bf16_f32 v61, -v22, v21
  v_cos_f32 v77, v20
  v_sin_f32 v93, v20
  v_fmamk_f32 v20, v18, 0x40800000, v19
  v_cos_f32 v21, v20
  v_sin_f32 v22, v20
  v_mul_f32 v20, 0x3d000000, v20
  v_cvt_pk_bf16_f32 v46, v21, v22
  v_cvt_pk_bf16_f32 v62, -v22, v21
  v_cos_f32 v78, v20
  v_sin_f32 v94, v20
  v_fmamk_f32 v20, v18, 0x40c00000, v19
  v_cos_f32 v21, v20
  v_sin_f32 v22, v20
  v_mul_f32 v20, 0x3d000000, v20
  v_cvt_pk_bf16_f32 v47, v21, v22
  v_cvt_pk_bf16_f32 v63, -v22, v21
  v_cos_f32 v79, v20
  v_sin_f32 v95, v20
  v_add_f32 v20, v18, v19
  v_cos_f32 v21, v20
  v_sin_f32 v22, v20
  v_mul_f32 v20, 0x3d000000, v20
  v_cvt_pk_bf16_f32 v52, v21, v22
  v_cvt_pk_bf16_f32 v68, -v22, v21
  v_cos_f32 v84, v20
  v_sin_f32 v100, v20
  v_fmamk_f32 v20, v18, 0x40400000, v19
  v_cos_f32 v21, v20
  v_sin_f32 v22, v20
  v_mul_f32 v20, 0x3d000000, v20
  v_cvt_pk_bf16_f32 v53, v21, v22
  v_cvt_pk_bf16_f32 v69, -v22, v21
  v_cos_f32 v85, v20
  v_sin_f32 v101, v20
  v_fmamk_f32 v20, v18, 0x40a00000, v19
  v_cos_f32 v21, v20
  v_sin_f32 v22, v20
  v_mul_f32 v20, 0x3d000000, v20
  v_cvt_pk_bf16_f32 v54, v21, v22
  v_cvt_pk_bf16_f32 v70, -v22, v21
  v_cos_f32 v86, v20
  v_sin_f32 v102, v20
  v_fmamk_f32 v20, v18, 0x40e00000, v19
  v_cos_f32 v21, v20
  v_sin_f32 v22, v20
  v_mul_f32 v20, 0x3d000000, v20
  v_cvt_pk_bf16_f32 v55, v21, v22
  v_cvt_pk_bf16_f32 v71, -v22, v21
  v_cos_f32 v87, v20
  v_sin_f32 v103, v20
  s_cmp_eq_u32 s97, 0
  s_cbranch_scc1 fa_kernel_k1w22
  s_waitcnt vmcnt(16)
fa_kernel_k1w22:
  v_lshlrev_b32 v104, 16, v24
  v_and_b32 v106, 0xffff0000, v24
  v_lshlrev_b32 v152, 16, v136
  v_and_b32 v154, 0xffff0000, v136
  v_lshlrev_b32 v108, 16, v25
  v_and_b32 v110, 0xffff0000, v25
  v_lshlrev_b32 v156, 16, v137
  v_and_b32 v158, 0xffff0000, v137
  v_lshlrev_b32 v112, 16, v26
  v_and_b32 v114, 0xffff0000, v26
  v_lshlrev_b32 v160, 16, v138
  v_and_b32 v162, 0xffff0000, v138
  v_lshlrev_b32 v116, 16, v27
  v_and_b32 v118, 0xffff0000, v27
  v_lshlrev_b32 v164, 16, v139
  v_and_b32 v166, 0xffff0000, v139
  v_lshlrev_b32 v120, 16, v28
  v_and_b32 v122, 0xffff0000, v28
  v_lshlrev_b32 v168, 16, v140
  v_and_b32 v170, 0xffff0000, v140
  v_lshlrev_b32 v124, 16, v29
  v_and_b32 v126, 0xffff0000, v29
  v_lshlrev_b32 v172, 16, v141
  v_and_b32 v174, 0xffff0000, v141
  v_lshlrev_b32 v128, 16, v30
  v_and_b32 v130, 0xffff0000, v30
  v_lshlrev_b32 v176, 16, v142
  v_and_b32 v178, 0xffff0000, v142
  v_lshlrev_b32 v132, 16, v31
  v_and_b32 v134, 0xffff0000, v31
  v_lshlrev_b32 v180, 16, v143
  v_and_b32 v182, 0xffff0000, v143
  s_cmp_eq_u32 s97, 0
  s_cbranch_scc1 fa_kernel_k1w23
  s_waitcnt vmcnt(0)
fa_kernel_k1w23:
  v_lshlrev_b32 v105, 16, v32
  v_and_b32 v107, 0xffff0000, v32
  v_lshlrev_b32 v153, 16, v144
  v_and_b32 v155, 0xffff0000, v144
  v_lshlrev_b32 v109, 16, v33
  v_and_b32 v111, 0xffff0000, v33
  v_lshlrev_b32 v157, 16, v145
  v_and_b32 v159, 0xffff0000, v145
  v_lshlrev_b32 v113, 16, v34
  v_and_b32 v115, 0xffff0000, v34
  v_lshlrev_b32 v161, 16, v146
  v_and_b32 v163, 0xffff0000, v146
  v_lshlrev_b32 v117, 16, v35
  v_and_b32 v119, 0xffff0000, v35
  v_lshlrev_b32 v165, 16, v147
  v_and_b32 v167, 0xffff0000, v147
  v_lshlrev_b32 v121, 16, v36
  v_and_b32 v123, 0xffff0000, v36
  v_lshlrev_b32 v169, 16, v148
  v_and_b32 v171, 0xffff0000, v148
  v_lshlrev_b32 v125, 16, v37
  v_and_b32 v127, 0xffff0000, v37
  v_lshlrev_b32 v173, 16, v149
  v_and_b32 v175, 0xffff0000, v149
  v_lshlrev_b32 v129, 16, v38
  v_and_b32 v131, 0xffff0000, v38
  v_lshlrev_b32 v177, 16, v150
  v_and_b32 v179, 0xffff0000, v150
  v_lshlrev_b32 v133, 16, v39
  v_and_b32 v135, 0xffff0000, v39
  v_lshlrev_b32 v181, 16, v151
  v_and_b32 v183, 0xffff0000, v151
  v_pk_add_f32 v[104:105], v[104:105], v[152:153]
  v_pk_add_f32 v[106:107], v[106:107], v[154:155]
  v_pk_add_f32 v[108:109], v[108:109], v[156:157]
  v_pk_add_f32 v[110:111], v[110:111], v[158:159]
  v_pk_add_f32 v[112:113], v[112:113], v[160:161]
  v_pk_add_f32 v[114:115], v[114:115], v[162:163]
  v_pk_add_f32 v[116:117], v[116:117], v[164:165]
  v_pk_add_f32 v[118:119], v[118:119], v[166:167]
  v_pk_add_f32 v[120:121], v[120:121], v[168:169]
  v_pk_add_f32 v[122:123], v[122:123], v[170:171]
  v_pk_add_f32 v[124:125], v[124:125], v[172:173]
  v_pk_add_f32 v[126:127], v[126:127], v[174:175]
  v_pk_add_f32 v[128:129], v[128:129], v[176:177]
  v_pk_add_f32 v[130:131], v[130:131], v[178:179]
  v_pk_add_f32 v[132:133], v[132:133], v[180:181]
  v_pk_add_f32 v[134:135], v[134:135], v[182:183]
  v_pk_add_f32 v[24:25], v[104:105], v[106:107]
  v_pk_add_f32 v[26:27], v[108:109], v[110:111]
  v_pk_add_f32 v[28:29], v[112:113], v[114:115]
  v_pk_add_f32 v[30:31], v[116:117], v[118:119]
  v_pk_add_f32 v[32:33], v[120:121], v[122:123]
  v_pk_add_f32 v[34:35], v[124:125], v[126:127]
  v_pk_add_f32 v[36:37], v[128:129], v[130:131]
  v_pk_add_f32 v[38:39], v[132:133], v[134:135]
  v_pk_add_f32 v[24:25], v[24:25], v[32:33]
  v_pk_add_f32 v[26:27], v[26:27], v[34:35]
  v_pk_add_f32 v[28:29], v[28:29], v[36:37]
  v_pk_add_f32 v[30:31], v[30:31], v[38:39]
  v_pk_add_f32 v[24:25], v[24:25], v[28:29]
  v_pk_add_f32 v[26:27], v[26:27], v[30:31]
  v_pk_add_f32 v[24:25], v[24:25], v[26:27]
  s_nop 1
  v_add_f32_dpp v24, v24, v24 row_shr:1 row_mask:0xf bank_mask:0xf
  v_add_f32_dpp v25, v25, v25 row_shr:1 row_mask:0xf bank_mask:0xf
  s_nop 0
  v_add_f32_dpp v24, v24, v24 row_shr:2 row_mask:0xf bank_mask:0xf
  v_add_f32_dpp v25, v25, v25 row_shr:2 row_mask:0xf bank_mask:0xf
  s_nop 0
  v_add_f32_dpp v24, v24, v24 row_shr:4 row_mask:0xf bank_mask:0xf
  v_add_f32_dpp v25, v25, v25 row_shr:4 row_mask:0xf bank_mask:0xf
  s_nop 0
  v_add_f32_dpp v24, v24, v24 row_shr:8 row_mask:0xf bank_mask:0xf
  v_add_f32_dpp v25, v25, v25 row_shr:8 row_mask:0xf bank_mask:0xf
  s_nop 0
  v_add_f32_dpp v24, v24, v24 row_bcast:15 row_mask:0xa bank_mask:0xf
  v_add_f32_dpp v25, v25, v25 row_bcast:15 row_mask:0xa bank_mask:0xf
  s_nop 0
  v_add_f32_dpp v24, v24, v24 row_bcast:31 row_mask:0xc bank_mask:0xf
  v_add_f32_dpp v25, v25, v25 row_bcast:31 row_mask:0xc bank_mask:0xf
  v_mul_f32 v24, 0xba800000, v24
  v_mul_f32 v25, 0xba800000, v25
  v_readlane_b32 s26, v24, 63
  v_readlane_b32 s27, v25, 63
  s_nop 1
  v_pk_add_f32 v[104:105], v[104:105], s[26:27]
  v_pk_add_f32 v[106:107], v[106:107], s[26:27]
  v_pk_add_f32 v[108:109], v[108:109], s[26:27]
  v_pk_add_f32 v[110:111], v[110:111], s[26:27]
  v_pk_add_f32 v[112:113], v[112:113], s[26:27]
  v_pk_add_f32 v[114:115], v[114:115], s[26:27]
  v_pk_add_f32 v[116:117], v[116:117], s[26:27]
  v_pk_add_f32 v[118:119], v[118:119], s[26:27]
  v_pk_add_f32 v[120:121], v[120:121], s[26:27]
  v_pk_add_f32 v[122:123], v[122:123], s[26:27]
  v_pk_add_f32 v[124:125], v[124:125], s[26:27]
  v_pk_add_f32 v[126:127], v[126:127], s[26:27]
  v_pk_add_f32 v[128:129], v[128:129], s[26:27]
  v_pk_add_f32 v[130:131], v[130:131], s[26:27]
  v_pk_add_f32 v[132:133], v[132:133], s[26:27]
  v_pk_add_f32 v[134:135], v[134:135], s[26:27]
  v_pk_mul_f32 v[24:25], v[104:105], v[104:105]
  v_pk_mul_f32 v[26:27], v[106:107], v[106:107]
  v_pk_mul_f32 v[28:29], v[108:109], v[108:109]
  v_pk_mul_f32 v[30:31], v[110:111], v[110:111]
  v_pk_fma_f32 v[24:25], v[112:113], v[112:113], v[24:25]
  v_pk_fma_f32 v[26:27], v[114:115], v[114:115], v[26:27]
  v_pk_fma_f32 v[28:29], v[116:117], v[116:117], v[28:29]
  v_pk_fma_f32 v[30:31], v[118:119], v[118:119], v[30:31]
  v_pk_fma_f32 v[24:25], v[120:121], v[120:121], v[24:25]
  v_pk_fma_f32 v[26:27], v[122:123], v[122:123], v[26:27]
  v_pk_fma_f32 v[28:29], v[124:125], v[124:125], v[28:29]
  v_pk_fma_f32 v[30:31], v[126:127], v[126:127], v[30:31]
  v_pk_fma_f32 v[24:25], v[128:129], v[128:129], v[24:25]
  v_pk_fma_f32 v[26:27], v[130:131], v[130:131], v[26:27]
  v_pk_fma_f32 v[28:29], v[132:133], v[132:133], v[28:29]
  v_pk_fma_f32 v[30:31], v[134:135], v[134:135], v[30:31]
  v_pk_add_f32 v[24:25], v[24:25], v[28:29]
  v_pk_add_f32 v[26:27], v[26:27], v[30:31]
  v_pk_add_f32 v[24:25], v[24:25], v[26:27]
  s_nop 1
  v_add_f32_dpp v24, v24, v24 row_shr:1 row_mask:0xf bank_mask:0xf
  v_add_f32_dpp v25, v25, v25 row_shr:1 row_mask:0xf bank_mask:0xf
  s_nop 0
  v_add_f32_dpp v24, v24, v24 row_shr:2 row_mask:0xf bank_mask:0xf
  v_add_f32_dpp v25, v25, v25 row_shr:2 row_mask:0xf bank_mask:0xf
  s_nop 0
  v_add_f32_dpp v24, v24, v24 row_shr:4 row_mask:0xf bank_mask:0xf
  v_add_f32_dpp v25, v25, v25 row_shr:4 row_mask:0xf bank_mask:0xf
  s_nop 0
  v_add_f32_dpp v24, v24, v24 row_shr:8 row_mask:0xf bank_mask:0xf
  v_add_f32_dpp v25, v25, v25 row_shr:8 row_mask:0xf bank_mask:0xf
  s_nop 0
  v_add_f32_dpp v24, v24, v24 row_bcast:15 row_mask:0xa bank_mask:0xf
  v_add_f32_dpp v25, v25, v25 row_bcast:15 row_mask:0xa bank_mask:0xf
  s_nop 0
  v_add_f32_dpp v24, v24, v24 row_bcast:31 row_mask:0xc bank_mask:0xf
  v_add_f32_dpp v25, v25, v25 row_bcast:31 row_mask:0xc bank_mask:0xf
  v_mov_b32 v26, 0x3727c5ac
  v_fmamk_f32 v24, v24, 0x3a800000, v26
  v_fmamk_f32 v25, v25, 0x3a800000, v26
  v_rsq_f32 v24, v24
  v_rsq_f32 v25, v25
  v_mul_f32 v24, 0x35000000, v24
  v_mul_f32 v25, 0x35000000, v25
  v_readlane_b32 s26, v24, 63
  v_readlane_b32 s27, v25, 63
  s_nop 1
  v_pk_mul_f32 v[104:105], v[104:105], s[26:27]
  v_pk_mul_f32 v[106:107], v[106:107], s[26:27]
  v_pk_mul_f32 v[108:109], v[108:109], s[26:27]
  v_pk_mul_f32 v[110:111], v[110:111], s[26:27]
  v_pk_mul_f32 v[112:113], v[112:113], s[26:27]
  v_pk_mul_f32 v[114:115], v[114:115], s[26:27]
  v_pk_mul_f32 v[116:117], v[116:117], s[26:27]
  v_pk_mul_f32 v[118:119], v[118:119], s[26:27]
  v_pk_mul_f32 v[120:121], v[120:121], s[26:27]
  v_pk_mul_f32 v[122:123], v[122:123], s[26:27]
  v_pk_mul_f32 v[124:125], v[124:125], s[26:27]
  v_pk_mul_f32 v[126:127], v[126:127], s[26:27]
  v_pk_mul_f32 v[128:129], v[128:129], s[26:27]
  v_pk_mul_f32 v[130:131], v[130:131], s[26:27]
  v_pk_mul_f32 v[132:133], v[132:133], s[26:27]
  v_pk_mul_f32 v[134:135], v[134:135], s[26:27]
  v_cvt_pk_bf16_f32 v136, v104, v105
  v_cvt_pk_bf16_f32 v137, v108, v109
  v_cvt_pk_bf16_f32 v138, v112, v113
  v_cvt_pk_bf16_f32 v139, v116, v117
  v_cvt_pk_bf16_f32 v140, v120, v121
  v_cvt_pk_bf16_f32 v141, v124, v125
  v_cvt_pk_bf16_f32 v142, v128, v129
  v_cvt_pk_bf16_f32 v143, v132, v133
  v_cvt_pk_bf16_f32 v144, v106, v107
  v_cvt_pk_bf16_f32 v145, v110, v111
  v_cvt_pk_bf16_f32 v146, v114, v115
  v_cvt_pk_bf16_f32 v147, v118, v119
  v_cvt_pk_bf16_f32 v148, v122, v123
  v_cvt_pk_bf16_f32 v149, v126, v127
  v_cvt_pk_bf16_f32 v150, v130, v131
  v_cvt_pk_bf16_f32 v151, v134, v135
  v_mfma_f32_16x16x32_bf16 v[152:155], v[136:139], v[40:43], 0
  v_mfma_f32_16x16x32_bf16 v[168:171], v[136:139], v[56:59], 0
  v_mfma_f32_16x16x32_bf16 v[156:159], v[136:139], v[44:47], 0
  v_mfma_f32_16x16x32_bf16 v[172:175], v[136:139], v[60:63], 0
  v_mfma_f32_16x16x32_bf16 v[160:163], v[144:147], v[40:43], 0
  v_mfma_f32_16x16x32_bf16 v[176:179], v[144:147], v[56:59], 0
  v_mfma_f32_16x16x32_bf16 v[164:167], v[144:147], v[44:47], 0
  v_mfma_f32_16x16x32_bf16 v[180:183], v[144:147], v[60:63], 0
  v_mfma_f32_16x16x32_bf16 v[152:155], v[140:143], v[48:51], v[152:155]
  v_mfma_f32_16x16x32_bf16 v[168:171], v[140:143], v[64:67], v[168:171]
  v_mfma_f32_16x16x32_bf16 v[156:159], v[140:143], v[52:55], v[156:159]
  v_mfma_f32_16x16x32_bf16 v[172:175], v[140:143], v[68:71], v[172:175]
  v_mfma_f32_16x16x32_bf16 v[160:163], v[148:151], v[48:51], v[160:163]
  v_mfma_f32_16x16x32_bf16 v[176:179], v[148:151], v[64:67], v[176:179]
  v_mfma_f32_16x16x32_bf16 v[164:167], v[148:151], v[52:55], v[164:167]
  v_mfma_f32_16x16x32_bf16 v[180:183], v[148:151], v[68:71], v[180:183]
  s_nop 0
  v_pk_mul_f32 v[16:17], v[152:153], v[72:73]
  v_pk_mul_f32 v[18:19], v[154:155], v[74:75]
  v_pk_fma_f32 v[16:17], v[168:169], v[88:89], v[16:17]
  v_pk_fma_f32 v[18:19], v[170:171], v[90:91], v[18:19]
  v_pk_mul_f32 v[168:169], v[168:169], v[72:73]
  v_pk_mul_f32 v[170:171], v[170:171], v[74:75]
  v_pk_fma_f32 v[168:169], v[152:153], v[88:89], v[168:169] neg_lo:[0,1,0] neg_hi:[0,1,0]
  v_pk_fma_f32 v[170:171], v[154:155], v[90:91], v[170:171] neg_lo:[0,1,0] neg_hi:[0,1,0]
  v_cvt_pk_bf16_f32 v104, v16, v168
  v_cvt_pk_bf16_f32 v105, v17, v169
  v_cvt_pk_bf16_f32 v106, v18, v170
  v_cvt_pk_bf16_f32 v107, v19, v171
  v_pk_mul_f32 v[16:17], v[156:157], v[76:77]
  v_pk_mul_f32 v[18:19], v[158:159], v[78:79]
  v_pk_fma_f32 v[16:17], v[172:173], v[92:93], v[16:17]
  v_pk_fma_f32 v[18:19], v[174:175], v[94:95], v[18:19]
  v_pk_mul_f32 v[172:173], v[172:173], v[76:77]
  v_pk_mul_f32 v[174:175], v[174:175], v[78:79]
  v_pk_fma_f32 v[172:173], v[156:157], v[92:93], v[172:173] neg_lo:[0,1,0] neg_hi:[0,1,0]
  v_pk_fma_f32 v[174:175], v[158:159], v[94:95], v[174:175] neg_lo:[0,1,0] neg_hi:[0,1,0]
  v_cvt_pk_bf16_f32 v112, v16, v172
  v_cvt_pk_bf16_f32 v113, v17, v173
  v_cvt_pk_bf16_f32 v114, v18, v174
  v_cvt_pk_bf16_f32 v115, v19, v175
  v_pk_mul_f32 v[16:17], v[160:161], v[80:81]
  v_pk_mul_f32 v[18:19], v[162:163], v[82:83]
  v_pk_fma_f32 v[16:17], v[176:177], v[96:97], v[16:17]
  v_pk_fma_f32 v[18:19], v[178:179], v[98:99], v[18:19]
  v_pk_mul_f32 v[176:177], v[176:177], v[80:81]
  v_pk_mul_f32 v[178:179], v[178:179], v[82:83]
  v_pk_fma_f32 v[176:177], v[160:161], v[96:97], v[176:177] neg_lo:[0,1,0] neg_hi:[0,1,0]
  v_pk_fma_f32 v[178:179], v[162:163], v[98:99], v[178:179] neg_lo:[0,1,0] neg_hi:[0,1,0]
  v_cvt_pk_bf16_f32 v108, v16, v176
  v_cvt_pk_bf16_f32 v109, v17, v177
  v_cvt_pk_bf16_f32 v110, v18, v178
  v_cvt_pk_bf16_f32 v111, v19, v179
  v_pk_mul_f32 v[16:17], v[164:165], v[84:85]
  v_pk_mul_f32 v[18:19], v[166:167], v[86:87]
  v_pk_fma_f32 v[16:17], v[180:181], v[100:101], v[16:17]
  v_pk_fma_f32 v[18:19], v[182:183], v[102:103], v[18:19]
  v_pk_mul_f32 v[180:181], v[180:181], v[84:85]
  v_pk_mul_f32 v[182:183], v[182:183], v[86:87]
  v_pk_fma_f32 v[180:181], v[164:165], v[100:101], v[180:181] neg_lo:[0,1,0] neg_hi:[0,1,0]
  v_pk_fma_f32 v[182:183], v[166:167], v[102:103], v[182:183] neg_lo:[0,1,0] neg_hi:[0,1,0]
  v_cvt_pk_bf16_f32 v116, v16, v180
  v_cvt_pk_bf16_f32 v117, v17, v181
  v_cvt_pk_bf16_f32 v118, v18, v182
  v_cvt_pk_bf16_f32 v119, v19, v183
  v_mfma_f32_16x16x32_bf16 v[72:75], v[40:43], v[104:107], 0
  v_mfma_f32_16x16x32_bf16 v[88:91], v[56:59], v[104:107], 0
  v_mfma_f32_16x16x32_bf16 v[76:79], v[44:47], v[104:107], 0
  v_mfma_f32_16x16x32_bf16 v[92:95], v[60:63], v[104:107], 0
  v_mfma_f32_16x16x32_bf16 v[80:83], v[40:43], v[112:115], 0
  v_mfma_f32_16x16x32_bf16 v[96:99], v[56:59], v[112:115], 0
  v_mfma_f32_16x16x32_bf16 v[84:87], v[44:47], v[112:115], 0
  v_mfma_f32_16x16x32_bf16 v[100:103], v[60:63], v[112:115], 0
  v_mfma_f32_16x16x32_bf16 v[72:75], v[48:51], v[108:111], v[72:75]
  v_mfma_f32_16x16x32_bf16 v[88:91], v[64:67], v[108:111], v[88:91]
  v_mfma_f32_16x16x32_bf16 v[76:79], v[52:55], v[108:111], v[76:79]
  v_mfma_f32_16x16x32_bf16 v[92:95], v[68:71], v[108:111], v[92:95]
  v_mfma_f32_16x16x32_bf16 v[80:83], v[48:51], v[116:119], v[80:83]
  v_mfma_f32_16x16x32_bf16 v[96:99], v[64:67], v[116:119], v[96:99]
  v_mfma_f32_16x16x32_bf16 v[84:87], v[52:55], v[116:119], v[84:87]
  v_mfma_f32_16x16x32_bf16 v[100:103], v[68:71], v[116:119], v[100:103]
  s_nop 1
  v_cvt_pk_bf16_f32 v136, v72, v88
  v_cvt_pk_bf16_f32 v137, v73, v89
  v_cvt_pk_bf16_f32 v138, v74, v90
  v_cvt_pk_bf16_f32 v139, v75, v91
  ds_write_b128 v8, v[136:139] offset:0
  v_cvt_pk_bf16_f32 v140, v76, v92
  v_cvt_pk_bf16_f32 v141, v77, v93
  v_cvt_pk_bf16_f32 v142, v78, v94
  v_cvt_pk_bf16_f32 v143, v79, v95
  ds_write_b128 v9, v[140:143] offset:0
  v_cvt_pk_bf16_f32 v144, v80, v96
  v_cvt_pk_bf16_f32 v145, v81, v97
  v_cvt_pk_bf16_f32 v146, v82, v98
  v_cvt_pk_bf16_f32 v147, v83, v99
  ds_write_b128 v8, v[144:147] offset:2048
  v_cvt_pk_bf16_f32 v148, v84, v100
  v_cvt_pk_bf16_f32 v149, v85, v101
  v_cvt_pk_bf16_f32 v150, v86, v102
  v_cvt_pk_bf16_f32 v151, v87, v103
  ds_write_b128 v9, v[148:151] offset:2048
  s_lshl_b32 s24, s20, 6
  s_waitcnt vmcnt(1) lgkmcnt(0)
  s_barrier
  ds_read2st64_b32 v[104:105], v10 offset0:0 offset1:16
  ds_read2st64_b32 v[106:107], v10 offset0:32 offset1:48
  ds_read2st64_b32 v[108:109], v11 offset0:0 offset1:16
  ds_read2st64_b32 v[110:111], v11 offset0:32 offset1:48
  ds_read2st64_b32 v[112:113], v12 offset0:0 offset1:16
  ds_read2st64_b32 v[114:115], v12 offset0:32 offset1:48
  ds_read2st64_b32 v[116:117], v13 offset0:0 offset1:16
  ds_read2st64_b32 v[118:119], v13 offset0:32 offset1:48
  s_waitcnt lgkmcnt(6)
  buffer_store_dwordx4 v[104:107], v6, s[12:15], s24 offen sc1
  s_add_u32 s24, s24, 0x100000
  s_waitcnt lgkmcnt(4)
  buffer_store_dwordx4 v[108:111], v6, s[12:15], s24 offen sc1
  s_add_u32 s24, s24, 0x100000
  s_waitcnt lgkmcnt(2)
  buffer_store_dwordx4 v[112:115], v6, s[12:15], s24 offen sc1
  s_add_u32 s24, s24, 0x100000
  s_waitcnt lgkmcnt(0)
  buffer_store_dwordx4 v[116:119], v6, s[12:15], s24 offen sc1
  s_cmp_eq_u32 s97, 0
  s_cbranch_scc1 fa_kernel_w1
  s_waitcnt vmcnt(0)
  s_barrier
  s_add_u32 s76, s92, 0x7000000
  s_addc_u32 s77, s93, 0
  s_mov_b32 s78, 0x28000
  s_mov_b32 s79, 0x00020000
  s_cmp_lg_u32 s96, 0
  s_cbranch_scc1 fa_kernel_pub24
  s_and_b32 s3, s20, 31
  s_lshl_b32 s3, s3, 7
  s_add_u32 s3, s3, 131072
  v_mov_b32 v250, 1
  v_mov_b32 v251, 0
  s_mov_b64 exec, 1
  buffer_atomic_add v250, v251, s[76:79], s3 offen sc1
  s_mov_b64 exec, -1
fa_kernel_pub24:
  v_mbcnt_lo_u32_b32 v1, -1, 0
  v_mbcnt_hi_u32_b32 v1, -1, v1
  s_lshl_b32 s3, s96, 6
  v_add_u32 v0, s3, v1
  v_and_b32 v2, 15, v1
  v_lshrrev_b32 v3, 4, v1
  s_lshl_b32 s20, s54, 5
  s_add_u32 s20, s20, s55
  s_mov_b32 s21, s96
  v_lshlrev_b32 v248, 7, v2
  v_lshl_add_u32 v248, v3, 4, v248
  v_lshlrev_b32 v6, 4, v1
  s_lshr_b32 s22, s21, 1
  s_and_b32 s23, s21, 1
  s_lshl_b32 s24, s20, 1
  s_add_u32 s24, s24, s22
  s_lshl_b32 s28, s20, 14
  s_lshl_b32 s25, s21, 12
  s_add_u32 s28, s28, s25
  v_xor_b32 v8, v2, v3
  v_lshlrev_b32 v8, 4, v8
  v_lshl_add_u32 v249, v3, 8, v8
  s_add_u32 s25, s25, 131072
  v_add_u32 v249, s25, v249
  v_lshrrev_b32 v8, 1, v3
  v_and_b32 v9, 1, v3
  v_lshl_add_u32 v8, v8, 2, v9
  s_lshl_b32 s25, s22, 1
  v_add_u32 v8, s25, v8
  v_xor_b32 v8, v8, v2
  v_lshlrev_b32 v8, 4, v8
  v_lshl_add_u32 v5, v2, 8, v8
  v_add_u32 v5, 131072, v5
  s_lshl_b32 s24, s24, 13
  s_lshl_b32 s26, s23, 12
  s_add_u32 s26, s26, s24
  s_lshl_b32 s27, s21, 11
  s_add_u32 s27, s27, 147456
  v_add_u32 v7, s27, v6
  s_add_u32 s12, s92, 0x800000
  s_addc_u32 s13, s93, 0
  s_mov_b32 s14, 0x400000
  s_mov_b32 s15, 0x00020000
  s_mov_b32 s16, s82
  s_mov_b32 s17, s83
  s_mov_b32 s18, 0x400000
  s_mov_b32 s19, 0x00020000
  s_add_u32 s8, s92, 0x1800000
  s_addc_u32 s9, s93, 0
  s_mov_b32 s10, 0x400000
  s_mov_b32 s11, 0x00020000
  buffer_load_dwordx4 v[56:59], v6, s[16:19], s26 offen offset:0 sc1
  buffer_load_dwordx4 v[60:63], v6, s[16:19], s26 offen offset:1024 sc1
  buffer_load_dwordx4 v[64:67], v6, s[16:19], s26 offen offset:2048 sc1
  buffer_load_dwordx4 v[68:71], v6, s[16:19], s26 offen offset:3072 sc1
  s_branch fa_kernel_k2w
fa_kernel_xch17:
  s_add_u32 s20, s92, 0x6800000
  s_addc_u32 s21, s93, 0
  s_mov_b32 s22, 0x800000
  s_mov_b32 s23, 0x00020000
  s_lshl_b32 s36, s2, 15
  s_lshl_b32 s37, s96, 13
  s_add_u32 s36, s36, s37
  s_add_u32 s37, s36, 4096
  s_nop 4
  buffer_store_dwordx4 v[32:35], v64, s[20:23], s36 offen offset:0 sc1
  buffer_store_dwordx4 v[36:39], v64, s[20:23], s36 offen offset:1024 sc1
  buffer_store_dwordx4 v[40:43], v64, s[20:23], s36 offen offset:2048 sc1
  buffer_store_dwordx4 v[44:47], v64, s[20:23], s36 offen offset:3072 sc1
  buffer_store_dwordx4 v[48:51], v64, s[20:23], s37 offen offset:0 sc1
  buffer_store_dwordx4 v[52:55], v64, s[20:23], s37 offen offset:1024 sc1
  buffer_store_dwordx4 v[56:59], v64, s[20:23], s37 offen offset:2048 sc1
  buffer_store_dwordx4 v[60:63], v64, s[20:23], s37 offen offset:3072 sc1
  s_waitcnt vmcnt(0)
  s_barrier
  s_add_u32 s76, s92, 0x7000000
  s_addc_u32 s77, s93, 0
  s_mov_b32 s78, 0x28000
  s_mov_b32 s79, 0x00020000
  s_cmp_lg_u32 s96, 0
  s_cbranch_scc1 fa_kernel_pub25
  s_lshl_b32 s3, s2, 7
  s_add_u32 s3, s3, 65536
  v_mov_b32 v130, 1
  v_mov_b32 v131, 0
  s_mov_b64 exec, 1
  buffer_store_dword v130, v131, s[76:79], s3 offen sc1
  s_mov_b64 exec, -1
fa_kernel_pub25:
  s_xor_b32 s38, s2, 1
  s_xor_b32 s36, s36, 0x8000
  s_xor_b32 s37, s37, 0x8000
  s_cmp_lg_u32 s96, 0
  s_cbranch_scc1 fa_kernel_pe28
  v_mbcnt_lo_u32_b32 v131, -1, 0
  v_lshlrev_b32 v131, 7, v131
  s_lshl_b32 s3, s38, 7
  s_add_u32 s3, s3, 65536
  s_mov_b64 exec, 0x1
  s_mov_b32 s80, 0x40000
fa_kernel_pl26:
  buffer_load_dword v130, v131, s[76:79], s3 offen sc1
  s_waitcnt vmcnt(0)
  v_cmp_gt_u32 vcc, 1, v130
  s_cbranch_vccz fa_kernel_pd27
  s_sub_u32 s80, s80, 1
  s_cmp_lg_u32 s80, 0
  s_cbranch_scc1 fa_kernel_pl26
fa_kernel_pd27:
  s_mov_b64 exec, -1
fa_kernel_pe28:
  s_barrier
  buffer_load_dwordx4 v[32:35], v64, s[20:23], s36 offen offset:0 sc1
  buffer_load_dwordx4 v[36:39], v64, s[20:23], s36 offen offset:1024 sc1
  buffer_load_dwordx4 v[40:43], v64, s[20:23], s36 offen offset:2048 sc1
  buffer_load_dwordx4 v[44:47], v64, s[20:23], s36 offen offset:3072 sc1
  buffer_load_dwordx4 v[48:51], v64, s[20:23], s37 offen offset:0 sc1
  buffer_load_dwordx4 v[52:55], v64, s[20:23], s37 offen offset:1024 sc1
  buffer_load_dwordx4 v[56:59], v64, s[20:23], s37 offen offset:2048 sc1
  buffer_load_dwordx4 v[60:63], v64, s[20:23], s37 offen offset:3072 sc1
  s_mov_b32 s16, s90
  s_mov_b32 s17, s91
  s_mov_b32 s18, 0x400000
  s_mov_b32 s19, 0x00020000
  s_waitcnt vmcnt(4)
  v_pk_add_f32 v[0:1], v[0:1], v[32:33]
  v_pk_add_f32 v[2:3], v[2:3], v[34:35]
  v_pk_add_f32 v[4:5], v[4:5], v[36:37]
  v_pk_add_f32 v[6:7], v[6:7], v[38:39]
  v_pk_add_f32 v[8:9], v[8:9], v[40:41]
  v_pk_add_f32 v[10:11], v[10:11], v[42:43]
  v_pk_add_f32 v[12:13], v[12:13], v[44:45]
  v_pk_add_f32 v[14:15], v[14:15], v[46:47]
  v_permlane16_swap_b32 v0, v8
  v_permlane16_swap_b32 v1, v9
  v_permlane16_swap_b32 v2, v10
  v_permlane16_swap_b32 v3, v11
  v_lshlrev_b32 v120, 16, v88
  v_and_b32 v121, 0xffff0000, v88
  v_pk_add_f32 v[0:1], v[0:1], v[120:121]
  v_cvt_pk_bf16_f32 v88, v0, v1
  v_lshlrev_b32 v120, 16, v89
  v_and_b32 v121, 0xffff0000, v89
  v_pk_add_f32 v[2:3], v[2:3], v[120:121]
  v_cvt_pk_bf16_f32 v89, v2, v3
  v_lshlrev_b32 v120, 16, v90
  v_and_b32 v121, 0xffff0000, v90
  v_pk_add_f32 v[8:9], v[8:9], v[120:121]
  v_cvt_pk_bf16_f32 v90, v8, v9
  v_lshlrev_b32 v120, 16, v91
  v_and_b32 v121, 0xffff0000, v91
  v_pk_add_f32 v[10:11], v[10:11], v[120:121]
  v_cvt_pk_bf16_f32 v91, v10, v11
  buffer_store_dwordx4 v[88:91], v85, s[16:19], s44 offen offset:0
  v_permlane16_swap_b32 v4, v12
  v_permlane16_swap_b32 v5, v13
  v_permlane16_swap_b32 v6, v14
  v_permlane16_swap_b32 v7, v15
  v_lshlrev_b32 v120, 16, v92
  v_and_b32 v121, 0xffff0000, v92
  v_pk_add_f32 v[4:5], v[4:5], v[120:121]
  v_cvt_pk_bf16_f32 v92, v4, v5
  v_lshlrev_b32 v120, 16, v93
  v_and_b32 v121, 0xffff0000, v93
  v_pk_add_f32 v[6:7], v[6:7], v[120:121]
  v_cvt_pk_bf16_f32 v93, v6, v7
  v_lshlrev_b32 v120, 16, v94
  v_and_b32 v121, 0xffff0000, v94
  v_pk_add_f32 v[12:13], v[12:13], v[120:121]
  v_cvt_pk_bf16_f32 v94, v12, v13
  v_lshlrev_b32 v120, 16, v95
  v_and_b32 v121, 0xffff0000, v95
  v_pk_add_f32 v[14:15], v[14:15], v[120:121]
  v_cvt_pk_bf16_f32 v95, v14, v15
  buffer_store_dwordx4 v[92:95], v85, s[16:19], s45 offen offset:0
  s_waitcnt vmcnt(2)
  v_pk_add_f32 v[16:17], v[16:17], v[48:49]
  v_pk_add_f32 v[18:19], v[18:19], v[50:51]
  v_pk_add_f32 v[20:21], v[20:21], v[52:53]
  v_pk_add_f32 v[22:23], v[22:23], v[54:55]
  v_pk_add_f32 v[24:25], v[24:25], v[56:57]
  v_pk_add_f32 v[26:27], v[26:27], v[58:59]
  v_pk_add_f32 v[28:29], v[28:29], v[60:61]
  v_pk_add_f32 v[30:31], v[30:31], v[62:63]
  v_permlane16_swap_b32 v16, v24
  v_permlane16_swap_b32 v17, v25
  v_permlane16_swap_b32 v18, v26
  v_permlane16_swap_b32 v19, v27
  v_lshlrev_b32 v120, 16, v96
  v_and_b32 v121, 0xffff0000, v96
  v_pk_add_f32 v[16:17], v[16:17], v[120:121]
  v_cvt_pk_bf16_f32 v96, v16, v17
  v_lshlrev_b32 v120, 16, v97
  v_and_b32 v121, 0xffff0000, v97
  v_pk_add_f32 v[18:19], v[18:19], v[120:121]
  v_cvt_pk_bf16_f32 v97, v18, v19
  v_lshlrev_b32 v120, 16, v98
  v_and_b32 v121, 0xffff0000, v98
  v_pk_add_f32 v[24:25], v[24:25], v[120:121]
  v_cvt_pk_bf16_f32 v98, v24, v25
  v_lshlrev_b32 v120, 16, v99
  v_and_b32 v121, 0xffff0000, v99
  v_pk_add_f32 v[26:27], v[26:27], v[120:121]
  v_cvt_pk_bf16_f32 v99, v26, v27
  buffer_store_dwordx4 v[96:99], v85, s[16:19], s44 offen offset:64
  v_permlane16_swap_b32 v20, v28
  v_permlane16_swap_b32 v21, v29
  v_permlane16_swap_b32 v22, v30
  v_permlane16_swap_b32 v23, v31
  v_lshlrev_b32 v120, 16, v100
  v_and_b32 v121, 0xffff0000, v100
  v_pk_add_f32 v[20:21], v[20:21], v[120:121]
  v_cvt_pk_bf16_f32 v100, v20, v21
  v_lshlrev_b32 v120, 16, v101
  v_and_b32 v121, 0xffff0000, v101
  v_pk_add_f32 v[22:23], v[22:23], v[120:121]
  v_cvt_pk_bf16_f32 v101, v22, v23
  v_lshlrev_b32 v120, 16, v102
  v_and_b32 v121, 0xffff0000, v102
  v_pk_add_f32 v[28:29], v[28:29], v[120:121]
  v_cvt_pk_bf16_f32 v102, v28, v29
  v_lshlrev_b32 v120, 16, v103
  v_and_b32 v121, 0xffff0000, v103
  v_pk_add_f32 v[30:31], v[30:31], v[120:121]
  v_cvt_pk_bf16_f32 v103, v30, v31
  buffer_store_dwordx4 v[100:103], v85, s[16:19], s45 offen offset:64
  s_endpgm
fa_kernel_w1:
  v_mul_u32_u24 v4, 272, v1
  s_lshl_b32 s45, s96, 2
  s_add_u32 s45, s45, 61440
  v_add_u32 v4, s45, v4
  v_lshrrev_b32 v5, 4, v0
  v_mul_u32_u24 v7, 272, v5
  v_lshl_add_u32 v7, v2, 4, v7
  v_add_u32 v7, 61440, v7
  v_lshlrev_b32 v8, 13, v5
  v_lshl_add_u32 v8, v2, 4, v8
  s_lshl_b32 s46, s40, 19
  s_lshl_b32 s45, s42, 12
  s_add_u32 s46, s46, s45
  s_lshl_b32 s45, s43, 11
  s_add_u32 s46, s46, s45
  s_and_b32 s45, s41, 7
  s_lshl_b32 s45, s45, 8
  s_add_u32 s46, s46, s45
  v_add_u32 v9, s40, v5
  v_cmp_eq_u32 vcc, 0, v9
  v_mov_b32 v10, 0x40000000
  s_nop 0
  v_cndmask_b32 v9, v8, v10, vcc
  v_and_b32 v4, 31, v1
  v_mul_u32_u24 v4, 544, v4
  v_lshrrev_b32 v6, 5, v1
  v_lshl_add_u32 v4, v6, 4, v4
  s_lshl_b32 s45, s96, 2
  s_add_u32 s45, s45, 61440
  v_add_u32 v4, s45, v4
  s_mov_b32 s44, 0x05040100
  s_mov_b32 s45, 0x07060302
  v_accvgpr_read_b32 v24, a100
  v_accvgpr_read_b32 v40, a116
  v_accvgpr_read_b32 v25, a101
  v_accvgpr_read_b32 v41, a117
  v_accvgpr_read_b32 v26, a102
  v_accvgpr_read_b32 v42, a118
  v_accvgpr_read_b32 v27, a103
  v_accvgpr_read_b32 v43, a119
  v_accvgpr_read_b32 v28, a104
  v_accvgpr_read_b32 v44, a120
  v_accvgpr_read_b32 v29, a105
  v_accvgpr_read_b32 v45, a121
  v_accvgpr_read_b32 v30, a106
  v_accvgpr_read_b32 v46, a122
  v_accvgpr_read_b32 v31, a107
  v_accvgpr_read_b32 v47, a123
  v_perm_b32 v56, v40, v24, s44
  v_perm_b32 v64, v40, v24, s45
  ds_write2_b32 v4, v56, v64 offset0:0 offset1:68
  v_perm_b32 v57, v41, v25, s44
  v_perm_b32 v65, v41, v25, s45
  ds_write2_b32 v4, v57, v65 offset0:8 offset1:76
  v_perm_b32 v58, v42, v26, s44
  v_perm_b32 v66, v42, v26, s45
  ds_write2_b32 v4, v58, v66 offset0:16 offset1:84
  v_perm_b32 v59, v43, v27, s44
  v_perm_b32 v67, v43, v27, s45
  ds_write2_b32 v4, v59, v67 offset0:24 offset1:92
  v_perm_b32 v60, v44, v28, s44
  v_perm_b32 v68, v44, v28, s45
  ds_write2_b32 v4, v60, v68 offset0:32 offset1:100
  v_perm_b32 v61, v45, v29, s44
  v_perm_b32 v69, v45, v29, s45
  ds_write2_b32 v4, v61, v69 offset0:40 offset1:108
  v_perm_b32 v62, v46, v30, s44
  v_perm_b32 v70, v46, v30, s45
  ds_write2_b32 v4, v62, v70 offset0:48 offset1:116
  v_perm_b32 v63, v47, v31, s44
  v_perm_b32 v71, v47, v31, s45
  ds_write2_b32 v4, v63, v71 offset0:56 offset1:124
  s_waitcnt lgkmcnt(0)
  s_barrier
  ds_read_b128 v[24:27], v7 offset:0
  ds_read_b128 v[28:31], v7 offset:4352
  ds_read_b128 v[32:35], v7 offset:8704
  ds_read_b128 v[36:39], v7 offset:13056
  s_waitcnt lgkmcnt(3)
  buffer_store_dwordx4 v[24:27], v9, s[72:75], s46 offen sc1
  s_add_u32 s46, s46, 131072
  s_waitcnt lgkmcnt(2)
  buffer_store_dwordx4 v[28:31], v8, s[72:75], s46 offen sc1
  s_add_u32 s46, s46, 131072
  s_waitcnt lgkmcnt(1)
  buffer_store_dwordx4 v[32:35], v8, s[72:75], s46 offen sc1
  s_add_u32 s46, s46, 131072
  s_waitcnt lgkmcnt(0)
  buffer_store_dwordx4 v[36:39], v8, s[72:75], s46 offen sc1
  s_cmp_eq_u32 s96, 3
  s_cbranch_scc0 fa_kernel_n1
  v_accvgpr_read_b32 v40, a132
  v_accvgpr_read_b32 v42, a133
  v_lshlrev_b32 v40, 16, v40
  v_lshlrev_b32 v42, 16, v42
  s_nop 1
  v_mov_b32_dpp v41, v40 row_ror:8 row_mask:0xf bank_mask:0xf
  v_mov_b32_dpp v43, v42 row_ror:8 row_mask:0xf bank_mask:0xf
  v_add_f32 v40, v40, v41
  v_sub_f32 v42, v42, v43
  v_mul_f32 v40, 0.5, v40
  v_mul_f32 v42, 0.5, v42
  v_cvt_pk_bf16_f32 v40, v40, v42
  v_lshlrev_b32 v41, 2, v1
  s_lshl_b32 s45, s20, 5
  s_mov_b64 exec, 0xff
  buffer_store_dword v40, v41, s[72:75], s45 offen sc1
  s_mov_b64 exec, -1
fa_kernel_n1:
  s_cmp_lg_u32 s96, 0
  s_cbranch_scc1 fa_kernel_p2
  v_lshlrev_b32 v251, 2, v1
  s_mov_b32 s80, 0x40000
  s_mov_b32 s3, 0x01010101
  s_mov_b64 exec, 0xff
fa_kernel_p1:
  buffer_load_dword v250, v251, s[68:71], 0 offen sc1
  s_waitcnt vmcnt(0)
  v_cmp_ne_u32 vcc, s3, v250
  s_cbranch_vccz fa_kernel_p3
  s_sub_u32 s80, s80, 1
  s_cmp_lg_u32 s80, 0
  s_cbranch_scc1 fa_kernel_p1
fa_kernel_p3:
  s_mov_b64 exec, -1
fa_kernel_p2:
  s_waitcnt vmcnt(0)
  s_barrier
  s_add_u32 s76, s92, 0x7000000
  s_addc_u32 s77, s93, 0
  s_mov_b32 s78, 0x28000
  s_mov_b32 s79, 0x00020000
  s_cmp_lg_u32 s96, 0
  s_cbranch_scc1 fa_kernel_pub29
  s_and_b32 s3, s20, 31
  s_lshl_b32 s3, s3, 7
  s_add_u32 s3, s3, 131072
  v_mov_b32 v250, 1
  v_mov_b32 v251, 0
  s_mov_b64 exec, 1
  buffer_atomic_add v250, v251, s[76:79], s3 offen sc1
  s_mov_b64 exec, -1
fa_kernel_pub29:
  v_mbcnt_lo_u32_b32 v1, -1, 0
  v_mbcnt_hi_u32_b32 v1, -1, v1
  s_lshl_b32 s3, s96, 6
  v_add_u32 v0, s3, v1
  v_and_b32 v2, 15, v1
  v_lshrrev_b32 v3, 4, v1
  s_lshl_b32 s20, s54, 5
  s_add_u32 s20, s20, s55
  s_mov_b32 s21, s96
  v_lshlrev_b32 v248, 7, v2
  v_lshl_add_u32 v248, v3, 4, v248
  v_lshlrev_b32 v6, 4, v1
  s_lshr_b32 s22, s21, 1
  s_and_b32 s23, s21, 1
  s_lshl_b32 s24, s20, 1
  s_add_u32 s24, s24, s22
  s_lshl_b32 s28, s20, 14
  s_lshl_b32 s25, s21, 12
  s_add_u32 s28, s28, s25
  v_xor_b32 v8, v2, v3
  v_lshlrev_b32 v8, 4, v8
  v_lshl_add_u32 v249, v3, 8, v8
  s_add_u32 s25, s25, 131072
  v_add_u32 v249, s25, v249
  v_lshrrev_b32 v8, 1, v3
  v_and_b32 v9, 1, v3
  v_lshl_add_u32 v8, v8, 2, v9
  s_lshl_b32 s25, s22, 1
  v_add_u32 v8, s25, v8
  v_xor_b32 v8, v8, v2
  v_lshlrev_b32 v8, 4, v8
  v_lshl_add_u32 v5, v2, 8, v8
  v_add_u32 v5, 131072, v5
  s_lshl_b32 s24, s24, 13
  s_lshl_b32 s26, s23, 12
  s_add_u32 s26, s26, s24
  s_lshl_b32 s27, s21, 11
  s_add_u32 s27, s27, 147456
  v_add_u32 v7, s27, v6
  s_mov_b32 s60, s86
  s_mov_b32 s61, s87
  s_cmp_eq_u32 s97, 0
  s_cselect_b32 s62, 7340032, 0
  s_mov_b32 s63, 0x00020000
  v_lshlrev_b32 v252, 7, v1
  s_lshl_b32 s64, s20, 2
  s_add_u32 s64, s64, s96
  s_lshl_b32 s64, s64, 12
  s_mov_b64 exec, 0xffffffff
  buffer_load_dword v253, v252, s[60:63], s64 offen
  s_mov_b64 exec, -1
  s_branch fa_kernel_pre
fa_kernel_p0:
  s_add_u32 s12, s92, 0x800000
  s_addc_u32 s13, s93, 0
  s_mov_b32 s14, 0x400000
  s_mov_b32 s15, 0x00020000
  s_mov_b32 s16, s82
  s_mov_b32 s17, s83
  s_mov_b32 s18, 0x400000
  s_mov_b32 s19, 0x00020000
  s_add_u32 s8, s92, 0x1800000
  s_addc_u32 s9, s93, 0
  s_mov_b32 s10, 0x400000
  s_mov_b32 s11, 0x00020000
  buffer_load_dwordx4 v[56:59], v6, s[16:19], s26 offen offset:0 sc1
  buffer_load_dwordx4 v[60:63], v6, s[16:19], s26 offen offset:1024 sc1
  buffer_load_dwordx4 v[64:67], v6, s[16:19], s26 offen offset:2048 sc1
  buffer_load_dwordx4 v[68:71], v6, s[16:19], s26 offen offset:3072 sc1
  s_branch fa_kernel_k2l
fa_code_end:

.section .rodata,"a"
.p2align 6
.amdhsa_kernel fa_kernel
  .amdhsa_next_free_vgpr 512
  .amdhsa_next_free_sgpr 102
  .amdhsa_accum_offset 256
  .amdhsa_group_segment_fixed_size 0
  .amdhsa_kernarg_size 80
  .amdhsa_user_sgpr_count 2
  .amdhsa_user_sgpr_kernarg_segment_ptr 1
  .amdhsa_system_sgpr_workgroup_id_x 1
  .amdhsa_float_denorm_mode_32 3
  .amdhsa_float_denorm_mode_16_64 3
.end_amdhsa_kernel
```
